```python
import torch

def _softmax(x, axis=-1):
    return torch.softmax(x, dim=axis)
def _gelu(x):
    return torch.nn.functional.gelu(x, approximate="tanh")
def _silu(x):
    return torch.nn.functional.silu(x)
def _sigmoid(x):
    return torch.sigmoid(x)
def _layernorm(x, axis=-1, eps=1e-5):
    m = x.mean(dim=axis, keepdim=True)
    v = x.var(dim=axis, keepdim=True, unbiased=False)
    return (x - m) / torch.sqrt(v + eps)
def _scatter_add(tgt, idx, src, axis=0):
    return tgt.clone().index_add_(axis, idx, src)
def _segment_sum(src, seg, n):
    out = torch.zeros((n,) + src.shape[1:], dtype=src.dtype)
    return out.index_add_(0, seg, src)
def _pad(x, pw):
    flat = tuple(v for pair in reversed(pw) for v in pair)
    return torch.nn.functional.pad(x, flat)

kernel_name = 'interleave_layers__ssm_conv_h3__glu_gated_reglu__prompt'

def setup_inputs():

    _w = (lambda a: (lambda t: t.to(torch.bfloat16) if t.is_floating_point() else t)(torch.as_tensor(a)))
    def _A_setup():
        B, S, D = 1, 2048, 576
        ks = 4
        return {
            "q": _w((lambda *s: torch.randn(*s, dtype=torch.bfloat16) * 0.05)(B, S, D)),
            "k": _w((lambda *s: torch.randn(*s, dtype=torch.bfloat16) * 0.2)(B, S, D)),
            "v": _w((lambda *s: torch.randn(*s, dtype=torch.bfloat16) * 0.2)(B, S, D)),
            "shift_k": _w((lambda *s: torch.randn(*s, dtype=torch.bfloat16) * 0.2)(D, ks) * 0.5),
            "ssm_k": _w((lambda *s: torch.randn(*s, dtype=torch.bfloat16) * 0.4)(D, S) * (1.0 / S ** 0.5)),
            "ssm_D": _w((lambda *s: torch.randn(*s, dtype=torch.bfloat16) * 0.2)(D)),
        }
    _A_in = _A_setup()

    def _B_setup():
        B, S, D, F = 1, 2048, 576, 4608
        return {
            "x": _w((lambda *s: torch.randn(*s, dtype=torch.bfloat16) * 0.05)(B, S, D)),
            "W_gate": _w((lambda *s: torch.randn(*s, dtype=torch.bfloat16) * 0.2)(D, F) * (2.0 / D) ** 0.5),
            "W_up": _w((lambda *s: torch.randn(*s, dtype=torch.bfloat16) * 0.2)(D, F) * (2.0 / D) ** 0.5),
            "W_down": _w((lambda *s: torch.randn(*s, dtype=torch.bfloat16) * 0.2)(F, D) * (1.0 / F) ** 0.5),
        }
    _B_in = _B_setup()

    return {
        "A_q": _A_in["q"],
        "A_k": _A_in["k"],
        "A_v": _A_in["v"],
        "A_shift_k": _A_in["shift_k"],
        "A_ssm_k": _A_in["ssm_k"],
        "A_ssm_D": _A_in["ssm_D"],
        "B_x": _B_in["x"],
        "B_W_gate": _B_in["W_gate"],
        "B_W_up": _B_in["W_up"],
        "B_W_down": _B_in["W_down"],
    }

def reference(A_q, A_k, A_v, A_shift_k, A_ssm_k, A_ssm_D, B_x, B_W_gate, B_W_up, B_W_down):
    def _A_ref(q, k, v, shift_k, ssm_k, ssm_D):
        B, S, D = q.shape
        ks = shift_k.shape[-1]
        k_pad = _pad(k, ((0, 0), (ks - 1, 0), (0, 0)))
        k_shift = torch.zeros_like(k)
        for t in range(ks):
            k_shift = k_shift + k_pad[:, t:t + S, :] * shift_k[:, ks - 1 - t][None, None, :]
        kv = k_shift * v
        L = 2 * S
        kv_pad = _pad(kv, ((0, 0), (0, S), (0, 0)))
        kf_pad = _pad(ssm_k, ((0, 0), (0, S)))
        kv_f = (lambda x, axes=(-2,-1): torch.fft.rfft2(x.float(), dim=axes))(kv_pad[:, None, :, :], axes=(1, 2))
        kf_f = (lambda x, axes=(-2,-1): torch.fft.rfft2(x.float(), dim=axes))(kf_pad[:, None, :], axes=(1, 2))
        kf_f = (lambda x, *d: x.permute(*d))(kf_f, 1, 2, 0)
        y_f = kv_f * kf_f[None, :, :, :]
        y = (lambda x, s, axes=(-2,-1): torch.fft.irfft2(x, s=s, dim=axes).to(torch.bfloat16))(y_f, (1, L), axes=(1, 2))[:, 0, :S, :]
        y = y + kv * ssm_D[None, None, :]
        return q * y

    def _B_ref(x, W_gate, W_up, W_down):
        gate = torch.einsum("bsd,df->bsf", x, W_gate)
        up = torch.einsum("bsd,df->bsf", x, W_up)
        gate = gate * (lambda x, dt: x.to(dt))(gate > 0, gate.dtype)
        h = gate * up
        return torch.einsum("bsf,fd->bsd", h, W_down)

    x = A_q
    x = x + _A_ref(_layernorm(x, axis=-1), A_k, A_v, A_shift_k, A_ssm_k, A_ssm_D)
    x = x + _B_ref(_layernorm(x, axis=-1), B_W_gate, B_W_up, B_W_down)
    x = x + _A_ref(_layernorm(x, axis=-1), A_k, A_v, A_shift_k, A_ssm_k, A_ssm_D)
    x = x + _B_ref(_layernorm(x, axis=-1), B_W_gate, B_W_up, B_W_down)
    return x
```

```asm
; @launch grid=(256,1,1) block=(256,1,1) lds=163840
.amdgcn_target "amdgcn-amd-amdhsa--gfx950"
.text
.globl interleave_layers__ssm_conv_h3__glu_gated_reglu__prompt_kernel
.p2align 8
.type interleave_layers__ssm_conv_h3__glu_gated_reglu__prompt_kernel,@function
interleave_layers__ssm_conv_h3__glu_gated_reglu__prompt_kernel:
mega_kernel:
    s_cmp_ge_u32 s2, 256
    s_cbranch_scc1 END_1
    s_memrealtime s[12:13]
    s_load_dwordx16 s[16:31], s[0:1], 0
    s_load_dwordx8 s[32:39], s[0:1], 64
    s_load_dwordx2 s[4:5], s[0:1], 96
    s_getpc_b64 s[60:61]
PF_8:
    s_sub_u32 s60, s60, PF_8-mega_kernel
    s_subb_u32 s61, s61, 0
    s_lshr_b32 s62, s2, 3
    s_mul_i32 s62, s62, 4096
    v_lshl_add_u32 v210, v0, 4, s62
    v_min_u32 v210, code_end-mega_kernel-16, v210
    v_mov_b32 v211, s61
    v_add_co_u32 v210, vcc, s60, v210
    s_nop 1
    v_addc_co_u32 v211, vcc, 0, v211, vcc
    global_load_dwordx4 v[212:215], v[210:211], off
    v_lshrrev_b32 v1, 6, v0
    s_mov_b32 s7, 0
    s_mov_b32 s96, 0
    v_readfirstlane_b32 s3, v1
    v_and_b32 v4, 31, v0
    v_lshlrev_b32 v4, 2, v4
    s_lshr_b32 s45, s2, 5
    s_and_b32 s46, s2, 31
    v_and_b32 v2, 63, v0
    v_lshrrev_b32 v24, 3, v2
    v_and_b32 v25, 7, v0
    v_mul_u32_u24 v24, 1152, v24
    s_mul_i32 s47, s46, 73728
    s_lshl_b32 s48, s45, 7
    s_add_u32 s47, s47, s48
    s_sub_u32 s47, s47, 9216
    s_mul_i32 s48, s3, 9216
    s_add_u32 s47, s47, s48
    v_add_u32 v24, s47, v24
    v_xor_b32 v26, s3, v25
    v_lshl_add_u32 v27, v26, 4, v24
    v_xor_b32 v26, 4, v26
    v_lshl_add_u32 v28, v26, 4, v24
    v_add_u32 v28, 36864, v28
    v_lshl_add_u32 v29, v25, 4, v24
    v_subrev_u32 v29, s48, v29
    v_add_u32 v29, 73728, v29
    s_lshl_b32 s49, s3, 10
    v_lshrrev_b32 v20, 3, v0
    s_lshl_b32 s48, s45, 7
    v_lshl_add_u32 v22, v20, 2, s48
    v_lshlrev_b32 v20, 2, v22
    v_lshrrev_b32 v23, 6, v0
    s_lshl_b32 s48, s45, 4
    s_add_u32 s48, s48, 1024
    v_lshl_add_u32 v64, v23, 2, s48
    v_lshlrev_b32 v21, 2, v64
    s_waitcnt lgkmcnt(0)
    s_mov_b32 s64, s22
    s_mov_b32 s65, s23
    s_mov_b32 s66, 0x1200
    s_mov_b32 s67, 0x20000
    buffer_load_dwordx4 v[56:59], v20, s[64:67], 0 offen
    buffer_load_dwordx4 v[60:63], v21, s[64:67], 0 offen
    v_mov_b32 v7, s12
    s_sub_u32 s92, s12, 3000
    s_mov_b32 s52, s18
    s_mov_b32 s53, s19
    s_mov_b32 s54, 0x240000
    s_mov_b32 s55, 0x20000
    s_mov_b32 s56, s20
    s_mov_b32 s57, s21
    s_mov_b32 s58, 0x240000
    s_mov_b32 s59, 0x20000
    s_and_b32 s50, s3, 1
    s_cmp_eq_u32 s50, 0
    s_cselect_b32 s60, s18, s20
    s_cselect_b32 s61, s19, s21
    s_mov_b32 s62, 0x240000
    s_mov_b32 s63, 0x20000
    s_mul_i32 s50, s50, 9216
    s_add_u32 s50, s50, 8192
    s_add_u32 m0, s49, 0
    s_nop 0
    buffer_load_dwordx4 v27, s[52:55], 0 offen nt lds
    s_add_u32 m0, s49, 4096
    s_nop 0
    buffer_load_dwordx4 v28, s[52:55], 0 offen nt lds
    s_add_u32 m0, s49, 9216
    s_nop 0
    buffer_load_dwordx4 v27, s[56:59], 0 offen nt lds
    s_add_u32 m0, s49, 13312
    s_nop 0
    buffer_load_dwordx4 v28, s[56:59], 0 offen nt lds
    s_mov_b32 m0, s50
    s_lshr_b32 s51, s3, 1
    buffer_load_dwordx4 v29, s[60:63], 0 offen nt lds
    s_lshl_b32 s48, s51, 6
    s_lshl_b32 s47, s46, 6
    s_add_u32 s48, s48, s47
    s_sub_u32 s48, s48, 8
    v_add_u32 v26, s48, v2
    s_movk_i32 s47, 1152
    v_mul_lo_u32 v26, v26, s47
    s_lshl_b32 s48, s45, 4
    s_add_u32 s48, s48, 1024
    v_add_u32 v26, s48, v26
    s_and_b32 s48, s3, 1
    s_mul_i32 s48, s48, 1152
    s_lshl_b32 s47, s51, 10
    s_add_u32 s48, s48, s47
    s_add_u32 m0, s48, 18432
    s_cmp_eq_u32 s51, 0
    s_cselect_b64 exec, -1, 0xff
    buffer_load_dwordx4 v26, s[60:63], 0 offen lds
    s_mov_b64 exec, -1
    v_lshrrev_b32 v26, 3, v0
    v_mov_b32 v27, v22
    s_mov_b32 s8, s4
    s_mov_b32 s9, s5
    s_mov_b32 s10, 0x10000000
    s_mov_b32 s11, 0x20000
    s_or_b32 s12, s2, s3
    s_cmp_lg_u32 s12, 0
    s_cbranch_scc1 NN_10
    s_mov_b32 s12, s38
    s_mov_b32 s13, s39
    s_mov_b32 s14, 0x100
    s_mov_b32 s15, 0x20000
    v_or_b32 v7, 1, v7
    buffer_store_dword v7, off, s[12:15], 0 sc1
NN_10:
    s_lshl_b32 s50, s2, 2
    s_add_u32 s50, s50, s3
    s_lshl_b32 s51, s50, 12
    v_lshlrev_b32 v5, 4, v2
    s_cmp_lt_u32 s2, 144
    s_cselect_b32 s51, s51, 0
    s_cselect_b32 s54, 4096, 0
    s_add_u32 s52, s24, s51
    s_addc_u32 s53, s25, 0
    s_mov_b32 s55, 0x20000
    s_mov_b32 s56, s26
    s_mov_b32 s57, s27
    s_mov_b32 s58, 0x480
    s_mov_b32 s59, 0x20000
    buffer_load_dwordx4 v[140:143], v5, s[52:55], 0 offen offset:0 nt
    buffer_load_dwordx4 v[144:147], v5, s[52:55], 0 offen offset:1024 nt
    buffer_load_dwordx4 v[148:151], v5, s[52:55], 0 offen offset:2048 nt
    buffer_load_dwordx4 v[152:155], v5, s[52:55], 0 offen offset:3072 nt
    v_lshrrev_b32 v16, 4, v2
    v_and_b32 v17, 15, v2
    v_add_u32 v16, v16, v17
    v_lshlrev_b32 v16, 1, v16
    v_subrev_u32 v16, 32, v16
    buffer_load_ushort v207, v16, s[52:55], 0 offen
    s_lshl_b32 s51, s50, 1
    buffer_load_ushort v208, off, s[56:59], s51
    s_mov_b32 s88, s16
    s_mov_b32 s89, s17
    s_mov_b32 s90, 0x240000
    s_mov_b32 s91, 0x20000
    s_mov_b32 s12, s38
    s_mov_b32 s13, s39
    s_mov_b32 s14, 0x100
    s_mov_b32 s15, 0x20000
    v_lshl_add_u32 v65, v23, 2, v5
    v_add_u32 v65, 18512, v65
    v_lshlrev_b32 v64, 11, v64
    v_bfe_u32 v16, v0, 3, 1
    v_lshl_add_u32 v64, v16, 12, v64
    v_lshl_add_u32 v64, v25, 4, v64
    s_lshl_b32 s66, s46, 7
    s_add_u32 s66, s66, 0x6000000
    v_lshlrev_b32 v17, 8, v23
    v_add_u32 v17, 21504, v17
    v_xor_b32 v16, 7, v2
    v_lshl_add_u32 v16, v16, 1, v17
    v_add_u32 v17, v17, v5
    v_lshlrev_b32 v30, 11, v27
    s_lshl_b32 s48, s46, 7
    v_lshl_add_u32 v31, v25, 4, s48
    v_add_u32 v30, v30, v31
    v_lshrrev_b32 v28, 2, v26
    v_and_b32 v29, 3, v26
    v_lshlrev_b32 v29, 2, v29
    v_lshl_add_u32 v29, v25, 10, v29
    v_xor_b32 v31, v28, v25
    v_lshl_add_u32 v66, v31, 4, v29
    v_add_u32 v31, 1, v25
    v_and_b32 v31, 7, v31
    v_xor_b32 v31, v28, v31
    v_lshl_add_u32 v67, v31, 4, v29
    s_mov_b32 s64, 0x6000000
    s_mov_b32 s65, 0x6001000
    s_waitcnt vmcnt(12)
    v_lshlrev_b32 v68, 16, v56
    v_lshlrev_b32 v69, 16, v58
    v_and_b32 v70, 0xffff0000, v56
    v_and_b32 v71, 0xffff0000, v58
    v_lshlrev_b32 v72, 16, v57
    v_lshlrev_b32 v73, 16, v59
    v_and_b32 v74, 0xffff0000, v57
    v_and_b32 v75, 0xffff0000, v59
    v_lshlrev_b32 v100, 16, v60
    v_lshlrev_b32 v101, 16, v62
    v_and_b32 v102, 0xffff0000, v60
    v_and_b32 v103, 0xffff0000, v62
    v_lshlrev_b32 v104, 16, v61
    v_lshlrev_b32 v105, 16, v63
    v_and_b32 v106, 0xffff0000, v61
    v_and_b32 v107, 0xffff0000, v63
    s_waitcnt vmcnt(6)
    s_barrier
    buffer_load_dword v209, off, s[12:15], 0 sc1
    ds_read2_b32 v[120:121], v65 offset0:0 offset1:4
    ds_read2_b32 v[122:123], v65 offset0:8 offset1:12
    ds_read_b32 v119, v65 offset:1200
    ds_read2_b32 v[32:33], v66 offset0:128 offset1:160
    ds_read2_b32 v[34:35], v66 offset0:192 offset1:224
    v_add_u32 v26, 1024, v67
    v_add_u32 v27, 10240, v67
    ds_read2_b32 v[36:37], v26 offset0:0 offset1:32
    ds_read2_b32 v[38:39], v26 offset0:64 offset1:96
    ds_read2_b32 v[40:41], v26 offset0:128 offset1:160
    ds_read2_b32 v[42:43], v26 offset0:192 offset1:224
    ds_read2_b32 v[46:47], v27 offset0:0 offset1:32
    ds_read2_b32 v[48:49], v27 offset0:64 offset1:96
    ds_read2_b32 v[50:51], v27 offset0:128 offset1:160
    ds_read2_b32 v[52:53], v27 offset0:192 offset1:224
    s_waitcnt lgkmcnt(10)
    v_lshlrev_b32 v108, 16, v119
    v_and_b32 v109, 0xffff0000, v119
    v_lshlrev_b32 v110, 16, v120
    v_and_b32 v111, 0xffff0000, v120
    v_lshlrev_b32 v112, 16, v121
    v_and_b32 v113, 0xffff0000, v121
    v_lshlrev_b32 v114, 16, v122
    v_and_b32 v115, 0xffff0000, v122
    v_lshlrev_b32 v116, 16, v123
    v_and_b32 v117, 0xffff0000, v123
    v_pk_mul_f32 v[110:111], v[110:111], v[106:107]
    v_pk_fma_f32 v[110:111], v[112:113], v[104:105], v[110:111]
    v_pk_fma_f32 v[110:111], v[114:115], v[102:103], v[110:111]
    v_pk_fma_f32 v[110:111], v[116:117], v[100:101], v[110:111]
    v_pk_mul_f32 v[110:111], v[110:111], v[108:109]
    v_cvt_pk_bf16_f32 v118, v110, v111
    ds_write_b16 v16, v118
    ds_write_b16_d16_hi v16, v118 offset:128
    ds_read_b128 v[136:139], v17
    s_waitcnt lgkmcnt(7)
    v_lshlrev_b32 v78, 16, v33
    v_and_b32 v79, 0xffff0000, v33
    v_lshlrev_b32 v80, 16, v34
    v_and_b32 v81, 0xffff0000, v34
    v_lshlrev_b32 v82, 16, v35
    v_and_b32 v83, 0xffff0000, v35
    v_lshlrev_b32 v84, 16, v36
    v_and_b32 v85, 0xffff0000, v36
    v_lshlrev_b32 v86, 16, v37
    v_and_b32 v87, 0xffff0000, v37
    v_lshlrev_b32 v88, 16, v38
    v_and_b32 v89, 0xffff0000, v38
    v_lshlrev_b32 v90, 16, v39
    v_and_b32 v91, 0xffff0000, v39
    v_lshlrev_b32 v92, 16, v40
    v_and_b32 v93, 0xffff0000, v40
    v_lshlrev_b32 v94, 16, v41
    v_and_b32 v95, 0xffff0000, v41
    v_lshlrev_b32 v96, 16, v42
    v_and_b32 v97, 0xffff0000, v42
    v_lshlrev_b32 v98, 16, v43
    v_and_b32 v99, 0xffff0000, v43
    v_pk_mul_f32 v[102:103], v[78:79], v[74:75]
    v_pk_mul_f32 v[104:105], v[80:81], v[74:75]
    v_pk_mul_f32 v[106:107], v[82:83], v[74:75]
    v_pk_mul_f32 v[108:109], v[84:85], v[74:75]
    v_pk_mul_f32 v[110:111], v[86:87], v[74:75]
    v_pk_mul_f32 v[112:113], v[88:89], v[74:75]
    v_pk_mul_f32 v[114:115], v[90:91], v[74:75]
    v_pk_mul_f32 v[116:117], v[92:93], v[74:75]
    v_pk_fma_f32 v[102:103], v[80:81], v[72:73], v[102:103]
    v_pk_fma_f32 v[104:105], v[82:83], v[72:73], v[104:105]
    v_pk_fma_f32 v[106:107], v[84:85], v[72:73], v[106:107]
    v_pk_fma_f32 v[108:109], v[86:87], v[72:73], v[108:109]
    v_pk_fma_f32 v[110:111], v[88:89], v[72:73], v[110:111]
    v_pk_fma_f32 v[112:113], v[90:91], v[72:73], v[112:113]
    v_pk_fma_f32 v[114:115], v[92:93], v[72:73], v[114:115]
    v_pk_fma_f32 v[116:117], v[94:95], v[72:73], v[116:117]
    v_pk_fma_f32 v[102:103], v[82:83], v[70:71], v[102:103]
    v_pk_fma_f32 v[104:105], v[84:85], v[70:71], v[104:105]
    v_pk_fma_f32 v[106:107], v[86:87], v[70:71], v[106:107]
    v_pk_fma_f32 v[108:109], v[88:89], v[70:71], v[108:109]
    v_pk_fma_f32 v[110:111], v[90:91], v[70:71], v[110:111]
    v_pk_fma_f32 v[112:113], v[92:93], v[70:71], v[112:113]
    v_pk_fma_f32 v[114:115], v[94:95], v[70:71], v[114:115]
    v_pk_fma_f32 v[116:117], v[96:97], v[70:71], v[116:117]
    v_pk_fma_f32 v[102:103], v[84:85], v[68:69], v[102:103]
    v_pk_fma_f32 v[104:105], v[86:87], v[68:69], v[104:105]
    v_pk_fma_f32 v[106:107], v[88:89], v[68:69], v[106:107]
    v_pk_fma_f32 v[108:109], v[90:91], v[68:69], v[108:109]
    v_pk_fma_f32 v[110:111], v[92:93], v[68:69], v[110:111]
    v_pk_fma_f32 v[112:113], v[94:95], v[68:69], v[112:113]
    v_pk_fma_f32 v[114:115], v[96:97], v[68:69], v[114:115]
    v_pk_fma_f32 v[116:117], v[98:99], v[68:69], v[116:117]
    s_waitcnt lgkmcnt(0)
    s_mov_b64 exec, 0xffff
    buffer_store_dwordx4 v[136:139], v64, s[8:11], s66 offen sc1
    s_mov_b64 exec, -1
    v_lshlrev_b32 v78, 16, v46
    v_and_b32 v79, 0xffff0000, v46
    v_lshlrev_b32 v80, 16, v47
    v_and_b32 v81, 0xffff0000, v47
    v_lshlrev_b32 v82, 16, v48
    v_and_b32 v83, 0xffff0000, v48
    v_lshlrev_b32 v84, 16, v49
    v_and_b32 v85, 0xffff0000, v49
    v_lshlrev_b32 v86, 16, v50
    v_and_b32 v87, 0xffff0000, v50
    v_lshlrev_b32 v88, 16, v51
    v_and_b32 v89, 0xffff0000, v51
    v_lshlrev_b32 v90, 16, v52
    v_and_b32 v91, 0xffff0000, v52
    v_lshlrev_b32 v92, 16, v53
    v_and_b32 v93, 0xffff0000, v53
    v_pk_mul_f32 v[102:103], v[102:103], v[78:79]
    v_pk_mul_f32 v[104:105], v[104:105], v[80:81]
    v_pk_mul_f32 v[106:107], v[106:107], v[82:83]
    v_pk_mul_f32 v[108:109], v[108:109], v[84:85]
    v_pk_mul_f32 v[110:111], v[110:111], v[86:87]
    v_pk_mul_f32 v[112:113], v[112:113], v[88:89]
    v_pk_mul_f32 v[114:115], v[114:115], v[90:91]
    v_pk_mul_f32 v[116:117], v[116:117], v[92:93]
    v_cvt_pk_bf16_f32 v124, v116, v114
    v_cvt_pk_bf16_f32 v125, v112, v110
    v_cvt_pk_bf16_f32 v126, v108, v106
    v_cvt_pk_bf16_f32 v127, v104, v102
    buffer_store_dwordx4 v[124:127], v30, s[8:11], s64 offen sc1
    v_cvt_pk_bf16_f32 v132, v117, v115
    v_cvt_pk_bf16_f32 v133, v113, v111
    v_cvt_pk_bf16_f32 v134, v109, v107
    v_cvt_pk_bf16_f32 v135, v105, v103
    buffer_store_dwordx4 v[132:135], v30, s[8:11], s65 offen sc1
    s_mov_b64 exec, -1
    buffer_load_dwordx4 v[156:159], v5, s[52:55], 0 offen offset:4
    buffer_load_dwordx4 v[160:163], v5, s[52:55], 0 offen offset:1028
    buffer_load_dwordx4 v[164:167], v5, s[52:55], 0 offen offset:2052
    buffer_load_dwordx4 v[168:171], v5, s[52:55], 0 offen offset:3076
    buffer_load_dwordx4 v[172:175], v5, s[52:55], 0 offen offset:8
    buffer_load_dwordx4 v[176:179], v5, s[52:55], 0 offen offset:1032
    buffer_load_dwordx4 v[180:183], v5, s[52:55], 0 offen offset:2056
    buffer_load_dwordx4 v[184:187], v5, s[52:55], 0 offen offset:3080
    s_waitcnt vmcnt(11)
    v_readfirstlane_b32 s6, v209
    s_cmp_eq_u32 s6, 0
    s_cbranch_scc1 KV3_11
    s_sub_u32 s47, s6, s92
    s_cmp_ge_i32 s47, 0
    s_cbranch_scc1 KV2_9
KV3_11:
    s_mov_b32 s47, 0x80000
NC_12:
    buffer_load_dword v32, off, s[12:15], 0 sc1
    s_sub_u32 s47, s47, 1
    s_waitcnt vmcnt(0)
    v_readfirstlane_b32 s6, v32
    s_cmp_eq_u32 s47, 0
    s_cbranch_scc1 NO_13
    s_cmp_eq_u32 s6, 0
    s_cbranch_scc1 NC_12
    s_cmp_lt_u32 s47, 0x7ff38
    s_cbranch_scc1 NO_13
    s_sub_u32 s48, s6, s92
    s_cmp_lt_i32 s48, 0
    s_cbranch_scc1 NC_12
NO_13:
KV2_9:
    s_lshl_b32 s51, s2, 7
    s_add_u32 s51, s51, 0x5800000
    v_mov_b32 v32, s6
    s_lshl_b32 s47, s3, 28
    s_add_u32 s47, s47, s51
    s_waitcnt vmcnt(8) lgkmcnt(0)
    s_barrier
    buffer_store_dword v32, v4, s[8:11], s47 offen sc1
    s_cmp_eq_u32 s3, 0
    s_cbranch_scc1 PAD_END
    s_mov_b64 exec, 0
    s_cmp_eq_u32 s3, 1
    s_cbranch_scc1 PAD_0
    s_cmp_eq_u32 s3, 2
    s_cbranch_scc1 PAD_1
    s_branch PAD_2
.p2align 12
PAD_END:
    s_mov_b64 exec, -1
    s_cmp_ge_u32 s2, 144
    s_cbranch_scc1 TOUCH_2
    v_and_b32 v16, 63, v0
    v_lshlrev_b32 v224, 2, v16
    s_mul_i32 s60, s3, 33152
    s_mul_i32 s61, s3, 7584
    s_add_u32 s61, s61, 132608
    v_add_u32 v229, s61, v5
    v_mov_b32 v20, 0
    v_mov_b32 v21, 0
    v_mov_b32 v22, 0
    v_mov_b32 v23, 0
    ds_write_b128 v229, v[20:23]
    v_mov_b32 v224, v5
    v_add_u32 v17, s60, v224
    s_waitcnt vmcnt(1)
    ds_write_b128 v17, v[140:143] offset:32
    v_alignbit_b32 v72, v156, v140, 16
    v_alignbit_b32 v73, v157, v141, 16
    v_alignbit_b32 v74, v158, v142, 16
    v_alignbit_b32 v75, v159, v143, 16
    ds_write_b128 v17, v[156:159] offset:8352
    v_alignbit_b32 v88, v172, v156, 16
    v_alignbit_b32 v89, v173, v157, 16
    v_alignbit_b32 v90, v174, v158, 16
    v_alignbit_b32 v91, v175, v159, 16
    ds_write_b128 v17, v[144:147] offset:1056
    v_alignbit_b32 v76, v160, v144, 16
    v_alignbit_b32 v77, v161, v145, 16
    v_alignbit_b32 v78, v162, v146, 16
    v_alignbit_b32 v79, v163, v147, 16
    ds_write_b128 v17, v[160:163] offset:9376
    v_alignbit_b32 v92, v176, v160, 16
    v_alignbit_b32 v93, v177, v161, 16
    v_alignbit_b32 v94, v178, v162, 16
    v_alignbit_b32 v95, v179, v163, 16
    ds_write_b128 v17, v[148:151] offset:2080
    v_alignbit_b32 v80, v164, v148, 16
    v_alignbit_b32 v81, v165, v149, 16
    v_alignbit_b32 v82, v166, v150, 16
    v_alignbit_b32 v83, v167, v151, 16
    ds_write_b128 v17, v[164:167] offset:10400
    v_alignbit_b32 v96, v180, v164, 16
    v_alignbit_b32 v97, v181, v165, 16
    v_alignbit_b32 v98, v182, v166, 16
    v_alignbit_b32 v99, v183, v167, 16
    ds_write_b128 v17, v[152:155] offset:3104
    v_alignbit_b32 v84, v168, v152, 16
    v_alignbit_b32 v85, v169, v153, 16
    v_alignbit_b32 v86, v170, v154, 16
    v_alignbit_b32 v87, v171, v155, 16
    ds_write_b128 v17, v[168:171] offset:11424
    v_alignbit_b32 v100, v184, v168, 16
    v_alignbit_b32 v101, v185, v169, 16
    v_alignbit_b32 v102, v186, v170, 16
    v_alignbit_b32 v103, v187, v171, 16
    s_waitcnt lgkmcnt(4)
    ds_write_b128 v17, v[72:75] offset:4192
    ds_write_b128 v17, v[88:91] offset:12512
    ds_write_b128 v17, v[76:79] offset:5216
    ds_write_b128 v17, v[92:95] offset:13536
    ds_write_b128 v17, v[80:83] offset:6240
    ds_write_b128 v17, v[96:99] offset:14560
    ds_write_b128 v17, v[84:87] offset:7264
    ds_write_b128 v17, v[100:103] offset:15584
    v_and_b32 v227, 15, v16
    v_lshrrev_b32 v228, 4, v16
    v_lshlrev_b32 v19, 3, v228
    v_mul_u32_u24 v18, 4160, v228
    v_lshl_add_u32 v18, v227, 1, v18
    v_add_u32 v18, s60, v18
    ds_write_b16 v18, v207
    v_sub_u32 v19, v227, v19
    v_add_u32 v19, 25, v19
    v_and_b32 v24, 3, v19
    v_mul_u32_u24 v24, 4160, v24
    v_lshrrev_b32 v19, 2, v19
    v_lshl_add_u32 v19, v19, 3, v24
    v_add_u32 v225, s60, v19
    v_lshlrev_b32 v19, 5, v227
    v_lshl_add_u32 v19, v228, 4, v19
    v_add_u32 v226, s61, v19
    s_lshr_b32 s49, s2, 4
    s_bfe_u32 s47, s2, 0x30001
    s_cmp_ge_u32 s2, 128
    s_cselect_b32 s49, s47, s49
    s_lshl_b32 s49, s49, 12
    s_add_u32 s49, s49, 0x5800000
    s_lshl_b32 s47, s2, 2
    s_add_u32 s47, s47, s3
    s_lshl_b32 s47, s47, 12
    s_add_u32 s62, s47, 0x6000000
    s_add_u32 m0, s61, 480
    s_mov_b32 s63, s49
    s_waitcnt lgkmcnt(0)
    s_cmp_lg_u32 s3, 0
    s_cbranch_scc1 SW_16
    v_and_b32 v24, 63, v0
    v_lshlrev_b32 v24, 7, v24
    s_mov_b64 exec, 0xffffffff
    s_mov_b32 s47, 0x80000
    buffer_load_dword v200, v24, s[8:11], s63 offen sc1
SP_14:
    s_waitcnt vmcnt(0)
    v_cmp_ne_u32 vcc, s6, v200
    s_cbranch_vccz SO_15
    s_mov_b64 exec, vcc
    buffer_load_dword v200, v24, s[8:11], s63 offen sc1
    s_sub_u32 s47, s47, 1
    s_cmp_lg_u32 s47, 0
    s_cbranch_scc1 SP_14
SO_15:
    s_mov_b64 exec, -1
    s_branch SB_17
SW_16:
    s_waitcnt vmcnt(0)
SB_17:
    s_barrier
    buffer_load_dwordx4 v224, s[8:11], s62 offen offset:0 sc1 lds
    buffer_load_dwordx4 v224, s[8:11], s62 offen offset:1024 sc1 lds
    buffer_load_dwordx4 v224, s[8:11], s62 offen offset:2048 sc1 lds
    buffer_load_dwordx4 v224, s[8:11], s62 offen offset:3072 sc1 lds
    v_and_b32 v16, 7, v0
    v_bfe_u32 v17, v0, 3, 2
    v_bfe_u32 v18, v0, 5, 1
    v_lshrrev_b32 v19, 6, v0
    v_lshl_add_u32 v20, v19, 2, v18
    v_lshl_add_u32 v21, v19, 1, v18
    v_lshlrev_b32 v217, 4, v16
    v_lshl_add_u32 v217, v17, 8, v217
    v_lshl_add_u32 v217, v20, 12, v217
    v_bfe_u32 v22, v0, 4, 2
    v_lshl_add_u32 v22, v22, 4, v16
    v_bfe_u32 v23, v0, 3, 1
    v_lshlrev_b32 v23, 2, v23
    v_lshrrev_b32 v24, 1, v19
    v_lshl_add_u32 v23, v24, 12, v23
    v_add_u32 v23, 65536, v23
    v_and_b32 v24, 1, v19
    v_lshl_add_u32 v218, v22, 4, v23
    v_lshl_add_u32 v218, v24, 3, v218
    v_bfe_u32 v22, v0, 4, 2
    v_lshl_add_u32 v22, v22, 3, v16
    v_lshl_add_u32 v219, v22, 3, v23
    v_lshl_add_u32 v219, v24, 9, v219
    v_mul_u32_u24 v22, 1152, v16
    v_lshl_add_u32 v250, v20, 6, v22
    v_lshl_add_u32 v250, v17, 3, v250
    v_lshl_add_u32 v251, v21, 4, v22
    v_lshl_add_u32 v251, v17, 2, v251
    v_lshlrev_b32 v22, 3, v16
    v_lshl_add_u32 v252, v20, 9, v22
    v_lshl_add_u32 v252, v17, 6, v252
    v_lshl_add_u32 v253, v21, 7, v22
    v_lshrrev_b32 v22, 1, v17
    v_lshl_add_u32 v253, v22, 6, v253
    v_and_b32 v22, 1, v17
    v_lshl_add_u32 v253, v22, 2, v253
    v_add_u32 v253, 0x2000, v253
    v_and_b32 v16, 63, v0
    v_lshlrev_b32 v1, 4, v16
    v_lshlrev_b32 v2, 3, v16
    v_lshrrev_b32 v17, 3, v16
    v_lshrrev_b32 v18, 4, v16
    v_lshlrev_b32 v19, 1, v18
    v_and_b32 v20, 7, v16
    v_xor_b32 v19, v19, v20
    v_lshlrev_b32 v19, 4, v19
    s_movk_i32 s44, 9216
    s_movk_i32 s45, 1152
    v_mad_u32_u24 v3, v17, s44, v19
    v_mad_u32_u24 v5, v17, s45, v19
    v_lshrrev_b32 v17, 2, v16
    v_and_b32 v19, 3, v16
    v_lshlrev_b32 v19, 3, v19
    v_bfe_u32 v20, v16, 3, 2
    v_lshl_add_u32 v21, v17, 7, v19
    v_xor_b32 v22, 0, v20
    v_lshl_add_u32 v6, v22, 5, v21
    v_xor_b32 v22, 1, v20
    v_lshl_add_u32 v7, v22, 5, v21
    v_xor_b32 v22, 2, v20
    v_lshl_add_u32 v8, v22, 5, v21
    v_xor_b32 v22, 3, v20
    v_lshl_add_u32 v9, v22, 5, v21
    v_lshl_add_u32 v10, v17, 5, v19
    v_add_u32 v11, 0x10000, v6
    v_add_u32 v12, 0x10000, v7
    v_add_u32 v13, 0x10000, v8
    v_add_u32 v14, 0x10000, v9
    v_add_u32 v15, 0x10000, v10
    s_and_b32 s46, s2, 7
    s_lshr_b32 s47, s2, 3
    s_and_b32 s24, s47, 3
    s_mul_i32 s28, s47, 73728
    s_bfe_u32 s44, s2, 0x20001
    s_lshl_b32 s44, s44, 10
    s_add_u32 s28, s28, s44
    s_and_b32 s44, s2, 1
    s_lshl_b32 s44, s44, 7
    s_add_u32 s28, s28, s44
    s_add_u32 s41, s28, s44
    s_lshr_b32 s47, s47, 2
    s_lshl_b32 s18, s3, 10
    s_mul_i32 s48, s46, 1152
    s_lshl_b32 s49, s24, 8
    s_lshl_b32 s50, s24, 5
    s_add_u32 s50, s50, 1024
    s_mul_i32 s44, s3, 73728
    s_add_u32 s44, s44, s48
    s_add_u32 s36, s44, s49
    s_mul_i32 s50, s24, 18432
    s_add_u32 s50, s50, 0x5900000
    s_mul_i32 s44, s46, 3
    s_and_b32 s45, s3, 1
    s_add_u32 s44, s44, s45
    s_mul_i32 s44, s44, 73728
    s_lshr_b32 s45, s3, 1
    s_lshl_b32 s45, s45, 10
    s_add_u32 s44, s44, s45
    s_add_u32 s37, s44, s50
    s_and_b32 s48, s46, 6
    s_mul_i32 s48, s48, 663552
    s_mul_i32 s44, s3, 9216
    s_add_u32 s44, s44, s48
    s_add_u32 s38, s44, s49
    s_and_b32 s48, s46, 6
    s_mul_i32 s48, s48, 221184
    s_add_u32 s48, s48, 147456
    s_add_u32 s48, s48, s50
    s_lshl_b32 s44, s3, 12
    s_add_u32 s39, s44, s48
    s_and_b32 s44, s18, 1024
    s_add_u32 s44, s44, 16384
    s_add_u32 s40, s44, s48
    s_lshl_b32 s45, s47, 2
    s_add_u32 s45, s45, s3
    s_mul_i32 s45, s45, 73728
    s_add_u32 s16, s45, 0x1800000
    s_mul_i32 s44, s46, 2359296
    s_add_u32 s45, s45, s44
    s_add_u32 s17, s45, 0x2000000
    s_lshl_b32 s44, s24, 12
    s_add_u32 s25, s17, s44
    s_lshr_b32 s44, s24, 1
    s_lshl_b32 s44, s44, 12
    s_and_b32 s45, s24, 1
    s_lshl_b32 s45, s45, 9
    s_add_u32 s44, s44, s45
    s_add_u32 s49, s44, 65536
    s_add_u32 s27, s49, s17
    s_and_b32 s44, s46, 1
    s_lshl_b32 s44, s44, 1
    s_and_b32 s45, s3, 1
    s_add_u32 s44, s44, s45
    s_lshl_b32 s45, s47, 2
    s_add_u32 s44, s44, s45
    s_mul_i32 s44, s44, 73728
    s_lshr_b32 s50, s3, 1
    s_and_b32 s48, s46, 6
    s_add_u32 s48, s48, s50
    s_lshl_b32 s93, s50, 12
    s_lshl_b32 s50, s50, 11
    s_mul_i32 s45, s48, 2359296
    s_add_u32 s45, s45, s44
    s_add_u32 s45, s45, 0x2000000
    s_add_u32 s17, s45, s50
    s_sub_u32 s94, s45, s50
    s_lshr_b32 s45, s46, 1
    s_mul_i32 s45, s45, 2359296
    s_add_u32 s45, s45, s44
    s_add_u32 s45, s45, s50
    s_add_u32 s45, s45, 0x4000000
    s_add_u32 s43, s45, s49
    s_lshl_b32 s44, s24, 14
    s_add_u32 s22, s45, s44
    s_lshl_b32 s47, s47, 3
    s_add_u32 s48, s48, s47
    s_lshl_b32 s48, s48, 9
    s_add_u32 s95, s48, 0x5860000
    s_add_u32 s47, s47, s46
    s_lshl_b32 s47, s47, 9
    s_add_u32 s23, s47, 0x5860000
    s_add_u32 s72, s30, s36
    s_addc_u32 s73, s31, 0
    s_add_u32 s74, s32, s36
    s_addc_u32 s75, s33, 0
    s_add_u32 s76, s34, s38
    s_addc_u32 s77, s35, 0
    s_add_u32 s78, s4, s16
    s_addc_u32 s79, s5, 0
    s_add_u32 s80, s4, s17
    s_addc_u32 s81, s5, 0
    s_add_u32 s82, s4, s94
    s_addc_u32 s83, s5, 0
    s_add_u32 s84, s4, s37
    s_addc_u32 s85, s5, 0
    s_add_u32 s86, s4, s39
    s_addc_u32 s87, s5, 0
    s_add_u32 s98, s4, s40
    s_addc_u32 s99, s5, 0
    s_waitcnt lgkmcnt(0)
    s_waitcnt vmcnt(3)
    ds_read_b128 a[32:35], v226 offset:448
    ds_read_b64 a[0:1], v225 offset:0
    ds_read_b64 a[2:3], v225 offset:8
    ds_read_b128 a[36:39], v226 offset:960
    ds_read_b64 a[4:5], v225 offset:512
    ds_read_b64 a[6:7], v225 offset:520
    s_waitcnt vmcnt(2)
    ds_read_b128 a[40:43], v226 offset:1472
    ds_read_b64 a[8:9], v225 offset:1024
    ds_read_b64 a[10:11], v225 offset:1032
    s_waitcnt lgkmcnt(6)
    v_mfma_f32_16x16x32_bf16 v[168:171], a[0:3], a[32:35], 0
    ds_read_b128 a[44:47], v226 offset:1984
    ds_read_b64 a[12:13], v225 offset:1536
    s_waitcnt lgkmcnt(5)
    v_mfma_f32_16x16x32_bf16 v[172:175], a[0:3], a[36:39], 0
    ds_read_b64 a[14:15], v225 offset:1544
    ds_read_b128 a[96:99], v226 offset:384
    v_xor_b32 v17, 1, v228
    v_mfma_f32_16x16x32_bf16 v[172:175], a[4:7], a[32:35], v[172:175]
    ds_read_b64 a[64:65], v225 offset:64
    ds_read_b64 a[66:67], v225 offset:72
    s_waitcnt lgkmcnt(6)
    v_mfma_f32_16x16x32_bf16 v[176:179], a[0:3], a[40:43], 0
    ds_read_b128 a[100:103], v226 offset:896
    ds_read_b64 a[68:69], v225 offset:576
    v_lshlrev_b32 v17, 3, v17
    v_mfma_f32_16x16x32_bf16 v[176:179], a[4:7], a[36:39], v[176:179]
    ds_read_b64 a[70:71], v225 offset:584
    v_lshl_add_u32 v17, v227, 5, v17
    v_mfma_f32_16x16x32_bf16 v[176:179], a[8:11], a[32:35], v[176:179]
    ds_read_b128 a[104:107], v226 offset:1408
    v_add_u32 v17, s61, v17
    s_waitcnt lgkmcnt(7)
    v_mfma_f32_16x16x32_bf16 v[180:183], a[0:3], a[44:47], 0
    ds_read_b64 a[72:73], v225 offset:1088
    v_lshlrev_b32 v208, 16, v208
    v_mfma_f32_16x16x32_bf16 v[180:183], a[4:7], a[40:43], v[180:183]
    ds_read_b64 a[74:75], v225 offset:1096
    v_lshlrev_b32 v18, 5, v227
    v_mfma_f32_16x16x32_bf16 v[180:183], a[8:11], a[36:39], v[180:183]
    ds_read_b128 a[108:111], v226 offset:1920
    v_lshl_add_u32 v18, v228, 3, v18
    v_mfma_f32_16x16x32_bf16 v[180:183], a[12:15], a[32:35], v[180:183]
    ds_read_b64 a[76:77], v225 offset:1600
    v_add_u32 v18, s60, v18
    s_waitcnt lgkmcnt(8)
    v_mfma_f32_16x16x32_bf16 v[168:171], a[64:67], a[96:99], v[168:171]
    ds_read_b64 a[78:79], v225 offset:1608
    ds_read_b128 a[32:35], v226 offset:320
    s_waitcnt lgkmcnt(7)
    v_mfma_f32_16x16x32_bf16 v[172:175], a[64:67], a[100:103], v[172:175]
    ds_read_b64 a[0:1], v225 offset:128
    ds_read_b64 a[2:3], v225 offset:136
    v_lshlrev_b32 v24, 2, v0
    v_mfma_f32_16x16x32_bf16 v[172:175], a[68:71], a[96:99], v[172:175]
    ds_read_b128 a[36:39], v226 offset:832
    ds_read_b64 a[4:5], v225 offset:640
    s_waitcnt lgkmcnt(8)
    v_mfma_f32_16x16x32_bf16 v[176:179], a[64:67], a[104:107], v[176:179]
    ds_read_b64 a[6:7], v225 offset:648
    v_add_u32 v26, 66304, v24
    v_mfma_f32_16x16x32_bf16 v[176:179], a[68:71], a[100:103], v[176:179]
    ds_read_b128 a[40:43], v226 offset:1344
    v_lshrrev_b32 v25, 2, v0
    v_mfma_f32_16x16x32_bf16 v[176:179], a[72:75], a[96:99], v[176:179]
    ds_read_b64 a[8:9], v225 offset:1152
    v_mul_u32_u24 v25, 9216, v25
    s_waitcnt lgkmcnt(8)
    v_mfma_f32_16x16x32_bf16 v[180:183], a[64:67], a[108:111], v[180:183]
    ds_read_b64 a[10:11], v225 offset:1160
    v_and_b32 v19, 3, v0
    v_mfma_f32_16x16x32_bf16 v[180:183], a[68:71], a[104:107], v[180:183]
    ds_read_b128 a[44:47], v226 offset:1856
    v_lshl_add_u32 v25, v19, 4, v25
    v_mfma_f32_16x16x32_bf16 v[180:183], a[72:75], a[100:103], v[180:183]
    ds_read_b64 a[12:13], v225 offset:1664
    v_mov_b32 v27, s6
    v_mfma_f32_16x16x32_bf16 v[180:183], a[76:79], a[96:99], v[180:183]
    ds_read_b64 a[14:15], v225 offset:1672
    s_lshl_b32 s47, s2, 6
    s_waitcnt lgkmcnt(9)
    v_mfma_f32_16x16x32_bf16 v[168:171], a[0:3], a[32:35], v[168:171]
    ds_read_b128 a[96:99], v226 offset:256
    ds_read_b64 a[64:65], v225 offset:192
    s_waitcnt lgkmcnt(8)
    v_mfma_f32_16x16x32_bf16 v[172:175], a[0:3], a[36:39], v[172:175]
    ds_read_b64 a[66:67], v225 offset:200
    ds_read_b128 a[100:103], v226 offset:768
    s_add_u32 s47, s47, 0x5c00000
    v_mfma_f32_16x16x32_bf16 v[172:175], a[4:7], a[32:35], v[172:175]
    ds_read_b64 a[68:69], v225 offset:704
    s_mov_b32 s48, 0x05040100
    s_waitcnt lgkmcnt(8)
    v_mfma_f32_16x16x32_bf16 v[176:179], a[0:3], a[40:43], v[176:179]
    ds_read_b64 a[70:71], v225 offset:712
    s_mov_b32 s49, 0x07060302
    v_mfma_f32_16x16x32_bf16 v[176:179], a[4:7], a[36:39], v[176:179]
    ds_read_b128 a[104:107], v226 offset:1280
    s_lshl_b32 s50, s3, 28
    v_mfma_f32_16x16x32_bf16 v[176:179], a[8:11], a[32:35], v[176:179]
    ds_read_b64 a[72:73], v225 offset:1216
    s_lshl_b32 s51, s2, 7
    s_waitcnt lgkmcnt(8)
    v_mfma_f32_16x16x32_bf16 v[180:183], a[0:3], a[44:47], v[180:183]
    ds_read_b64 a[74:75], v225 offset:1224
    s_add_u32 s51, s51, 0x5808000
    v_mfma_f32_16x16x32_bf16 v[180:183], a[4:7], a[40:43], v[180:183]
    ds_read_b128 a[108:111], v226 offset:1792
    s_add_u32 s45, s50, s51
    v_mfma_f32_16x16x32_bf16 v[180:183], a[8:11], a[36:39], v[180:183]
    ds_read_b64 a[76:77], v225 offset:1728
    s_lshr_b32 s44, s2, 2
    v_mfma_f32_16x16x32_bf16 v[180:183], a[12:15], a[32:35], v[180:183]
    ds_read_b64 a[78:79], v225 offset:1736
    s_lshl_b32 s44, s44, 7
    s_waitcnt lgkmcnt(9)
    v_mfma_f32_16x16x32_bf16 v[168:171], a[64:67], a[96:99], v[168:171]
    ds_read_b128 a[32:35], v226 offset:192
    ds_read_b64 a[0:1], v225 offset:256
    s_waitcnt lgkmcnt(8)
    v_mfma_f32_16x16x32_bf16 v[172:175], a[64:67], a[100:103], v[172:175]
    ds_read_b64 a[2:3], v225 offset:264
    ds_read_b128 a[36:39], v226 offset:704
    s_add_u32 s50, s50, s44
    v_mfma_f32_16x16x32_bf16 v[172:175], a[68:71], a[96:99], v[172:175]
    ds_read_b64 a[4:5], v225 offset:768
    s_and_b32 s44, s2, 3
    s_waitcnt lgkmcnt(8)
    v_mfma_f32_16x16x32_bf16 v[176:179], a[64:67], a[104:107], v[176:179]
    ds_read_b64 a[6:7], v225 offset:776
    s_lshl_b32 s44, s44, 2
    v_mfma_f32_16x16x32_bf16 v[176:179], a[68:71], a[100:103], v[176:179]
    ds_read_b128 a[40:43], v226 offset:1216
    s_add_u32 s50, s50, s44
    v_mfma_f32_16x16x32_bf16 v[176:179], a[72:75], a[96:99], v[176:179]
    ds_read_b64 a[8:9], v225 offset:1280
    s_add_u32 s50, s50, 0x58a0000
    s_waitcnt lgkmcnt(8)
    v_mfma_f32_16x16x32_bf16 v[180:183], a[64:67], a[108:111], v[180:183]
    ds_read_b64 a[10:11], v225 offset:1288
    s_mul_i32 s46, s2, 9216
    v_mfma_f32_16x16x32_bf16 v[180:183], a[68:71], a[104:107], v[180:183]
    ds_read_b128 a[44:47], v226 offset:1728
    buffer_load_dwordx2 v[240:241], v250, s[88:91], s46 offen offset:0
    v_mfma_f32_16x16x32_bf16 v[180:183], a[72:75], a[100:103], v[180:183]
    ds_read_b64 a[12:13], v225 offset:1792
    v_mfma_f32_16x16x32_bf16 v[180:183], a[76:79], a[96:99], v[180:183]
    ds_read_b64 a[14:15], v225 offset:1800
    s_waitcnt lgkmcnt(9)
    v_mfma_f32_16x16x32_bf16 v[168:171], a[0:3], a[32:35], v[168:171]
    ds_read_b128 a[96:99], v226 offset:128
    ds_read_b64 a[64:65], v225 offset:320
    s_waitcnt lgkmcnt(8)
    v_mfma_f32_16x16x32_bf16 v[172:175], a[0:3], a[36:39], v[172:175]
    ds_read_b64 a[66:67], v225 offset:328
    ds_read_b128 a[100:103], v226 offset:640
    v_mfma_f32_16x16x32_bf16 v[172:175], a[4:7], a[32:35], v[172:175]
    ds_read_b64 a[68:69], v225 offset:832
    buffer_load_dwordx2 v[242:243], v250, s[88:91], s46 offen offset:32
    s_waitcnt lgkmcnt(8)
    v_mfma_f32_16x16x32_bf16 v[176:179], a[0:3], a[40:43], v[176:179]
    ds_read_b64 a[70:71], v225 offset:840
    v_mfma_f32_16x16x32_bf16 v[176:179], a[4:7], a[36:39], v[176:179]
    ds_read_b128 a[104:107], v226 offset:1152
    v_mfma_f32_16x16x32_bf16 v[176:179], a[8:11], a[32:35], v[176:179]
    ds_read_b64 a[72:73], v225 offset:1344
    s_waitcnt lgkmcnt(8)
    v_mfma_f32_16x16x32_bf16 v[180:183], a[0:3], a[44:47], v[180:183]
    ds_read_b64 a[74:75], v225 offset:1352
    v_mfma_f32_16x16x32_bf16 v[180:183], a[4:7], a[40:43], v[180:183]
    ds_read_b128 a[108:111], v226 offset:1664
    buffer_load_dwordx2 v[244:245], v250, s[88:91], s46 offen offset:128
    v_mfma_f32_16x16x32_bf16 v[180:183], a[8:11], a[36:39], v[180:183]
    ds_read_b64 a[76:77], v225 offset:1856
    v_mfma_f32_16x16x32_bf16 v[180:183], a[12:15], a[32:35], v[180:183]
    ds_read_b64 a[78:79], v225 offset:1864
    s_waitcnt lgkmcnt(9)
    v_mfma_f32_16x16x32_bf16 v[168:171], a[64:67], a[96:99], v[168:171]
    ds_read_b128 a[32:35], v226 offset:64
    ds_read_b64 a[0:1], v225 offset:384
    s_waitcnt lgkmcnt(8)
    v_mfma_f32_16x16x32_bf16 v[172:175], a[64:67], a[100:103], v[172:175]
    ds_read_b64 a[2:3], v225 offset:392
    ds_read_b128 a[36:39], v226 offset:576
    v_mfma_f32_16x16x32_bf16 v[172:175], a[68:71], a[96:99], v[172:175]
    ds_read_b64 a[4:5], v225 offset:896
    buffer_load_dwordx2 v[246:247], v250, s[88:91], s46 offen offset:160
    s_waitcnt lgkmcnt(8)
    v_mfma_f32_16x16x32_bf16 v[176:179], a[64:67], a[104:107], v[176:179]
    ds_read_b64 a[6:7], v225 offset:904
    v_mfma_f32_16x16x32_bf16 v[176:179], a[68:71], a[100:103], v[176:179]
    ds_read_b128 a[40:43], v226 offset:1088
    v_mfma_f32_16x16x32_bf16 v[176:179], a[72:75], a[96:99], v[176:179]
    ds_read_b64 a[8:9], v225 offset:1408
    s_waitcnt lgkmcnt(8)
    v_mfma_f32_16x16x32_bf16 v[180:183], a[64:67], a[108:111], v[180:183]
    ds_read_b64 a[10:11], v225 offset:1416
    v_mfma_f32_16x16x32_bf16 v[180:183], a[68:71], a[104:107], v[180:183]
    ds_read_b128 a[44:47], v226 offset:1600
    buffer_load_dword v248, v251, s[88:91], s46 offen offset:1024
    v_mfma_f32_16x16x32_bf16 v[180:183], a[72:75], a[100:103], v[180:183]
    ds_read_b64 a[12:13], v225 offset:1920
    s_add_u32 s46, s28, 0x1800000
    v_mfma_f32_16x16x32_bf16 v[180:183], a[76:79], a[96:99], v[180:183]
    ds_read_b64 a[14:15], v225 offset:1928
    s_waitcnt lgkmcnt(9)
    v_mfma_f32_16x16x32_bf16 v[168:171], a[0:3], a[32:35], v[168:171]
    ds_read_b64 v[32:33], v17 offset:480
    ds_read_b64 v[34:35], v17 offset:992
    s_waitcnt lgkmcnt(8)
    v_mfma_f32_16x16x32_bf16 v[172:175], a[0:3], a[36:39], v[172:175]
    ds_read_b64 v[36:37], v17 offset:1504
    ds_read_b64 v[38:39], v17 offset:2016
    v_mfma_f32_16x16x32_bf16 v[172:175], a[4:7], a[32:35], v[172:175]
    ds_read_b128 a[96:99], v226 offset:0
    ds_read_b64 a[64:65], v225 offset:448
    s_waitcnt lgkmcnt(9)
    v_mfma_f32_16x16x32_bf16 v[176:179], a[0:3], a[40:43], v[176:179]
    ds_read_b64 a[66:67], v225 offset:456
    ds_read_b128 a[100:103], v226 offset:512
    buffer_store_dwordx4 v[24:27], v217, s[8:11], s46 offen sc1
    v_mfma_f32_16x16x32_bf16 v[176:179], a[4:7], a[36:39], v[176:179]
    ds_read_b64 a[68:69], v225 offset:960
    v_mfma_f32_16x16x32_bf16 v[176:179], a[8:11], a[32:35], v[176:179]
    ds_read_b64 a[70:71], v225 offset:968
    s_waitcnt lgkmcnt(10)
    v_mfma_f32_16x16x32_bf16 v[180:183], a[0:3], a[44:47], v[180:183]
    ds_read_b128 a[104:107], v226 offset:1024
    v_mfma_f32_16x16x32_bf16 v[180:183], a[4:7], a[40:43], v[180:183]
    ds_read_b64 a[72:73], v225 offset:1472
    v_mfma_f32_16x16x32_bf16 v[180:183], a[8:11], a[36:39], v[180:183]
    ds_read_b64 a[74:75], v225 offset:1480
    buffer_store_dword v24, v218, s[8:11], s46 offen sc1
    v_mfma_f32_16x16x32_bf16 v[180:183], a[12:15], a[32:35], v[180:183]
    ds_read_b128 a[108:111], v226 offset:1536
    s_add_u32 s46, s46, 8192
    s_waitcnt lgkmcnt(7)
    v_mfma_f32_16x16x32_bf16 v[168:171], a[64:67], a[96:99], v[168:171]
    ds_read_b64 a[76:77], v225 offset:1984
    ds_read_b64 a[78:79], v225 offset:1992
    s_waitcnt lgkmcnt(6)
    v_mfma_f32_16x16x32_bf16 v[172:175], a[64:67], a[100:103], v[172:175]
    s_waitcnt vmcnt(8)
    ds_read_b128 a[48:51], v226 offset:2496
    ds_read_b64 a[0:1], v225 offset:0
    v_mfma_f32_16x16x32_bf16 v[172:175], a[68:71], a[96:99], v[172:175]
    ds_read_b64 a[2:3], v225 offset:8
    ds_read_b128 a[44:47], v226 offset:1984
    s_waitcnt lgkmcnt(7)
    v_mfma_f32_16x16x32_bf16 v[176:179], a[64:67], a[104:107], v[176:179]
    ds_read_b64 a[4:5], v225 offset:512
    ds_read_b64 a[6:7], v225 offset:520
    buffer_store_dwordx4 v[24:27], v217, s[8:11], s46 offen sc1
    v_mfma_f32_16x16x32_bf16 v[176:179], a[68:71], a[100:103], v[176:179]
    ds_read_b128 a[40:43], v226 offset:1472
    ds_read_b64 a[8:9], v225 offset:1024
    v_mfma_f32_16x16x32_bf16 v[176:179], a[72:75], a[96:99], v[176:179]
    ds_read_b64 a[10:11], v225 offset:1032
    ds_read_b128 a[36:39], v226 offset:960
    s_waitcnt lgkmcnt(10)
    v_mfma_f32_16x16x32_bf16 v[180:183], a[64:67], a[108:111], v[180:183]
    ds_read_b64 a[12:13], v225 offset:1536
    ds_read_b64 a[14:15], v225 offset:1544
    v_mfma_f32_16x16x32_bf16 v[180:183], a[68:71], a[104:107], v[180:183]
    ds_read_b128 a[32:35], v226 offset:448
    ds_read_b64 a[16:17], v225 offset:2048
    v_mfma_f32_16x16x32_bf16 v[180:183], a[72:75], a[100:103], v[180:183]
    s_waitcnt lgkmcnt(8)
    ds_read_b64 a[18:19], v225 offset:2056
    ds_read_b128 a[52:55], v226 offset:3008
    v_mfma_f32_16x16x32_bf16 v[180:183], a[76:79], a[96:99], v[180:183]
    ds_read_b64 a[20:21], v225 offset:2560
    s_waitcnt lgkmcnt(2)
    v_mfma_f32_16x16x32_bf16 v[184:187], a[0:3], a[48:51], 0
    ds_read_b64 a[22:23], v225 offset:2568
    v_mfma_f32_16x16x32_bf16 v[184:187], a[4:7], a[44:47], v[184:187]
    s_waitcnt vmcnt(8)
    ds_read_b128 a[56:59], v226 offset:3520
    v_mfma_f32_16x16x32_bf16 v[184:187], a[8:11], a[40:43], v[184:187]
    ds_read_b64 a[24:25], v225 offset:3072
    v_mfma_f32_16x16x32_bf16 v[184:187], a[12:15], a[36:39], v[184:187]
    ds_read_b64 a[26:27], v225 offset:3080
    v_mfma_f32_16x16x32_bf16 v[184:187], a[16:19], a[32:35], v[184:187]
    ds_read_b128 a[60:63], v226 offset:4032
    v_and_b32 v20, 0xffff0000, v33
    s_waitcnt lgkmcnt(4)
    v_mfma_f32_16x16x32_bf16 v[188:191], a[0:3], a[52:55], 0
    ds_read_b64 a[28:29], v225 offset:3584
    v_lshlrev_b32 v21, 16, v33
    v_mfma_f32_16x16x32_bf16 v[188:191], a[4:7], a[48:51], v[188:191]
    ds_read_b64 a[30:31], v225 offset:3592
    v_and_b32 v22, 0xffff0000, v32
    v_mfma_f32_16x16x32_bf16 v[188:191], a[8:11], a[44:47], v[188:191]
    ds_read_b128 a[112:115], v226 offset:2432
    v_lshlrev_b32 v23, 16, v32
    v_mfma_f32_16x16x32_bf16 v[188:191], a[12:15], a[40:43], v[188:191]
    ds_read_b64 a[64:65], v225 offset:64
    v_fmac_f32 v168, v20, v208
    v_mfma_f32_16x16x32_bf16 v[188:191], a[16:19], a[36:39], v[188:191]
    ds_read_b64 a[66:67], v225 offset:72
    v_fmac_f32 v169, v21, v208
    v_mfma_f32_16x16x32_bf16 v[188:191], a[20:23], a[32:35], v[188:191]
    ds_read_b128 a[108:111], v226 offset:1920
    v_fmac_f32 v170, v22, v208
    s_waitcnt lgkmcnt(7)
    v_mfma_f32_16x16x32_bf16 v[192:195], a[0:3], a[56:59], 0
    ds_read_b64 a[68:69], v225 offset:576
    v_fmac_f32 v171, v23, v208
    v_mfma_f32_16x16x32_bf16 v[192:195], a[4:7], a[52:55], v[192:195]
    ds_read_b64 a[70:71], v225 offset:584
    v_cvt_pk_bf16_f32 v168, v168, v169
    v_mfma_f32_16x16x32_bf16 v[192:195], a[8:11], a[48:51], v[192:195]
    ds_read_b128 a[104:107], v226 offset:1408
    v_cvt_pk_bf16_f32 v169, v170, v171
    v_mfma_f32_16x16x32_bf16 v[192:195], a[12:15], a[44:47], v[192:195]
    ds_read_b64 a[72:73], v225 offset:1088
    v_and_b32 v20, 0xffff0000, v35
    v_mfma_f32_16x16x32_bf16 v[192:195], a[16:19], a[40:43], v[192:195]
    ds_read_b64 a[74:75], v225 offset:1096
    v_lshlrev_b32 v21, 16, v35
    v_mfma_f32_16x16x32_bf16 v[192:195], a[20:23], a[36:39], v[192:195]
    ds_read_b128 a[100:103], v226 offset:896
    v_and_b32 v22, 0xffff0000, v34
    v_mfma_f32_16x16x32_bf16 v[192:195], a[24:27], a[32:35], v[192:195]
PAD_0:
    s_cbranch_execz PAD_3
    ds_read_b64 a[76:77], v225 offset:1600
    v_lshlrev_b32 v23, 16, v34
    s_waitcnt lgkmcnt(11)
    v_mfma_f32_16x16x32_bf16 v[196:199], a[0:3], a[60:63], 0
    ds_read_b64 a[78:79], v225 offset:1608
    v_fmac_f32 v172, v20, v208
    v_mfma_f32_16x16x32_bf16 v[196:199], a[4:7], a[56:59], v[196:199]
    ds_read_b128 a[96:99], v226 offset:384
    v_fmac_f32 v173, v21, v208
    v_mfma_f32_16x16x32_bf16 v[196:199], a[8:11], a[52:55], v[196:199]
    ds_read_b64 a[80:81], v225 offset:2112
    v_fmac_f32 v174, v22, v208
    v_mfma_f32_16x16x32_bf16 v[196:199], a[12:15], a[48:51], v[196:199]
    s_waitcnt lgkmcnt(8)
    ds_read_b64 a[82:83], v225 offset:2120
    v_fmac_f32 v175, v23, v208
    v_mfma_f32_16x16x32_bf16 v[196:199], a[16:19], a[44:47], v[196:199]
    ds_read_b128 a[116:119], v226 offset:2944
    v_cvt_pk_bf16_f32 v172, v172, v173
    v_mfma_f32_16x16x32_bf16 v[196:199], a[20:23], a[40:43], v[196:199]
    ds_read_b64 a[84:85], v225 offset:2624
    v_cvt_pk_bf16_f32 v173, v174, v175
    v_mfma_f32_16x16x32_bf16 v[196:199], a[24:27], a[36:39], v[196:199]
    ds_read_b64 a[86:87], v225 offset:2632
    v_and_b32 v20, 0xffff0000, v37
    v_mfma_f32_16x16x32_bf16 v[196:199], a[28:31], a[32:35], v[196:199]
    ds_read_b128 a[120:123], v226 offset:3456
    v_lshlrev_b32 v21, 16, v37
    s_waitcnt lgkmcnt(4)
    v_mfma_f32_16x16x32_bf16 v[184:187], a[64:67], a[112:115], v[184:187]
    ds_read_b64 a[88:89], v225 offset:3136
    v_and_b32 v22, 0xffff0000, v36
    v_mfma_f32_16x16x32_bf16 v[184:187], a[68:71], a[108:111], v[184:187]
    ds_read_b64 a[90:91], v225 offset:3144
    v_lshlrev_b32 v23, 16, v36
    v_mfma_f32_16x16x32_bf16 v[184:187], a[72:75], a[104:107], v[184:187]
    ds_read_b128 a[124:127], v226 offset:3968
    v_fmac_f32 v176, v20, v208
    v_mfma_f32_16x16x32_bf16 v[184:187], a[76:79], a[100:103], v[184:187]
    ds_read_b64 a[92:93], v225 offset:3648
    v_fmac_f32 v177, v21, v208
    v_mfma_f32_16x16x32_bf16 v[184:187], a[80:83], a[96:99], v[184:187]
    ds_read_b64 a[94:95], v225 offset:3656
    v_fmac_f32 v178, v22, v208
    s_waitcnt lgkmcnt(6)
    v_mfma_f32_16x16x32_bf16 v[188:191], a[64:67], a[116:119], v[188:191]
    ds_read_b128 a[48:51], v226 offset:2368
    v_fmac_f32 v179, v23, v208
    v_mfma_f32_16x16x32_bf16 v[188:191], a[68:71], a[112:115], v[188:191]
    ds_read_b64 a[0:1], v225 offset:128
    v_cvt_pk_bf16_f32 v176, v176, v177
    v_mfma_f32_16x16x32_bf16 v[188:191], a[72:75], a[108:111], v[188:191]
    ds_read_b64 a[2:3], v225 offset:136
    v_cvt_pk_bf16_f32 v177, v178, v179
    v_mfma_f32_16x16x32_bf16 v[188:191], a[76:79], a[104:107], v[188:191]
    ds_read_b128 a[44:47], v226 offset:1856
    v_and_b32 v20, 0xffff0000, v39
    v_mfma_f32_16x16x32_bf16 v[188:191], a[80:83], a[100:103], v[188:191]
    ds_read_b64 a[4:5], v225 offset:640
    v_lshlrev_b32 v21, 16, v39
    v_mfma_f32_16x16x32_bf16 v[188:191], a[84:87], a[96:99], v[188:191]
    ds_read_b64 a[6:7], v225 offset:648
    v_and_b32 v22, 0xffff0000, v38
    s_waitcnt lgkmcnt(9)
    v_mfma_f32_16x16x32_bf16 v[192:195], a[64:67], a[120:123], v[192:195]
    ds_read_b128 a[40:43], v226 offset:1344
    v_lshlrev_b32 v23, 16, v38
    v_mfma_f32_16x16x32_bf16 v[192:195], a[68:71], a[116:119], v[192:195]
    ds_read_b64 a[8:9], v225 offset:1152
    v_fmac_f32 v180, v20, v208
    v_mfma_f32_16x16x32_bf16 v[192:195], a[72:75], a[112:115], v[192:195]
    ds_read_b64 a[10:11], v225 offset:1160
    v_fmac_f32 v181, v21, v208
    v_mfma_f32_16x16x32_bf16 v[192:195], a[76:79], a[108:111], v[192:195]
    ds_read_b128 a[36:39], v226 offset:832
    v_fmac_f32 v182, v22, v208
    v_mfma_f32_16x16x32_bf16 v[192:195], a[80:83], a[104:107], v[192:195]
    ds_read_b64 a[12:13], v225 offset:1664
    v_fmac_f32 v183, v23, v208
    v_mfma_f32_16x16x32_bf16 v[192:195], a[84:87], a[100:103], v[192:195]
    s_waitcnt lgkmcnt(8)
    ds_read_b64 a[14:15], v225 offset:1672
    v_cvt_pk_bf16_f32 v180, v180, v181
    v_mfma_f32_16x16x32_bf16 v[192:195], a[88:91], a[96:99], v[192:195]
    ds_read_b128 a[32:35], v226 offset:320
    v_cvt_pk_bf16_f32 v181, v182, v183
    v_mfma_f32_16x16x32_bf16 v[196:199], a[64:67], a[124:127], v[196:199]
    ds_read_b64 a[16:17], v225 offset:2176
    ds_write_b64 v18, v[168:169] offset:20480
    v_mfma_f32_16x16x32_bf16 v[196:199], a[68:71], a[120:123], v[196:199]
    ds_read_b64 a[18:19], v225 offset:2184
    ds_write_b64 v18, v[172:173] offset:20992
    v_mfma_f32_16x16x32_bf16 v[196:199], a[72:75], a[116:119], v[196:199]
    s_waitcnt lgkmcnt(8)
    ds_read_b128 a[52:55], v226 offset:2880
    ds_write_b64 v18, v[176:177] offset:21504
    v_mfma_f32_16x16x32_bf16 v[196:199], a[76:79], a[112:115], v[196:199]
    ds_read_b64 a[20:21], v225 offset:2688
    ds_write_b64 v18, v[180:181] offset:22016
    v_mfma_f32_16x16x32_bf16 v[196:199], a[80:83], a[108:111], v[196:199]
    ds_read_b64 a[22:23], v225 offset:2696
    v_mfma_f32_16x16x32_bf16 v[196:199], a[84:87], a[104:107], v[196:199]
    ds_read_b128 a[56:59], v226 offset:3392
    v_mfma_f32_16x16x32_bf16 v[196:199], a[88:91], a[100:103], v[196:199]
    s_waitcnt lgkmcnt(8)
    ds_read_b64 a[24:25], v225 offset:3200
    v_mfma_f32_16x16x32_bf16 v[196:199], a[92:95], a[96:99], v[196:199]
    ds_read_b64 a[26:27], v225 offset:3208
    s_waitcnt lgkmcnt(9)
    v_mfma_f32_16x16x32_bf16 v[184:187], a[0:3], a[48:51], v[184:187]
    ds_read_b128 a[60:63], v226 offset:3904
    v_mfma_f32_16x16x32_bf16 v[184:187], a[4:7], a[44:47], v[184:187]
    ds_read_b64 a[28:29], v225 offset:3712
    v_mfma_f32_16x16x32_bf16 v[184:187], a[8:11], a[40:43], v[184:187]
    ds_read_b64 a[30:31], v225 offset:3720
    v_mfma_f32_16x16x32_bf16 v[184:187], a[12:15], a[36:39], v[184:187]
    ds_read_b128 a[112:115], v226 offset:2304
    v_mfma_f32_16x16x32_bf16 v[184:187], a[16:19], a[32:35], v[184:187]
    ds_read_b64 a[64:65], v225 offset:192
    s_waitcnt lgkmcnt(8)
    v_mfma_f32_16x16x32_bf16 v[188:191], a[0:3], a[52:55], v[188:191]
    ds_read_b64 a[66:67], v225 offset:200
    s_barrier
    v_mfma_f32_16x16x32_bf16 v[188:191], a[4:7], a[48:51], v[188:191]
    ds_read_b128 a[108:111], v226 offset:1792
    ds_read_b32 v72, v24 offset:20480
    v_mfma_f32_16x16x32_bf16 v[188:191], a[8:11], a[44:47], v[188:191]
    ds_read_b64 a[68:69], v225 offset:704
    ds_read_b32 v73, v24 offset:53632
    v_mfma_f32_16x16x32_bf16 v[188:191], a[12:15], a[40:43], v[188:191]
    ds_read_b64 a[70:71], v225 offset:712
    s_waitcnt lgkmcnt(8)
    ds_read_b32 v74, v26 offset:20480
    v_mfma_f32_16x16x32_bf16 v[188:191], a[16:19], a[36:39], v[188:191]
    ds_read_b128 a[104:107], v226 offset:1280
    ds_read_b32 v75, v26 offset:53632
    v_mfma_f32_16x16x32_bf16 v[188:191], a[20:23], a[32:35], v[188:191]
    ds_read_b64 a[72:73], v225 offset:1216
    ds_read_b32 v76, v24 offset:21504
    v_mfma_f32_16x16x32_bf16 v[192:195], a[0:3], a[56:59], v[192:195]
    ds_read_b64 a[74:75], v225 offset:1224
    s_waitcnt lgkmcnt(8)
    ds_read_b32 v77, v24 offset:54656
    v_mfma_f32_16x16x32_bf16 v[192:195], a[4:7], a[52:55], v[192:195]
    ds_read_b128 a[100:103], v226 offset:768
    ds_read_b32 v78, v26 offset:21504
    v_mfma_f32_16x16x32_bf16 v[192:195], a[8:11], a[48:51], v[192:195]
    ds_read_b64 a[76:77], v225 offset:1728
    ds_read_b32 v79, v26 offset:54656
    v_mfma_f32_16x16x32_bf16 v[192:195], a[12:15], a[44:47], v[192:195]
    ds_read_b64 a[78:79], v225 offset:1736
    v_mfma_f32_16x16x32_bf16 v[192:195], a[16:19], a[40:43], v[192:195]
    s_waitcnt lgkmcnt(8)
    ds_read_b128 a[96:99], v226 offset:256
    v_mfma_f32_16x16x32_bf16 v[192:195], a[20:23], a[36:39], v[192:195]
    ds_read_b64 a[80:81], v225 offset:2240
    v_mfma_f32_16x16x32_bf16 v[192:195], a[24:27], a[32:35], v[192:195]
    ds_read_b64 a[82:83], v225 offset:2248
    v_mfma_f32_16x16x32_bf16 v[196:199], a[0:3], a[60:63], v[196:199]
    ds_read_b128 a[116:119], v226 offset:2816
    v_mfma_f32_16x16x32_bf16 v[196:199], a[4:7], a[56:59], v[196:199]
    ds_read_b64 a[84:85], v225 offset:2752
    v_mfma_f32_16x16x32_bf16 v[196:199], a[8:11], a[52:55], v[196:199]
    ds_read_b64 a[86:87], v225 offset:2760
    v_mfma_f32_16x16x32_bf16 v[196:199], a[12:15], a[48:51], v[196:199]
    s_waitcnt lgkmcnt(8)
    ds_read_b128 a[120:123], v226 offset:3328
    v_perm_b32 v88, v73, v72, s48
    v_mfma_f32_16x16x32_bf16 v[196:199], a[16:19], a[44:47], v[196:199]
    ds_read_b64 a[88:89], v225 offset:3264
    v_perm_b32 v89, v75, v74, s48
    v_mfma_f32_16x16x32_bf16 v[196:199], a[20:23], a[40:43], v[196:199]
    ds_read_b64 a[90:91], v225 offset:3272
    v_perm_b32 v90, v73, v72, s49
    v_mfma_f32_16x16x32_bf16 v[196:199], a[24:27], a[36:39], v[196:199]
    ds_read_b128 a[124:127], v226 offset:3840
    v_perm_b32 v91, v75, v74, s49
    v_mfma_f32_16x16x32_bf16 v[196:199], a[28:31], a[32:35], v[196:199]
    ds_read_b64 a[92:93], v225 offset:3776
    buffer_store_dwordx4 v[88:91], v25, s[8:11], s47 offen sc1
    s_waitcnt lgkmcnt(8)
    v_mfma_f32_16x16x32_bf16 v[184:187], a[64:67], a[112:115], v[184:187]
    ds_read_b64 a[94:95], v225 offset:3784
    s_add_u32 s47, s47, 589824
    v_mfma_f32_16x16x32_bf16 v[184:187], a[68:71], a[108:111], v[184:187]
    ds_read_b128 a[48:51], v226 offset:2240
    v_perm_b32 v92, v77, v76, s48
    v_mfma_f32_16x16x32_bf16 v[184:187], a[72:75], a[104:107], v[184:187]
    ds_read_b64 a[0:1], v225 offset:256
    v_perm_b32 v93, v79, v78, s48
    v_mfma_f32_16x16x32_bf16 v[184:187], a[76:79], a[100:103], v[184:187]
    ds_read_b64 a[2:3], v225 offset:264
    v_perm_b32 v94, v77, v76, s49
    v_mfma_f32_16x16x32_bf16 v[184:187], a[80:83], a[96:99], v[184:187]
    ds_read_b128 a[44:47], v226 offset:1728
    v_perm_b32 v95, v79, v78, s49
    s_waitcnt lgkmcnt(10)
    v_mfma_f32_16x16x32_bf16 v[188:191], a[64:67], a[116:119], v[188:191]
    ds_read_b64 a[4:5], v225 offset:768
    buffer_store_dwordx4 v[92:95], v25, s[8:11], s47 offen sc1
    v_mfma_f32_16x16x32_bf16 v[188:191], a[68:71], a[112:115], v[188:191]
    ds_read_b64 a[6:7], v225 offset:776
    s_add_u32 s47, s47, 589824
    v_mfma_f32_16x16x32_bf16 v[188:191], a[72:75], a[108:111], v[188:191]
    ds_read_b128 a[40:43], v226 offset:1216
    v_mfma_f32_16x16x32_bf16 v[188:191], a[76:79], a[104:107], v[188:191]
    ds_read_b64 a[8:9], v225 offset:1280
    v_mfma_f32_16x16x32_bf16 v[188:191], a[80:83], a[100:103], v[188:191]
    s_waitcnt lgkmcnt(8)
    ds_read_b64 a[10:11], v225 offset:1288
    v_mfma_f32_16x16x32_bf16 v[188:191], a[84:87], a[96:99], v[188:191]
    ds_read_b128 a[36:39], v226 offset:704
    v_mfma_f32_16x16x32_bf16 v[192:195], a[64:67], a[120:123], v[192:195]
    ds_read_b64 a[12:13], v225 offset:1792
    v_mfma_f32_16x16x32_bf16 v[192:195], a[68:71], a[116:119], v[192:195]
    ds_read_b64 a[14:15], v225 offset:1800
    v_mfma_f32_16x16x32_bf16 v[192:195], a[72:75], a[112:115], v[192:195]
    ds_read_b128 a[32:35], v226 offset:192
    v_mfma_f32_16x16x32_bf16 v[192:195], a[76:79], a[108:111], v[192:195]
    ds_read_b64 a[16:17], v225 offset:2304
    v_mfma_f32_16x16x32_bf16 v[192:195], a[80:83], a[104:107], v[192:195]
    s_waitcnt lgkmcnt(8)
    ds_read_b64 a[18:19], v225 offset:2312
    v_mfma_f32_16x16x32_bf16 v[192:195], a[84:87], a[100:103], v[192:195]
    ds_read_b128 a[52:55], v226 offset:2752
    v_mfma_f32_16x16x32_bf16 v[192:195], a[88:91], a[96:99], v[192:195]
    ds_read_b64 a[20:21], v225 offset:2816
    v_mfma_f32_16x16x32_bf16 v[196:199], a[64:67], a[124:127], v[196:199]
    ds_read_b64 a[22:23], v225 offset:2824
    v_mfma_f32_16x16x32_bf16 v[196:199], a[68:71], a[120:123], v[196:199]
    ds_read_b128 a[56:59], v226 offset:3264
    v_mfma_f32_16x16x32_bf16 v[196:199], a[72:75], a[116:119], v[196:199]
    ds_read_b64 a[24:25], v225 offset:3328
    v_mfma_f32_16x16x32_bf16 v[196:199], a[76:79], a[112:115], v[196:199]
    s_waitcnt lgkmcnt(8)
    ds_read_b64 a[26:27], v225 offset:3336
    v_mfma_f32_16x16x32_bf16 v[196:199], a[80:83], a[108:111], v[196:199]
    ds_read_b128 a[60:63], v226 offset:3776
    v_mfma_f32_16x16x32_bf16 v[196:199], a[84:87], a[104:107], v[196:199]
    ds_read_b64 a[28:29], v225 offset:3840
    v_mfma_f32_16x16x32_bf16 v[196:199], a[88:91], a[100:103], v[196:199]
    ds_read_b64 a[30:31], v225 offset:3848
    v_mfma_f32_16x16x32_bf16 v[196:199], a[92:95], a[96:99], v[196:199]
    s_waitcnt lgkmcnt(9)
    v_mfma_f32_16x16x32_bf16 v[184:187], a[0:3], a[48:51], v[184:187]
    ds_read_b128 a[112:115], v226 offset:2176
    v_mfma_f32_16x16x32_bf16 v[184:187], a[4:7], a[44:47], v[184:187]
    ds_read_b64 a[64:65], v225 offset:320
    v_mfma_f32_16x16x32_bf16 v[184:187], a[8:11], a[40:43], v[184:187]
    ds_read_b64 a[66:67], v225 offset:328
    v_mfma_f32_16x16x32_bf16 v[184:187], a[12:15], a[36:39], v[184:187]
    ds_read_b128 a[108:111], v226 offset:1664
    v_mfma_f32_16x16x32_bf16 v[184:187], a[16:19], a[32:35], v[184:187]
    ds_read_b64 a[68:69], v225 offset:832
    s_waitcnt lgkmcnt(11)
    v_mfma_f32_16x16x32_bf16 v[188:191], a[0:3], a[52:55], v[188:191]
    ds_read_b64 a[70:71], v225 offset:840
    v_mfma_f32_16x16x32_bf16 v[188:191], a[4:7], a[48:51], v[188:191]
    ds_read_b128 a[104:107], v226 offset:1152
    v_mfma_f32_16x16x32_bf16 v[188:191], a[8:11], a[44:47], v[188:191]
    ds_read_b64 a[72:73], v225 offset:1344
    v_mfma_f32_16x16x32_bf16 v[188:191], a[12:15], a[40:43], v[188:191]
    s_waitcnt lgkmcnt(8)
    ds_read_b64 a[74:75], v225 offset:1352
    v_mfma_f32_16x16x32_bf16 v[188:191], a[16:19], a[36:39], v[188:191]
    ds_read_b128 a[100:103], v226 offset:640
    v_mfma_f32_16x16x32_bf16 v[188:191], a[20:23], a[32:35], v[188:191]
    ds_read_b64 a[76:77], v225 offset:1856
    v_mfma_f32_16x16x32_bf16 v[192:195], a[0:3], a[56:59], v[192:195]
    ds_read_b64 a[78:79], v225 offset:1864
    v_mfma_f32_16x16x32_bf16 v[192:195], a[4:7], a[52:55], v[192:195]
    ds_read_b128 a[96:99], v226 offset:128
    v_mfma_f32_16x16x32_bf16 v[192:195], a[8:11], a[48:51], v[192:195]
    ds_read_b64 a[80:81], v225 offset:2368
    v_mfma_f32_16x16x32_bf16 v[192:195], a[12:15], a[44:47], v[192:195]
    s_waitcnt lgkmcnt(8)
    ds_read_b64 a[82:83], v225 offset:2376
    v_mfma_f32_16x16x32_bf16 v[192:195], a[16:19], a[40:43], v[192:195]
    ds_read_b128 a[116:119], v226 offset:2688
    v_mfma_f32_16x16x32_bf16 v[192:195], a[20:23], a[36:39], v[192:195]
    ds_read_b64 a[84:85], v225 offset:2880
    v_mfma_f32_16x16x32_bf16 v[192:195], a[24:27], a[32:35], v[192:195]
    ds_read_b64 a[86:87], v225 offset:2888
    v_mfma_f32_16x16x32_bf16 v[196:199], a[0:3], a[60:63], v[196:199]
    ds_read_b128 a[120:123], v226 offset:3200
    v_mfma_f32_16x16x32_bf16 v[196:199], a[4:7], a[56:59], v[196:199]
    ds_read_b64 a[88:89], v225 offset:3392
    v_mfma_f32_16x16x32_bf16 v[196:199], a[8:11], a[52:55], v[196:199]
    s_waitcnt lgkmcnt(8)
    ds_read_b64 a[90:91], v225 offset:3400
    v_mfma_f32_16x16x32_bf16 v[196:199], a[12:15], a[48:51], v[196:199]
    ds_read_b128 a[124:127], v226 offset:3712
    v_mfma_f32_16x16x32_bf16 v[196:199], a[16:19], a[44:47], v[196:199]
    ds_read_b64 a[92:93], v225 offset:3904
    v_mfma_f32_16x16x32_bf16 v[196:199], a[20:23], a[40:43], v[196:199]
    ds_read_b64 a[94:95], v225 offset:3912
    v_mfma_f32_16x16x32_bf16 v[196:199], a[24:27], a[36:39], v[196:199]
    v_mfma_f32_16x16x32_bf16 v[196:199], a[28:31], a[32:35], v[196:199]
    s_waitcnt lgkmcnt(9)
    v_mfma_f32_16x16x32_bf16 v[184:187], a[64:67], a[112:115], v[184:187]
    ds_read_b128 a[48:51], v226 offset:2112
    v_mfma_f32_16x16x32_bf16 v[184:187], a[68:71], a[108:111], v[184:187]
    ds_read_b64 a[0:1], v225 offset:384
    v_mfma_f32_16x16x32_bf16 v[184:187], a[72:75], a[104:107], v[184:187]
    ds_read_b64 a[2:3], v225 offset:392
    v_mfma_f32_16x16x32_bf16 v[184:187], a[76:79], a[100:103], v[184:187]
    ds_read_b128 a[44:47], v226 offset:1600
    v_mfma_f32_16x16x32_bf16 v[184:187], a[80:83], a[96:99], v[184:187]
    ds_read_b64 a[4:5], v225 offset:896
    s_waitcnt lgkmcnt(11)
    v_mfma_f32_16x16x32_bf16 v[188:191], a[64:67], a[116:119], v[188:191]
    ds_read_b64 a[6:7], v225 offset:904
    v_mfma_f32_16x16x32_bf16 v[188:191], a[68:71], a[112:115], v[188:191]
    ds_read_b128 a[40:43], v226 offset:1088
    v_mfma_f32_16x16x32_bf16 v[188:191], a[72:75], a[108:111], v[188:191]
    ds_read_b64 a[8:9], v225 offset:1408
    v_mfma_f32_16x16x32_bf16 v[188:191], a[76:79], a[104:107], v[188:191]
    s_waitcnt lgkmcnt(8)
    ds_read_b64 a[10:11], v225 offset:1416
    v_mfma_f32_16x16x32_bf16 v[188:191], a[80:83], a[100:103], v[188:191]
    ds_read_b128 a[36:39], v226 offset:576
    v_mfma_f32_16x16x32_bf16 v[188:191], a[84:87], a[96:99], v[188:191]
    ds_read_b64 a[12:13], v225 offset:1920
    v_mfma_f32_16x16x32_bf16 v[192:195], a[64:67], a[120:123], v[192:195]
    ds_read_b64 a[14:15], v225 offset:1928
    v_mfma_f32_16x16x32_bf16 v[192:195], a[68:71], a[116:119], v[192:195]
    ds_read_b128 a[32:35], v226 offset:64
    v_mfma_f32_16x16x32_bf16 v[192:195], a[72:75], a[112:115], v[192:195]
    ds_read_b64 a[16:17], v225 offset:2432
    v_mfma_f32_16x16x32_bf16 v[192:195], a[76:79], a[108:111], v[192:195]
    s_waitcnt lgkmcnt(8)
    ds_read_b64 a[18:19], v225 offset:2440
    s_waitcnt vmcnt(0)
    s_barrier
    buffer_store_dword v27, off, s[8:11], s50 sc1
    v_mfma_f32_16x16x32_bf16 v[192:195], a[80:83], a[104:107], v[192:195]
    ds_read_b128 a[52:55], v226 offset:2624
    v_mfma_f32_16x16x32_bf16 v[192:195], a[84:87], a[100:103], v[192:195]
    ds_read_b64 a[20:21], v225 offset:2944
    v_mfma_f32_16x16x32_bf16 v[192:195], a[88:91], a[96:99], v[192:195]
    ds_read_b64 a[22:23], v225 offset:2952
    v_mfma_f32_16x16x32_bf16 v[196:199], a[64:67], a[124:127], v[196:199]
    ds_read_b128 a[56:59], v226 offset:3136
    v_mfma_f32_16x16x32_bf16 v[196:199], a[68:71], a[120:123], v[196:199]
    ds_read_b64 a[24:25], v225 offset:3456
    v_mfma_f32_16x16x32_bf16 v[196:199], a[72:75], a[116:119], v[196:199]
    s_waitcnt lgkmcnt(8)
    ds_read_b64 a[26:27], v225 offset:3464
    v_mfma_f32_16x16x32_bf16 v[196:199], a[76:79], a[112:115], v[196:199]
    ds_read_b128 a[60:63], v226 offset:3648
    v_mfma_f32_16x16x32_bf16 v[196:199], a[80:83], a[108:111], v[196:199]
    ds_read_b64 a[28:29], v225 offset:3968
    v_mfma_f32_16x16x32_bf16 v[196:199], a[84:87], a[104:107], v[196:199]
    ds_read_b64 a[30:31], v225 offset:3976
    v_mfma_f32_16x16x32_bf16 v[196:199], a[88:91], a[100:103], v[196:199]
    v_mfma_f32_16x16x32_bf16 v[196:199], a[92:95], a[96:99], v[196:199]
    s_waitcnt lgkmcnt(9)
    v_mfma_f32_16x16x32_bf16 v[184:187], a[0:3], a[48:51], v[184:187]
    ds_read_b64 v[40:41], v17 offset:2528
    v_mfma_f32_16x16x32_bf16 v[184:187], a[4:7], a[44:47], v[184:187]
    ds_read_b64 v[42:43], v17 offset:3040
    v_mfma_f32_16x16x32_bf16 v[184:187], a[8:11], a[40:43], v[184:187]
    ds_read_b64 v[44:45], v17 offset:3552
    v_mfma_f32_16x16x32_bf16 v[184:187], a[12:15], a[36:39], v[184:187]
    ds_read_b64 v[46:47], v17 offset:4064
    v_mfma_f32_16x16x32_bf16 v[184:187], a[16:19], a[32:35], v[184:187]
    ds_read_b128 a[112:115], v226 offset:2048
    s_waitcnt lgkmcnt(11)
    v_mfma_f32_16x16x32_bf16 v[188:191], a[0:3], a[52:55], v[188:191]
    ds_read_b64 a[64:65], v225 offset:448
    v_mfma_f32_16x16x32_bf16 v[188:191], a[4:7], a[48:51], v[188:191]
    ds_read_b64 a[66:67], v225 offset:456
    v_mfma_f32_16x16x32_bf16 v[188:191], a[8:11], a[44:47], v[188:191]
    ds_read_b128 a[108:111], v226 offset:1536
    v_mfma_f32_16x16x32_bf16 v[188:191], a[12:15], a[40:43], v[188:191]
    s_waitcnt lgkmcnt(8)
    ds_read_b64 a[68:69], v225 offset:960
    v_mfma_f32_16x16x32_bf16 v[188:191], a[16:19], a[36:39], v[188:191]
    ds_read_b64 a[70:71], v225 offset:968
    v_mfma_f32_16x16x32_bf16 v[188:191], a[20:23], a[32:35], v[188:191]
    ds_read_b128 a[104:107], v226 offset:1024
    v_mfma_f32_16x16x32_bf16 v[192:195], a[0:3], a[56:59], v[192:195]
    ds_read_b64 a[72:73], v225 offset:1472
    v_mfma_f32_16x16x32_bf16 v[192:195], a[4:7], a[52:55], v[192:195]
    ds_read_b64 a[74:75], v225 offset:1480
    v_mfma_f32_16x16x32_bf16 v[192:195], a[8:11], a[48:51], v[192:195]
    ds_read_b128 a[100:103], v226 offset:512
    v_mfma_f32_16x16x32_bf16 v[192:195], a[12:15], a[44:47], v[192:195]
    s_waitcnt lgkmcnt(8)
    ds_read_b64 a[76:77], v225 offset:1984
    v_mfma_f32_16x16x32_bf16 v[192:195], a[16:19], a[40:43], v[192:195]
    ds_read_b64 a[78:79], v225 offset:1992
    v_mfma_f32_16x16x32_bf16 v[192:195], a[20:23], a[36:39], v[192:195]
    ds_read_b128 a[96:99], v226 offset:0
    v_mfma_f32_16x16x32_bf16 v[192:195], a[24:27], a[32:35], v[192:195]
    ds_read_b64 a[80:81], v225 offset:2496
    v_mfma_f32_16x16x32_bf16 v[196:199], a[0:3], a[60:63], v[196:199]
    ds_read_b64 a[82:83], v225 offset:2504
    v_mfma_f32_16x16x32_bf16 v[196:199], a[4:7], a[56:59], v[196:199]
    ds_read_b128 a[116:119], v226 offset:2560
    v_mfma_f32_16x16x32_bf16 v[196:199], a[8:11], a[52:55], v[196:199]
    s_waitcnt lgkmcnt(8)
    ds_read_b64 a[84:85], v225 offset:3008
    v_mfma_f32_16x16x32_bf16 v[196:199], a[12:15], a[48:51], v[196:199]
    ds_read_b64 a[86:87], v225 offset:3016
    v_mfma_f32_16x16x32_bf16 v[196:199], a[16:19], a[44:47], v[196:199]
    ds_read_b128 a[120:123], v226 offset:3072
    v_mfma_f32_16x16x32_bf16 v[196:199], a[20:23], a[40:43], v[196:199]
    ds_read_b64 a[88:89], v225 offset:3520
    v_mfma_f32_16x16x32_bf16 v[196:199], a[24:27], a[36:39], v[196:199]
    ds_read_b64 a[90:91], v225 offset:3528
    v_mfma_f32_16x16x32_bf16 v[196:199], a[28:31], a[32:35], v[196:199]
    ds_read_b128 a[124:127], v226 offset:3584
    s_waitcnt lgkmcnt(7)
    v_mfma_f32_16x16x32_bf16 v[184:187], a[64:67], a[112:115], v[184:187]
    ds_read_b64 a[92:93], v225 offset:4032
    v_mfma_f32_16x16x32_bf16 v[184:187], a[68:71], a[108:111], v[184:187]
    ds_read_b64 a[94:95], v225 offset:4040
    v_mfma_f32_16x16x32_bf16 v[184:187], a[72:75], a[104:107], v[184:187]
    v_mfma_f32_16x16x32_bf16 v[184:187], a[76:79], a[100:103], v[184:187]
    v_mfma_f32_16x16x32_bf16 v[184:187], a[80:83], a[96:99], v[184:187]
    s_waitcnt lgkmcnt(6)
    v_mfma_f32_16x16x32_bf16 v[188:191], a[64:67], a[116:119], v[188:191]
    v_mfma_f32_16x16x32_bf16 v[188:191], a[68:71], a[112:115], v[188:191]
    v_mfma_f32_16x16x32_bf16 v[188:191], a[72:75], a[108:111], v[188:191]
    v_mfma_f32_16x16x32_bf16 v[188:191], a[76:79], a[104:107], v[188:191]
    v_and_b32 v20, 0xffff0000, v41
    v_lshlrev_b32 v21, 16, v41
    v_mfma_f32_16x16x32_bf16 v[188:191], a[80:83], a[100:103], v[188:191]
    v_and_b32 v22, 0xffff0000, v40
    v_lshlrev_b32 v23, 16, v40
    v_mfma_f32_16x16x32_bf16 v[188:191], a[84:87], a[96:99], v[188:191]
    v_fmac_f32 v184, v20, v208
    v_fmac_f32 v185, v21, v208
    s_waitcnt lgkmcnt(3)
    v_mfma_f32_16x16x32_bf16 v[192:195], a[64:67], a[120:123], v[192:195]
    v_fmac_f32 v186, v22, v208
    v_fmac_f32 v187, v23, v208
    v_mfma_f32_16x16x32_bf16 v[192:195], a[68:71], a[116:119], v[192:195]
    v_cvt_pk_bf16_f32 v184, v184, v185
    v_cvt_pk_bf16_f32 v185, v186, v187
    v_mfma_f32_16x16x32_bf16 v[192:195], a[72:75], a[112:115], v[192:195]
    v_and_b32 v20, 0xffff0000, v43
    v_lshlrev_b32 v21, 16, v43
    v_mfma_f32_16x16x32_bf16 v[192:195], a[76:79], a[108:111], v[192:195]
    v_and_b32 v22, 0xffff0000, v42
    v_lshlrev_b32 v23, 16, v42
    v_mfma_f32_16x16x32_bf16 v[192:195], a[80:83], a[104:107], v[192:195]
    v_fmac_f32 v188, v20, v208
    v_fmac_f32 v189, v21, v208
    v_mfma_f32_16x16x32_bf16 v[192:195], a[84:87], a[100:103], v[192:195]
    v_fmac_f32 v190, v22, v208
    v_fmac_f32 v191, v23, v208
    v_mfma_f32_16x16x32_bf16 v[192:195], a[88:91], a[96:99], v[192:195]
    v_cvt_pk_bf16_f32 v188, v188, v189
    v_cvt_pk_bf16_f32 v189, v190, v191
    s_waitcnt lgkmcnt(0)
    v_mfma_f32_16x16x32_bf16 v[196:199], a[64:67], a[124:127], v[196:199]
    v_mfma_f32_16x16x32_bf16 v[196:199], a[68:71], a[120:123], v[196:199]
    v_mfma_f32_16x16x32_bf16 v[196:199], a[72:75], a[116:119], v[196:199]
    v_mfma_f32_16x16x32_bf16 v[196:199], a[76:79], a[112:115], v[196:199]
    v_and_b32 v20, 0xffff0000, v45
    v_lshlrev_b32 v21, 16, v45
    v_mfma_f32_16x16x32_bf16 v[196:199], a[80:83], a[108:111], v[196:199]
    v_and_b32 v22, 0xffff0000, v44
    v_lshlrev_b32 v23, 16, v44
    v_mfma_f32_16x16x32_bf16 v[196:199], a[84:87], a[104:107], v[196:199]
    v_fmac_f32 v192, v20, v208
    v_fmac_f32 v193, v21, v208
    v_mfma_f32_16x16x32_bf16 v[196:199], a[88:91], a[100:103], v[196:199]
    v_fmac_f32 v194, v22, v208
    v_fmac_f32 v195, v23, v208
    v_mfma_f32_16x16x32_bf16 v[196:199], a[92:95], a[96:99], v[196:199]
    v_cvt_pk_bf16_f32 v192, v192, v193
    v_cvt_pk_bf16_f32 v193, v194, v195
    s_waitcnt lgkmcnt(0)
    s_nop 3
    v_and_b32 v20, 0xffff0000, v47
    v_lshlrev_b32 v21, 16, v47
    v_and_b32 v22, 0xffff0000, v46
    v_lshlrev_b32 v23, 16, v46
    v_fmac_f32 v196, v20, v208
    v_fmac_f32 v197, v21, v208
    v_fmac_f32 v198, v22, v208
    v_fmac_f32 v199, v23, v208
    v_cvt_pk_bf16_f32 v196, v196, v197
    v_cvt_pk_bf16_f32 v197, v198, v199
    ds_write_b64 v18, v[184:185] offset:22528
    ds_write_b64 v18, v[188:189] offset:23040
    ds_write_b64 v18, v[192:193] offset:23552
    ds_write_b64 v18, v[196:197] offset:24064
    s_waitcnt lgkmcnt(0)
    s_barrier
    ds_read_b32 v80, v24 offset:22528
    ds_read_b32 v81, v24 offset:55680
    ds_read_b32 v82, v26 offset:22528
    ds_read_b32 v83, v26 offset:55680
    ds_read_b32 v84, v24 offset:23552
    ds_read_b32 v85, v24 offset:56704
    ds_read_b32 v86, v26 offset:23552
    ds_read_b32 v87, v26 offset:56704
    s_waitcnt lgkmcnt(4)
    v_perm_b32 v96, v81, v80, s48
    v_perm_b32 v97, v83, v82, s48
    v_perm_b32 v98, v81, v80, s49
    v_perm_b32 v99, v83, v82, s49
    buffer_store_dwordx4 v[96:99], v25, s[8:11], s47 offen sc1
    s_add_u32 s47, s47, 589824
    s_waitcnt lgkmcnt(0)
    v_perm_b32 v100, v85, v84, s48
    v_perm_b32 v101, v87, v86, s48
    v_perm_b32 v102, v85, v84, s49
    v_perm_b32 v103, v87, v86, s49
    buffer_store_dwordx4 v[100:103], v25, s[8:11], s47 offen sc1
    s_add_u32 s47, s47, 589824
    s_cmp_ge_u32 s2, 128
    s_cbranch_scc1 SLW_18
    s_mov_b32 s48, 0x58a0000
    s_cmp_lg_u32 s3, 0
    s_cbranch_scc1 YW_20
    v_lshrrev_b32 v16, 0, v0
    v_lshlrev_b32 v16, 7, v16
    v_and_b32 v17, 0, v0
    v_lshl_add_u32 v16, v17, 4, v16
    s_mov_b32 s49, 0x80000
YP_19:
    buffer_load_dwordx4 v[168:171], v16, s[8:11], s48 offen sc1
    s_sub_u32 s49, s49, 1
    s_cbranch_scc1 YW_20
    s_waitcnt vmcnt(0)
    v_xor_b32 v168, s6, v168
    v_xor_b32 v169, s6, v169
    v_xor_b32 v170, s6, v170
    v_xor_b32 v171, s6, v171
    v_or3_b32 v168, v168, v169, v170
    v_or_b32 v168, v168, v171
    v_cmp_ne_u32 vcc, 0, v168
    s_mov_b64 exec, vcc
    s_cbranch_execnz YP_19
YW_20:
    s_mov_b64 exec, -1
    s_waitcnt vmcnt(0)
    s_barrier
    buffer_store_dword v27, v4, s[8:11], s45 offen sc1
    s_mul_i32 s48, s2, 9216
    s_add_u32 s48, s48, 0x5c00000
    buffer_load_dwordx2 v[72:73], v252, s[8:11], s48 offen sc1
    s_add_u32 s49, s48, 256
    buffer_load_dwordx2 v[74:75], v252, s[8:11], s49 offen sc1
    s_add_u32 s49, s48, 1024
    buffer_load_dwordx2 v[76:77], v252, s[8:11], s49 offen sc1
    s_add_u32 s49, s48, 1280
    buffer_load_dwordx2 v[78:79], v252, s[8:11], s49 offen sc1
    buffer_load_dword v80, v253, s[8:11], s48 offen sc1
    v_and_b32 v29, 7, v0
    v_lshlrev_b32 v29, 6, v29
    v_add_u32 v29, 131072, v29
    s_lshl_b32 s48, s3, 3
    v_and_b32 v28, 32, v0
    v_bfe_u32 v30, v0, 4, 1
    v_lshl_add_u32 v28, v30, 2, v28
    v_add3_u32 v28, v28, v29, s48
    s_mov_b32 s48, 131072
    v_lshl_add_u32 v30, v0, 4, s48
    v_lshl_add_u32 v31, v0, 2, s48
    v_lshlrev_b32 v32, 16, v240
    v_and_b32 v33, 0xffff0000, v240
    v_lshlrev_b32 v34, 16, v241
    v_and_b32 v35, 0xffff0000, v241
    v_lshlrev_b32 v36, 16, v242
    v_and_b32 v37, 0xffff0000, v242
PAD_1:
    s_cbranch_execz PAD_4
    v_lshlrev_b32 v38, 16, v243
    v_and_b32 v39, 0xffff0000, v243
    v_lshlrev_b32 v40, 16, v244
    v_and_b32 v41, 0xffff0000, v244
    v_lshlrev_b32 v42, 16, v245
    v_and_b32 v43, 0xffff0000, v245
    v_lshlrev_b32 v44, 16, v246
    v_and_b32 v45, 0xffff0000, v246
    v_lshlrev_b32 v46, 16, v247
    v_and_b32 v47, 0xffff0000, v247
    v_lshlrev_b32 v48, 16, v248
    v_and_b32 v49, 0xffff0000, v248
    v_pk_add_f32 v[24:25], v[32:33], v[34:35]
    v_pk_mul_f32 v[26:27], v[32:33], v[32:33]
    v_pk_add_f32 v[16:17], v[38:39], v[40:41]
    v_pk_mul_f32 v[20:21], v[38:39], v[38:39]
    v_pk_add_f32 v[18:19], v[44:45], v[46:47]
    v_pk_mul_f32 v[22:23], v[44:45], v[44:45]
    v_pk_add_f32 v[24:25], v[24:25], v[36:37]
    v_pk_fma_f32 v[26:27], v[34:35], v[34:35], v[26:27]
    v_pk_add_f32 v[16:17], v[16:17], v[42:43]
    v_pk_fma_f32 v[20:21], v[40:41], v[40:41], v[20:21]
    v_pk_add_f32 v[18:19], v[18:19], v[48:49]
    v_pk_fma_f32 v[22:23], v[46:47], v[46:47], v[22:23]
    v_pk_add_f32 v[24:25], v[24:25], v[16:17]
    v_pk_fma_f32 v[26:27], v[36:37], v[36:37], v[26:27]
    v_pk_fma_f32 v[20:21], v[42:43], v[42:43], v[20:21]
    v_pk_fma_f32 v[22:23], v[48:49], v[48:49], v[22:23]
    v_pk_add_f32 v[24:25], v[24:25], v[18:19]
    v_pk_add_f32 v[26:27], v[26:27], v[20:21]
    v_add_f32 v24, v24, v25
    v_pk_add_f32 v[26:27], v[26:27], v[22:23]
    v_add_f32 v26, v26, v27
    s_nop 1
    v_permlane32_swap_b32 v24, v26
    v_add_f32 v24, v24, v26
    s_nop 1
    v_add_f32_dpp v24, v24, v24 row_ror:8 row_mask:0xf bank_mask:0xf
    ds_write_b32 v28, v24 offset:0
    s_waitcnt lgkmcnt(0)
    s_barrier
    ds_read_b128 v[52:55], v29 offset:0
    ds_read_b128 v[56:59], v29 offset:16
    ds_read_b128 v[60:63], v29 offset:32
    ds_read_b128 v[64:67], v29 offset:48
    s_waitcnt lgkmcnt(2)
    v_pk_add_f32 v[52:53], v[52:53], v[54:55]
    v_pk_add_f32 v[56:57], v[56:57], v[58:59]
    s_waitcnt lgkmcnt(0)
    v_pk_add_f32 v[60:61], v[60:61], v[62:63]
    v_pk_add_f32 v[64:65], v[64:65], v[66:67]
    v_pk_add_f32 v[52:53], v[52:53], v[56:57]
    v_pk_add_f32 v[60:61], v[60:61], v[64:65]
    v_add_f32 v24, v52, v53
    v_add_f32 v26, v60, v61
    v_mul_f32 v24, 0x3ae38e39, v24
    v_mul_f32 v26, 0x3ae38e39, v26
    v_fma_f32 v26, -v24, v24, v26
    v_cvt_pk_bf16_f32 v24, v24, v24
    v_max_f32 v26, 0, v26
    v_lshlrev_b32 v24, 16, v24
    v_cvt_pk_bf16_f32 v26, v26, v26
    v_pk_add_f32 v[52:53], v[32:33], v[24:25] op_sel_hi:[1,0] neg_lo:[0,1] neg_hi:[0,1]
    v_lshlrev_b32 v26, 16, v26
    v_pk_add_f32 v[54:55], v[34:35], v[24:25] op_sel_hi:[1,0] neg_lo:[0,1] neg_hi:[0,1]
    v_add_f32 v26, 0x3727c5ac, v26
    v_pk_add_f32 v[56:57], v[36:37], v[24:25] op_sel_hi:[1,0] neg_lo:[0,1] neg_hi:[0,1]
    v_cvt_pk_bf16_f32 v26, v26, v26
    v_pk_add_f32 v[58:59], v[38:39], v[24:25] op_sel_hi:[1,0] neg_lo:[0,1] neg_hi:[0,1]
    v_lshlrev_b32 v26, 16, v26
    v_pk_add_f32 v[60:61], v[40:41], v[24:25] op_sel_hi:[1,0] neg_lo:[0,1] neg_hi:[0,1]
    v_sqrt_f32 v26, v26
    v_pk_add_f32 v[62:63], v[42:43], v[24:25] op_sel_hi:[1,0] neg_lo:[0,1] neg_hi:[0,1]
    v_cvt_pk_bf16_f32 v26, v26, v26
    v_pk_add_f32 v[64:65], v[44:45], v[24:25] op_sel_hi:[1,0] neg_lo:[0,1] neg_hi:[0,1]
    v_lshlrev_b32 v26, 16, v26
    v_pk_add_f32 v[66:67], v[46:47], v[24:25] op_sel_hi:[1,0] neg_lo:[0,1] neg_hi:[0,1]
    v_rcp_f32 v26, v26
    v_pk_add_f32 v[68:69], v[48:49], v[24:25] op_sel_hi:[1,0] neg_lo:[0,1] neg_hi:[0,1]
    v_pk_mul_f32 v[52:53], v[52:53], v[26:27] op_sel_hi:[1,0]
    v_pk_mul_f32 v[54:55], v[54:55], v[26:27] op_sel_hi:[1,0]
    v_pk_mul_f32 v[56:57], v[56:57], v[26:27] op_sel_hi:[1,0]
    v_pk_mul_f32 v[58:59], v[58:59], v[26:27] op_sel_hi:[1,0]
    v_pk_mul_f32 v[60:61], v[60:61], v[26:27] op_sel_hi:[1,0]
    v_pk_mul_f32 v[62:63], v[62:63], v[26:27] op_sel_hi:[1,0]
    v_pk_mul_f32 v[64:65], v[64:65], v[26:27] op_sel_hi:[1,0]
    v_pk_mul_f32 v[66:67], v[66:67], v[26:27] op_sel_hi:[1,0]
    v_pk_mul_f32 v[68:69], v[68:69], v[26:27] op_sel_hi:[1,0]
    s_branch YREADY
SLW_18:
    s_waitcnt vmcnt(2)
    v_and_b32 v29, 7, v0
    v_lshlrev_b32 v29, 6, v29
    v_add_u32 v29, 131072, v29
    s_lshl_b32 s48, s3, 3
    v_and_b32 v28, 32, v0
    v_bfe_u32 v30, v0, 4, 1
    v_lshl_add_u32 v28, v30, 2, v28
    v_add3_u32 v28, v28, v29, s48
    s_mov_b32 s48, 131072
    v_lshl_add_u32 v30, v0, 4, s48
    v_lshl_add_u32 v31, v0, 2, s48
    v_lshlrev_b32 v32, 16, v240
    v_and_b32 v33, 0xffff0000, v240
    v_lshlrev_b32 v34, 16, v241
    v_and_b32 v35, 0xffff0000, v241
    v_lshlrev_b32 v36, 16, v242
    v_and_b32 v37, 0xffff0000, v242
    v_lshlrev_b32 v38, 16, v243
    v_and_b32 v39, 0xffff0000, v243
    v_lshlrev_b32 v40, 16, v244
    v_and_b32 v41, 0xffff0000, v244
    v_lshlrev_b32 v42, 16, v245
    v_and_b32 v43, 0xffff0000, v245
    v_lshlrev_b32 v44, 16, v246
    v_and_b32 v45, 0xffff0000, v246
    v_lshlrev_b32 v46, 16, v247
    v_and_b32 v47, 0xffff0000, v247
    v_lshlrev_b32 v48, 16, v248
    v_and_b32 v49, 0xffff0000, v248
    v_pk_add_f32 v[24:25], v[32:33], v[34:35]
    v_pk_mul_f32 v[26:27], v[32:33], v[32:33]
    v_pk_add_f32 v[16:17], v[38:39], v[40:41]
    v_pk_mul_f32 v[20:21], v[38:39], v[38:39]
    v_pk_add_f32 v[18:19], v[44:45], v[46:47]
    v_pk_mul_f32 v[22:23], v[44:45], v[44:45]
    v_pk_add_f32 v[24:25], v[24:25], v[36:37]
    v_pk_fma_f32 v[26:27], v[34:35], v[34:35], v[26:27]
    v_pk_add_f32 v[16:17], v[16:17], v[42:43]
    v_pk_fma_f32 v[20:21], v[40:41], v[40:41], v[20:21]
    v_pk_add_f32 v[18:19], v[18:19], v[48:49]
    v_pk_fma_f32 v[22:23], v[46:47], v[46:47], v[22:23]
    v_pk_add_f32 v[24:25], v[24:25], v[16:17]
    v_pk_fma_f32 v[26:27], v[36:37], v[36:37], v[26:27]
    v_pk_fma_f32 v[20:21], v[42:43], v[42:43], v[20:21]
    v_pk_fma_f32 v[22:23], v[48:49], v[48:49], v[22:23]
    v_pk_add_f32 v[24:25], v[24:25], v[18:19]
    v_pk_add_f32 v[26:27], v[26:27], v[20:21]
    v_add_f32 v24, v24, v25
    v_pk_add_f32 v[26:27], v[26:27], v[22:23]
    v_add_f32 v26, v26, v27
    s_nop 1
    v_permlane32_swap_b32 v24, v26
    v_add_f32 v24, v24, v26
    s_nop 1
    v_add_f32_dpp v24, v24, v24 row_ror:8 row_mask:0xf bank_mask:0xf
    ds_write_b32 v28, v24 offset:0
    s_waitcnt lgkmcnt(0)
    s_barrier
    ds_read_b128 v[52:55], v29 offset:0
    ds_read_b128 v[56:59], v29 offset:16
    ds_read_b128 v[60:63], v29 offset:32
    ds_read_b128 v[64:67], v29 offset:48
    s_waitcnt lgkmcnt(2)
    v_pk_add_f32 v[52:53], v[52:53], v[54:55]
    v_pk_add_f32 v[56:57], v[56:57], v[58:59]
    s_waitcnt lgkmcnt(0)
    v_pk_add_f32 v[60:61], v[60:61], v[62:63]
    v_pk_add_f32 v[64:65], v[64:65], v[66:67]
    v_pk_add_f32 v[52:53], v[52:53], v[56:57]
    v_pk_add_f32 v[60:61], v[60:61], v[64:65]
    v_add_f32 v24, v52, v53
    v_add_f32 v26, v60, v61
    v_mul_f32 v24, 0x3ae38e39, v24
    v_mul_f32 v26, 0x3ae38e39, v26
    v_fma_f32 v26, -v24, v24, v26
    v_cvt_pk_bf16_f32 v24, v24, v24
    v_max_f32 v26, 0, v26
    v_lshlrev_b32 v24, 16, v24
    v_cvt_pk_bf16_f32 v26, v26, v26
    v_pk_add_f32 v[52:53], v[32:33], v[24:25] op_sel_hi:[1,0] neg_lo:[0,1] neg_hi:[0,1]
    v_lshlrev_b32 v26, 16, v26
    v_pk_add_f32 v[54:55], v[34:35], v[24:25] op_sel_hi:[1,0] neg_lo:[0,1] neg_hi:[0,1]
    v_add_f32 v26, 0x3727c5ac, v26
    v_pk_add_f32 v[56:57], v[36:37], v[24:25] op_sel_hi:[1,0] neg_lo:[0,1] neg_hi:[0,1]
    v_cvt_pk_bf16_f32 v26, v26, v26
    v_pk_add_f32 v[58:59], v[38:39], v[24:25] op_sel_hi:[1,0] neg_lo:[0,1] neg_hi:[0,1]
    v_lshlrev_b32 v26, 16, v26
    v_pk_add_f32 v[60:61], v[40:41], v[24:25] op_sel_hi:[1,0] neg_lo:[0,1] neg_hi:[0,1]
    v_sqrt_f32 v26, v26
    v_pk_add_f32 v[62:63], v[42:43], v[24:25] op_sel_hi:[1,0] neg_lo:[0,1] neg_hi:[0,1]
    v_cvt_pk_bf16_f32 v26, v26, v26
    v_pk_add_f32 v[64:65], v[44:45], v[24:25] op_sel_hi:[1,0] neg_lo:[0,1] neg_hi:[0,1]
    v_lshlrev_b32 v26, 16, v26
    v_pk_add_f32 v[66:67], v[46:47], v[24:25] op_sel_hi:[1,0] neg_lo:[0,1] neg_hi:[0,1]
    v_rcp_f32 v26, v26
    v_pk_add_f32 v[68:69], v[48:49], v[24:25] op_sel_hi:[1,0] neg_lo:[0,1] neg_hi:[0,1]
    v_pk_mul_f32 v[52:53], v[52:53], v[26:27] op_sel_hi:[1,0]
    v_pk_mul_f32 v[54:55], v[54:55], v[26:27] op_sel_hi:[1,0]
    v_pk_mul_f32 v[56:57], v[56:57], v[26:27] op_sel_hi:[1,0]
    v_pk_mul_f32 v[58:59], v[58:59], v[26:27] op_sel_hi:[1,0]
    v_pk_mul_f32 v[60:61], v[60:61], v[26:27] op_sel_hi:[1,0]
    v_pk_mul_f32 v[62:63], v[62:63], v[26:27] op_sel_hi:[1,0]
    v_pk_mul_f32 v[64:65], v[64:65], v[26:27] op_sel_hi:[1,0]
    v_pk_mul_f32 v[66:67], v[66:67], v[26:27] op_sel_hi:[1,0]
    v_pk_mul_f32 v[68:69], v[68:69], v[26:27] op_sel_hi:[1,0]
    v_mov_b32 v16, s6
    s_lshl_b32 s47, s3, 28
    s_add_u32 s47, s47, s51
    s_waitcnt vmcnt(0) lgkmcnt(0)
    s_barrier
    buffer_store_dword v16, v4, s[8:11], s47 offen sc1
    s_branch ROW0_3
TOUCH_2:
    s_mov_b32 s72, s30
    s_mov_b32 s73, s31
    s_mov_b32 s74, 0x510000
    s_mov_b32 s75, 0x20000
    s_mov_b32 s76, s32
    s_mov_b32 s77, s33
    s_mov_b32 s78, 0x510000
    s_mov_b32 s79, 0x20000
    s_mov_b32 s80, s34
    s_mov_b32 s81, s35
    s_mov_b32 s82, 0x510000
    s_mov_b32 s83, 0x20000
    s_lshr_b32 s46, s2, 3
    s_sub_u32 s46, s46, 18
    s_and_b32 s45, s2, 7
    s_lshl_b32 s44, s46, 2
    s_add_u32 s44, s44, s3
    v_bfe_u32 v20, v0, 3, 3
    v_and_b32 v21, 7, v0
    v_lshlrev_b32 v22, 4, v21
    v_lshrrev_b32 v23, 1, v21
    v_mul_u32_u24 v23, 18432, v23
    v_lshl_add_u32 v23, v20, 5, v23
    v_and_b32 v24, 16, v22
    v_add_u32 v23, v23, v24
    s_mov_b32 s54, 0x510000
    s_mov_b32 s55, 0x20000
    s_add_u32 s47, s44, 0
    s_mul_i32 s48, s47, 911
    s_lshr_b32 s48, s48, 16
    s_mul_i32 s49, s48, 72
    s_sub_u32 s49, s47, s49
    s_cmp_eq_u32 s48, 0
    s_cselect_b32 s52, s30, s32
    s_cselect_b32 s53, s31, s33
    s_movk_i32 s50, 9216
    s_mul_i32 s51, s45, 1152
    s_mul_i32 s56, s45, 663552
    s_cmp_ge_u32 s48, 2
    s_cselect_b32 s52, s34, s52
    s_cselect_b32 s53, s35, s53
    s_cselect_b32 s50, 1152, s50
    s_cselect_b32 s51, s56, s51
    s_lshl_b32 s56, s49, 3
    s_mul_i32 s56, s56, s50
    s_add_u32 s51, s51, s56
    v_mad_u32_u24 v24, v20, s50, v22
    buffer_load_dwordx4 v[32:35], v24, s[52:55], s51 offen offset:1024
    s_mul_i32 s56, s45, 3
    s_add_u32 s56, s56, s48
    s_mul_i32 s56, s56, 73728
    s_lshl_b32 s57, s49, 8
    s_add_u32 s56, s56, s57
    s_add_u32 s56, s56, 0x5900000
    s_cmp_ge_u32 s48, 3
    s_cselect_b32 s60, 0x10000000, s56
    s_add_u32 s47, s44, 56
    s_mul_i32 s48, s47, 911
    s_lshr_b32 s48, s48, 16
    s_mul_i32 s49, s48, 72
    s_sub_u32 s49, s47, s49
    s_cmp_eq_u32 s48, 0
    s_cselect_b32 s52, s30, s32
    s_cselect_b32 s53, s31, s33
    s_movk_i32 s50, 9216
    s_mul_i32 s51, s45, 1152
    s_mul_i32 s56, s45, 663552
    s_cmp_ge_u32 s48, 2
    s_cselect_b32 s52, s34, s52
    s_cselect_b32 s53, s35, s53
    s_cselect_b32 s50, 1152, s50
    s_cselect_b32 s51, s56, s51
    s_lshl_b32 s56, s49, 3
    s_mul_i32 s56, s56, s50
    s_add_u32 s51, s51, s56
    v_mad_u32_u24 v24, v20, s50, v22
    buffer_load_dwordx4 v[36:39], v24, s[52:55], s51 offen offset:1024
    s_mul_i32 s56, s45, 3
    s_add_u32 s56, s56, s48
    s_mul_i32 s56, s56, 73728
    s_lshl_b32 s57, s49, 8
    s_add_u32 s56, s56, s57
    s_add_u32 s56, s56, 0x5900000
    s_cmp_ge_u32 s48, 3
    s_cselect_b32 s61, 0x10000000, s56
    s_add_u32 s47, s44, 112
    s_mul_i32 s48, s47, 911
    s_lshr_b32 s48, s48, 16
    s_mul_i32 s49, s48, 72
    s_sub_u32 s49, s47, s49
    s_cmp_eq_u32 s48, 0
    s_cselect_b32 s52, s30, s32
    s_cselect_b32 s53, s31, s33
    s_movk_i32 s50, 9216
    s_mul_i32 s51, s45, 1152
    s_mul_i32 s56, s45, 663552
    s_cmp_ge_u32 s48, 2
    s_cselect_b32 s52, s34, s52
    s_cselect_b32 s53, s35, s53
    s_cselect_b32 s50, 1152, s50
    s_cselect_b32 s51, s56, s51
    s_lshl_b32 s56, s49, 3
    s_mul_i32 s56, s56, s50
    s_add_u32 s51, s51, s56
    v_mad_u32_u24 v24, v20, s50, v22
    buffer_load_dwordx4 v[40:43], v24, s[52:55], s51 offen offset:1024
    s_mul_i32 s56, s45, 3
    s_add_u32 s56, s56, s48
    s_mul_i32 s56, s56, 73728
    s_lshl_b32 s57, s49, 8
    s_add_u32 s56, s56, s57
    s_add_u32 s56, s56, 0x5900000
    s_cmp_ge_u32 s48, 3
    s_cselect_b32 s62, 0x10000000, s56
    s_add_u32 s47, s44, 168
    s_mul_i32 s48, s47, 911
    s_lshr_b32 s48, s48, 16
    s_mul_i32 s49, s48, 72
    s_sub_u32 s49, s47, s49
    s_cmp_eq_u32 s48, 0
    s_cselect_b32 s52, s30, s32
    s_cselect_b32 s53, s31, s33
    s_movk_i32 s50, 9216
    s_mul_i32 s51, s45, 1152
    s_mul_i32 s56, s45, 663552
    s_cmp_ge_u32 s48, 2
    s_cselect_b32 s52, s34, s52
    s_cselect_b32 s53, s35, s53
    s_cselect_b32 s50, 1152, s50
    s_cselect_b32 s51, s56, s51
    s_lshl_b32 s56, s49, 3
    s_mul_i32 s56, s56, s50
    s_add_u32 s51, s51, s56
    v_mad_u32_u24 v24, v20, s50, v22
    buffer_load_dwordx4 v[44:47], v24, s[52:55], s51 offen offset:1024
    s_mul_i32 s56, s45, 3
    s_add_u32 s56, s56, s48
    s_mul_i32 s56, s56, 73728
    s_lshl_b32 s57, s49, 8
    s_add_u32 s56, s56, s57
    s_add_u32 s56, s56, 0x5900000
    s_cmp_ge_u32 s48, 3
    s_cselect_b32 s63, 0x10000000, s56
    s_sub_u32 s46, 55, s44
    s_mul_i32 s46, s46, 96
    v_and_b32 v16, 63, v0
    v_min_u32 v16, 47, v16
    v_add_u32 v16, s46, v16
    s_mul_i32 s47, s45, 663552
    s_mul_i32 s46, s45, 1152
    v_add_u32 v17, 0, v16
    v_min_u32 v17, 4607, v17
    v_lshrrev_b32 v25, 3, v17
    v_and_b32 v17, 7, v17
    v_lshlrev_b32 v17, 7, v17
    v_mul_u32_u24 v26, 9216, v25
    v_add_u32 v48, v26, v17
    v_mul_u32_u24 v26, 1152, v25
    v_add_u32 v49, v26, v17
    v_add_u32 v17, 48, v16
    v_min_u32 v17, 4607, v17
    v_lshrrev_b32 v25, 3, v17
    v_and_b32 v17, 7, v17
    v_lshlrev_b32 v17, 7, v17
    v_mul_u32_u24 v26, 9216, v25
    v_add_u32 v50, v26, v17
    v_mul_u32_u24 v26, 1152, v25
    v_add_u32 v51, v26, v17
    s_waitcnt vmcnt(3)
    buffer_store_dwordx4 v[32:35], v23, s[8:11], s60 offen sc1
    s_waitcnt vmcnt(3)
    buffer_store_dwordx4 v[36:39], v23, s[8:11], s61 offen sc1
    s_waitcnt vmcnt(3)
    buffer_store_dwordx4 v[40:43], v23, s[8:11], s62 offen sc1
    s_waitcnt vmcnt(3)
    buffer_store_dwordx4 v[44:47], v23, s[8:11], s63 offen sc1
    buffer_load_dword v200, v48, s[72:75], s46 offen
    buffer_load_dword v200, v48, s[72:75], s46 offen offset:64
    buffer_load_dword v200, v48, s[76:79], s46 offen
    buffer_load_dword v200, v48, s[76:79], s46 offen offset:64
    s_lshl_b32 s51, s2, 7
    s_add_u32 s51, s51, 0x5808000
    v_mov_b32 v24, s6
    s_lshl_b32 s48, s3, 28
    s_add_u32 s48, s48, s51
    s_waitcnt vmcnt(4) lgkmcnt(0)
    s_barrier
    buffer_store_dword v24, v4, s[8:11], s48 offen sc1
    s_lshl_b32 s48, s3, 28
    s_lshr_b32 s49, s2, 2
    s_lshl_b32 s49, s49, 7
    s_add_u32 s48, s48, s49
    s_and_b32 s49, s2, 3
    s_lshl_b32 s49, s49, 2
    s_add_u32 s48, s48, s49
    s_add_u32 s48, s48, 0x58a0000
    buffer_store_dword v24, off, s[8:11], s48 sc1
    v_and_b32 v16, 7, v0
    v_bfe_u32 v17, v0, 3, 2
    v_bfe_u32 v18, v0, 5, 1
    v_lshrrev_b32 v19, 6, v0
    v_lshl_add_u32 v20, v19, 2, v18
    v_lshl_add_u32 v21, v19, 1, v18
    v_lshlrev_b32 v217, 4, v16
    v_lshl_add_u32 v217, v17, 8, v217
    v_lshl_add_u32 v217, v20, 12, v217
    v_bfe_u32 v22, v0, 4, 2
    v_lshl_add_u32 v22, v22, 4, v16
    v_bfe_u32 v23, v0, 3, 1
    v_lshlrev_b32 v23, 2, v23
    v_lshrrev_b32 v24, 1, v19
    v_lshl_add_u32 v23, v24, 12, v23
    v_add_u32 v23, 65536, v23
    v_and_b32 v24, 1, v19
    v_lshl_add_u32 v218, v22, 4, v23
    v_lshl_add_u32 v218, v24, 3, v218
    v_bfe_u32 v22, v0, 4, 2
    v_lshl_add_u32 v22, v22, 3, v16
    v_lshl_add_u32 v219, v22, 3, v23
    v_lshl_add_u32 v219, v24, 9, v219
    v_mul_u32_u24 v22, 1152, v16
    v_lshl_add_u32 v250, v20, 6, v22
    v_lshl_add_u32 v250, v17, 3, v250
    v_lshl_add_u32 v251, v21, 4, v22
    v_lshl_add_u32 v251, v17, 2, v251
    v_lshlrev_b32 v22, 3, v16
    v_lshl_add_u32 v252, v20, 9, v22
    v_lshl_add_u32 v252, v17, 6, v252
    v_lshl_add_u32 v253, v21, 7, v22
    v_lshrrev_b32 v22, 1, v17
    v_lshl_add_u32 v253, v22, 6, v253
    v_and_b32 v22, 1, v17
    v_lshl_add_u32 v253, v22, 2, v253
    v_add_u32 v253, 0x2000, v253
    s_mul_i32 s49, s2, 9216
    buffer_load_dwordx2 v[240:241], v250, s[88:91], s49 offen offset:0
    buffer_load_dwordx2 v[242:243], v250, s[88:91], s49 offen offset:32
    buffer_load_dwordx2 v[244:245], v250, s[88:91], s49 offen offset:128
    buffer_load_dwordx2 v[246:247], v250, s[88:91], s49 offen offset:160
    buffer_load_dword v248, v251, s[88:91], s49 offen offset:1024
    buffer_load_dword v200, v50, s[72:75], s46 offen
    buffer_load_dword v200, v50, s[72:75], s46 offen offset:64
    s_waitcnt vmcnt(8)
    buffer_load_dword v200, v50, s[76:79], s46 offen
    buffer_load_dword v200, v50, s[76:79], s46 offen offset:64
    s_waitcnt vmcnt(8)
    buffer_load_dword v200, v49, s[80:83], s47 offen
    buffer_load_dword v200, v49, s[80:83], s47 offen offset:64
    s_waitcnt vmcnt(8)
    buffer_load_dword v200, v51, s[80:83], s47 offen
    buffer_load_dword v200, v51, s[80:83], s47 offen offset:64
    v_and_b32 v16, 63, v0
    v_lshlrev_b32 v1, 4, v16
    v_lshlrev_b32 v2, 3, v16
    v_lshrrev_b32 v17, 3, v16
    v_lshrrev_b32 v18, 4, v16
    v_lshlrev_b32 v19, 1, v18
    v_and_b32 v20, 7, v16
    v_xor_b32 v19, v19, v20
    v_lshlrev_b32 v19, 4, v19
    s_movk_i32 s44, 9216
    s_movk_i32 s45, 1152
    v_mad_u32_u24 v3, v17, s44, v19
    v_mad_u32_u24 v5, v17, s45, v19
    v_lshrrev_b32 v17, 2, v16
    v_and_b32 v19, 3, v16
    v_lshlrev_b32 v19, 3, v19
    v_bfe_u32 v20, v16, 3, 2
    v_lshl_add_u32 v21, v17, 7, v19
    v_xor_b32 v22, 0, v20
    v_lshl_add_u32 v6, v22, 5, v21
    v_xor_b32 v22, 1, v20
    v_lshl_add_u32 v7, v22, 5, v21
    v_xor_b32 v22, 2, v20
    v_lshl_add_u32 v8, v22, 5, v21
    v_xor_b32 v22, 3, v20
    v_lshl_add_u32 v9, v22, 5, v21
    v_lshl_add_u32 v10, v17, 5, v19
    v_add_u32 v11, 0x10000, v6
    v_add_u32 v12, 0x10000, v7
    v_add_u32 v13, 0x10000, v8
    v_add_u32 v14, 0x10000, v9
    v_add_u32 v15, 0x10000, v10
    s_and_b32 s46, s2, 7
    s_lshr_b32 s47, s2, 3
    s_and_b32 s24, s47, 3
    s_mul_i32 s28, s47, 73728
    s_bfe_u32 s44, s2, 0x20001
    s_lshl_b32 s44, s44, 10
    s_add_u32 s28, s28, s44
    s_and_b32 s44, s2, 1
    s_lshl_b32 s44, s44, 7
    s_add_u32 s28, s28, s44
    s_add_u32 s41, s28, s44
    s_lshr_b32 s47, s47, 2
    s_lshl_b32 s18, s3, 10
    s_mul_i32 s48, s46, 1152
    s_lshl_b32 s49, s24, 8
    s_lshl_b32 s50, s24, 5
    s_add_u32 s50, s50, 1024
    s_mul_i32 s44, s3, 73728
    s_add_u32 s44, s44, s48
    s_add_u32 s36, s44, s49
    s_mul_i32 s50, s24, 18432
    s_add_u32 s50, s50, 0x5900000
    s_mul_i32 s44, s46, 3
    s_and_b32 s45, s3, 1
    s_add_u32 s44, s44, s45
    s_mul_i32 s44, s44, 73728
    s_lshr_b32 s45, s3, 1
    s_lshl_b32 s45, s45, 10
    s_add_u32 s44, s44, s45
    s_add_u32 s37, s44, s50
    s_and_b32 s48, s46, 6
    s_mul_i32 s48, s48, 663552
    s_mul_i32 s44, s3, 9216
    s_add_u32 s44, s44, s48
    s_add_u32 s38, s44, s49
    s_and_b32 s48, s46, 6
    s_mul_i32 s48, s48, 221184
    s_add_u32 s48, s48, 147456
    s_add_u32 s48, s48, s50
    s_lshl_b32 s44, s3, 12
    s_add_u32 s39, s44, s48
    s_and_b32 s44, s18, 1024
    s_add_u32 s44, s44, 16384
    s_add_u32 s40, s44, s48
    s_lshl_b32 s45, s47, 2
    s_add_u32 s45, s45, s3
    s_mul_i32 s45, s45, 73728
    s_add_u32 s16, s45, 0x1800000
    s_mul_i32 s44, s46, 2359296
    s_add_u32 s45, s45, s44
    s_add_u32 s17, s45, 0x2000000
    s_lshl_b32 s44, s24, 12
    s_add_u32 s25, s17, s44
    s_lshr_b32 s44, s24, 1
    s_lshl_b32 s44, s44, 12
    s_and_b32 s45, s24, 1
    s_lshl_b32 s45, s45, 9
    s_add_u32 s44, s44, s45
    s_add_u32 s49, s44, 65536
    s_add_u32 s27, s49, s17
    s_and_b32 s44, s46, 1
    s_lshl_b32 s44, s44, 1
    s_and_b32 s45, s3, 1
    s_add_u32 s44, s44, s45
    s_lshl_b32 s45, s47, 2
    s_add_u32 s44, s44, s45
    s_mul_i32 s44, s44, 73728
    s_lshr_b32 s50, s3, 1
    s_and_b32 s48, s46, 6
    s_add_u32 s48, s48, s50
    s_lshl_b32 s93, s50, 12
    s_lshl_b32 s50, s50, 11
    s_mul_i32 s45, s48, 2359296
    s_add_u32 s45, s45, s44
    s_add_u32 s45, s45, 0x2000000
    s_add_u32 s17, s45, s50
    s_sub_u32 s94, s45, s50
    s_lshr_b32 s45, s46, 1
    s_mul_i32 s45, s45, 2359296
    s_add_u32 s45, s45, s44
    s_add_u32 s45, s45, s50
    s_add_u32 s45, s45, 0x4000000
    s_add_u32 s43, s45, s49
    s_lshl_b32 s44, s24, 14
    s_add_u32 s22, s45, s44
    s_lshl_b32 s47, s47, 3
    s_add_u32 s48, s48, s47
    s_lshl_b32 s48, s48, 9
    s_add_u32 s95, s48, 0x5860000
    s_add_u32 s47, s47, s46
    s_lshl_b32 s47, s47, 9
    s_add_u32 s23, s47, 0x5860000
    s_add_u32 s72, s30, s36
    s_addc_u32 s73, s31, 0
    s_add_u32 s74, s32, s36
    s_addc_u32 s75, s33, 0
    s_add_u32 s76, s34, s38
    s_addc_u32 s77, s35, 0
    s_add_u32 s78, s4, s16
    s_addc_u32 s79, s5, 0
    s_add_u32 s80, s4, s17
    s_addc_u32 s81, s5, 0
    s_add_u32 s82, s4, s94
    s_addc_u32 s83, s5, 0
    s_add_u32 s84, s4, s37
    s_addc_u32 s85, s5, 0
    s_add_u32 s86, s4, s39
    s_addc_u32 s87, s5, 0
    s_add_u32 s98, s4, s40
    s_addc_u32 s99, s5, 0
    s_waitcnt vmcnt(4)
    v_and_b32 v29, 7, v0
    v_lshlrev_b32 v29, 6, v29
    v_add_u32 v29, 131072, v29
    s_lshl_b32 s48, s3, 3
    v_and_b32 v28, 32, v0
    v_bfe_u32 v30, v0, 4, 1
    v_lshl_add_u32 v28, v30, 2, v28
    v_add3_u32 v28, v28, v29, s48
    s_mov_b32 s48, 131072
    v_lshl_add_u32 v30, v0, 4, s48
    v_lshl_add_u32 v31, v0, 2, s48
    v_lshlrev_b32 v32, 16, v240
    v_and_b32 v33, 0xffff0000, v240
    v_lshlrev_b32 v34, 16, v241
    v_and_b32 v35, 0xffff0000, v241
    v_lshlrev_b32 v36, 16, v242
    v_and_b32 v37, 0xffff0000, v242
    v_lshlrev_b32 v38, 16, v243
    v_and_b32 v39, 0xffff0000, v243
    v_lshlrev_b32 v40, 16, v244
    v_and_b32 v41, 0xffff0000, v244
    v_lshlrev_b32 v42, 16, v245
    v_and_b32 v43, 0xffff0000, v245
    v_lshlrev_b32 v44, 16, v246
    v_and_b32 v45, 0xffff0000, v246
    v_lshlrev_b32 v46, 16, v247
    v_and_b32 v47, 0xffff0000, v247
    v_lshlrev_b32 v48, 16, v248
    v_and_b32 v49, 0xffff0000, v248
    v_pk_add_f32 v[24:25], v[32:33], v[34:35]
    v_pk_mul_f32 v[26:27], v[32:33], v[32:33]
    v_pk_add_f32 v[16:17], v[38:39], v[40:41]
    v_pk_mul_f32 v[20:21], v[38:39], v[38:39]
    v_pk_add_f32 v[18:19], v[44:45], v[46:47]
    v_pk_mul_f32 v[22:23], v[44:45], v[44:45]
    v_pk_add_f32 v[24:25], v[24:25], v[36:37]
    v_pk_fma_f32 v[26:27], v[34:35], v[34:35], v[26:27]
    v_pk_add_f32 v[16:17], v[16:17], v[42:43]
    v_pk_fma_f32 v[20:21], v[40:41], v[40:41], v[20:21]
    v_pk_add_f32 v[18:19], v[18:19], v[48:49]
    v_pk_fma_f32 v[22:23], v[46:47], v[46:47], v[22:23]
    v_pk_add_f32 v[24:25], v[24:25], v[16:17]
    v_pk_fma_f32 v[26:27], v[36:37], v[36:37], v[26:27]
    v_pk_fma_f32 v[20:21], v[42:43], v[42:43], v[20:21]
    v_pk_fma_f32 v[22:23], v[48:49], v[48:49], v[22:23]
    v_pk_add_f32 v[24:25], v[24:25], v[18:19]
    v_pk_add_f32 v[26:27], v[26:27], v[20:21]
    v_add_f32 v24, v24, v25
    v_pk_add_f32 v[26:27], v[26:27], v[22:23]
    v_add_f32 v26, v26, v27
    s_nop 1
    v_permlane32_swap_b32 v24, v26
    v_add_f32 v24, v24, v26
    s_nop 1
    v_add_f32_dpp v24, v24, v24 row_ror:8 row_mask:0xf bank_mask:0xf
    ds_write_b32 v28, v24 offset:0
    s_waitcnt lgkmcnt(0)
    s_barrier
    ds_read_b128 v[52:55], v29 offset:0
    ds_read_b128 v[56:59], v29 offset:16
    ds_read_b128 v[60:63], v29 offset:32
    ds_read_b128 v[64:67], v29 offset:48
    s_waitcnt lgkmcnt(2)
    v_pk_add_f32 v[52:53], v[52:53], v[54:55]
    v_pk_add_f32 v[56:57], v[56:57], v[58:59]
    s_waitcnt lgkmcnt(0)
    v_pk_add_f32 v[60:61], v[60:61], v[62:63]
    v_pk_add_f32 v[64:65], v[64:65], v[66:67]
    v_pk_add_f32 v[52:53], v[52:53], v[56:57]
    v_pk_add_f32 v[60:61], v[60:61], v[64:65]
    v_add_f32 v24, v52, v53
    v_add_f32 v26, v60, v61
    v_mul_f32 v24, 0x3ae38e39, v24
    v_mul_f32 v26, 0x3ae38e39, v26
    v_fma_f32 v26, -v24, v24, v26
    v_cvt_pk_bf16_f32 v24, v24, v24
    v_max_f32 v26, 0, v26
    v_lshlrev_b32 v24, 16, v24
    v_cvt_pk_bf16_f32 v26, v26, v26
    v_pk_add_f32 v[52:53], v[32:33], v[24:25] op_sel_hi:[1,0] neg_lo:[0,1] neg_hi:[0,1]
    v_lshlrev_b32 v26, 16, v26
PAD_2:
    s_cbranch_execz PAD_5
    v_pk_add_f32 v[54:55], v[34:35], v[24:25] op_sel_hi:[1,0] neg_lo:[0,1] neg_hi:[0,1]
    v_add_f32 v26, 0x3727c5ac, v26
    v_pk_add_f32 v[56:57], v[36:37], v[24:25] op_sel_hi:[1,0] neg_lo:[0,1] neg_hi:[0,1]
    v_cvt_pk_bf16_f32 v26, v26, v26
    v_pk_add_f32 v[58:59], v[38:39], v[24:25] op_sel_hi:[1,0] neg_lo:[0,1] neg_hi:[0,1]
    v_lshlrev_b32 v26, 16, v26
    v_pk_add_f32 v[60:61], v[40:41], v[24:25] op_sel_hi:[1,0] neg_lo:[0,1] neg_hi:[0,1]
    v_sqrt_f32 v26, v26
    v_pk_add_f32 v[62:63], v[42:43], v[24:25] op_sel_hi:[1,0] neg_lo:[0,1] neg_hi:[0,1]
    v_cvt_pk_bf16_f32 v26, v26, v26
    v_pk_add_f32 v[64:65], v[44:45], v[24:25] op_sel_hi:[1,0] neg_lo:[0,1] neg_hi:[0,1]
    v_lshlrev_b32 v26, 16, v26
    v_pk_add_f32 v[66:67], v[46:47], v[24:25] op_sel_hi:[1,0] neg_lo:[0,1] neg_hi:[0,1]
    v_rcp_f32 v26, v26
    v_pk_add_f32 v[68:69], v[48:49], v[24:25] op_sel_hi:[1,0] neg_lo:[0,1] neg_hi:[0,1]
    v_pk_mul_f32 v[52:53], v[52:53], v[26:27] op_sel_hi:[1,0]
    v_pk_mul_f32 v[54:55], v[54:55], v[26:27] op_sel_hi:[1,0]
    v_pk_mul_f32 v[56:57], v[56:57], v[26:27] op_sel_hi:[1,0]
    v_pk_mul_f32 v[58:59], v[58:59], v[26:27] op_sel_hi:[1,0]
    v_pk_mul_f32 v[60:61], v[60:61], v[26:27] op_sel_hi:[1,0]
    v_pk_mul_f32 v[62:63], v[62:63], v[26:27] op_sel_hi:[1,0]
    v_pk_mul_f32 v[64:65], v[64:65], v[26:27] op_sel_hi:[1,0]
    v_pk_mul_f32 v[66:67], v[66:67], v[26:27] op_sel_hi:[1,0]
    v_pk_mul_f32 v[68:69], v[68:69], v[26:27] op_sel_hi:[1,0]
    s_add_u32 s46, s28, 0x1800000
    buffer_store_dwordx4 v[24:27], v217, s[8:11], s46 offen sc1
    buffer_store_dword v24, v218, s[8:11], s46 offen sc1
    s_add_u32 s46, s46, 8192
    buffer_store_dwordx4 v[24:27], v217, s[8:11], s46 offen sc1
    s_add_u32 m0, s18, 0
    v_add_u32 v220, 0, v3
    global_load_lds_dwordx4 v220, s[72:73]
    s_add_u32 m0, s18, 4096
    v_add_u32 v220, 294912, v3
    global_load_lds_dwordx4 v220, s[72:73]
    s_add_u32 m0, s18, 8192
    v_add_u32 v220, 0, v3
    global_load_lds_dwordx4 v220, s[74:75]
    s_add_u32 m0, s18, 12288
    v_add_u32 v220, 294912, v3
    global_load_lds_dwordx4 v220, s[74:75]
    s_add_u32 m0, s18, 16384
    v_add_u32 v220, 589824, v3
    global_load_lds_dwordx4 v220, s[72:73]
    s_add_u32 m0, s18, 20480
    v_add_u32 v220, 884736, v3
    global_load_lds_dwordx4 v220, s[72:73]
    s_add_u32 m0, s18, 24576
    v_add_u32 v220, 589824, v3
    global_load_lds_dwordx4 v220, s[74:75]
    s_add_u32 m0, s18, 28672
    v_add_u32 v220, 884736, v3
    global_load_lds_dwordx4 v220, s[74:75]
    s_add_u32 m0, s18, 32768
    v_add_u32 v220, 1179648, v3
    global_load_lds_dwordx4 v220, s[72:73]
    s_add_u32 m0, s18, 36864
    v_add_u32 v220, 1474560, v3
    global_load_lds_dwordx4 v220, s[72:73]
    s_add_u32 m0, s18, 40960
    v_add_u32 v220, 1179648, v3
    global_load_lds_dwordx4 v220, s[74:75]
    s_add_u32 m0, s18, 45056
    v_add_u32 v220, 1474560, v3
    global_load_lds_dwordx4 v220, s[74:75]
    s_mov_b32 s96, 1
ROW0_3:
    s_mov_b32 s48, 0x5808000
    s_cmp_lg_u32 s3, 0
    s_cbranch_scc1 SW_23
    v_and_b32 v16, 63, v0
    v_lshlrev_b32 v16, 7, v16
    v_and_b32 v17, 63, v0
    v_add_u32 v17, 64, v17
    v_min_u32 v17, 143, v17
    v_lshlrev_b32 v17, 7, v17
    v_and_b32 v18, 63, v0
    v_add_u32 v18, 128, v18
    v_min_u32 v18, 143, v18
    v_lshlrev_b32 v18, 7, v18
    s_mov_b32 s49, 0x80000
    s_mov_b64 s[52:53], -1
    s_mov_b64 s[54:55], -1
    s_mov_b64 s[56:57], -1
SP_21:
    s_mov_b64 exec, s[52:53]
    s_cbranch_execz SK_25
    buffer_load_dword v168, v16, s[8:11], s48 offen sc1
SK_25:
    s_mov_b64 exec, s[54:55]
    s_cbranch_execz SK_26
    buffer_load_dword v169, v17, s[8:11], s48 offen sc1
SK_26:
    s_mov_b64 exec, s[56:57]
    s_cbranch_execz SK_27
    buffer_load_dword v170, v18, s[8:11], s48 offen sc1
SK_27:
    s_mov_b64 exec, -1
    s_sub_u32 s49, s49, 1
    s_cbranch_scc1 SO_22
    s_waitcnt vmcnt(0)
    v_cmp_ne_u32 s[52:53], s6, v168
    v_cmp_ne_u32 s[54:55], s6, v169
    v_cmp_ne_u32 s[56:57], s6, v170
    s_or_b64 vcc, s[52:53], s[54:55]
    s_or_b64 vcc, vcc, s[56:57]
    s_cbranch_scc1 SP_21
SO_22:
    s_branch SB_24
SW_23:
    s_waitcnt vmcnt(0)
SB_24:
    s_barrier
    s_mul_i32 s48, s2, 9216
    s_add_u32 s48, s48, 0x5c00000
    buffer_load_dwordx2 v[72:73], v252, s[8:11], s48 offen sc1
    s_add_u32 s49, s48, 256
    buffer_load_dwordx2 v[74:75], v252, s[8:11], s49 offen sc1
    s_add_u32 s49, s48, 1024
    buffer_load_dwordx2 v[76:77], v252, s[8:11], s49 offen sc1
    s_add_u32 s49, s48, 1280
    buffer_load_dwordx2 v[78:79], v252, s[8:11], s49 offen sc1
    buffer_load_dword v80, v253, s[8:11], s48 offen sc1
YREADY:
    s_waitcnt vmcnt(0)
    v_lshlrev_b32 v118, 16, v72
    v_and_b32 v119, 0xffff0000, v72
    v_lshlrev_b32 v120, 16, v73
    v_and_b32 v121, 0xffff0000, v73
    v_lshlrev_b32 v122, 16, v74
    v_and_b32 v123, 0xffff0000, v74
    v_lshlrev_b32 v124, 16, v75
    v_and_b32 v125, 0xffff0000, v75
    v_lshlrev_b32 v126, 16, v76
    v_and_b32 v127, 0xffff0000, v76
    v_lshlrev_b32 v128, 16, v77
    v_and_b32 v129, 0xffff0000, v77
    v_lshlrev_b32 v130, 16, v78
    v_and_b32 v131, 0xffff0000, v78
    v_lshlrev_b32 v132, 16, v79
    v_and_b32 v133, 0xffff0000, v79
    v_lshlrev_b32 v134, 16, v80
    v_and_b32 v135, 0xffff0000, v80
NOY_5:
    v_pk_fma_f32 v[32:33], v[52:53], v[118:119], v[32:33]
    v_pk_fma_f32 v[34:35], v[54:55], v[120:121], v[34:35]
    v_pk_fma_f32 v[36:37], v[56:57], v[122:123], v[36:37]
    v_pk_fma_f32 v[38:39], v[58:59], v[124:125], v[38:39]
    v_pk_fma_f32 v[40:41], v[60:61], v[126:127], v[40:41]
    v_pk_fma_f32 v[42:43], v[62:63], v[128:129], v[42:43]
    v_pk_fma_f32 v[44:45], v[64:65], v[130:131], v[44:45]
    v_pk_fma_f32 v[46:47], v[66:67], v[132:133], v[46:47]
    v_pk_fma_f32 v[48:49], v[68:69], v[134:135], v[48:49]
    v_pk_add_f32 v[24:25], v[32:33], v[34:35]
    v_pk_mul_f32 v[26:27], v[32:33], v[32:33]
    v_pk_add_f32 v[16:17], v[38:39], v[40:41]
    v_pk_mul_f32 v[20:21], v[38:39], v[38:39]
    v_pk_add_f32 v[18:19], v[44:45], v[46:47]
    v_pk_mul_f32 v[22:23], v[44:45], v[44:45]
    v_pk_add_f32 v[24:25], v[24:25], v[36:37]
    v_pk_fma_f32 v[26:27], v[34:35], v[34:35], v[26:27]
    v_pk_add_f32 v[16:17], v[16:17], v[42:43]
    v_pk_fma_f32 v[20:21], v[40:41], v[40:41], v[20:21]
    v_pk_add_f32 v[18:19], v[18:19], v[48:49]
    v_pk_fma_f32 v[22:23], v[46:47], v[46:47], v[22:23]
    v_pk_add_f32 v[24:25], v[24:25], v[16:17]
    v_pk_fma_f32 v[26:27], v[36:37], v[36:37], v[26:27]
    v_pk_fma_f32 v[20:21], v[42:43], v[42:43], v[20:21]
    v_pk_fma_f32 v[22:23], v[48:49], v[48:49], v[22:23]
    v_pk_add_f32 v[24:25], v[24:25], v[18:19]
    v_pk_add_f32 v[26:27], v[26:27], v[20:21]
    v_add_f32 v24, v24, v25
    v_pk_add_f32 v[26:27], v[26:27], v[22:23]
    v_add_f32 v26, v26, v27
    s_nop 1
    v_permlane32_swap_b32 v24, v26
    v_add_f32 v24, v24, v26
    s_nop 1
    v_add_f32_dpp v24, v24, v24 row_ror:8 row_mask:0xf bank_mask:0xf
    ds_write_b32 v28, v24 offset:512
    s_waitcnt lgkmcnt(0)
    s_barrier
    ds_read_b128 v[52:55], v29 offset:512
    ds_read_b128 v[56:59], v29 offset:528
    ds_read_b128 v[60:63], v29 offset:544
    ds_read_b128 v[64:67], v29 offset:560
    v_cvt_pk_bf16_f32 v240, v32, v33
    v_cvt_pk_bf16_f32 v241, v34, v35
    v_cvt_pk_bf16_f32 v242, v36, v37
    v_cvt_pk_bf16_f32 v243, v38, v39
    v_cvt_pk_bf16_f32 v244, v40, v41
    v_cvt_pk_bf16_f32 v245, v42, v43
    v_cvt_pk_bf16_f32 v246, v44, v45
    v_cvt_pk_bf16_f32 v247, v46, v47
    v_cvt_pk_bf16_f32 v248, v48, v49
    ds_write_b128 v30, v[240:243] offset:1024
    ds_write_b128 v30, v[244:247] offset:5120
    ds_write_b32 v31, v248 offset:9216
    s_waitcnt lgkmcnt(5)
    v_pk_add_f32 v[52:53], v[52:53], v[54:55]
    v_pk_add_f32 v[56:57], v[56:57], v[58:59]
    s_waitcnt lgkmcnt(3)
    v_pk_add_f32 v[60:61], v[60:61], v[62:63]
    v_pk_add_f32 v[64:65], v[64:65], v[66:67]
    v_pk_add_f32 v[52:53], v[52:53], v[56:57]
    v_pk_add_f32 v[60:61], v[60:61], v[64:65]
    v_add_f32 v24, v52, v53
    v_add_f32 v26, v60, v61
    v_mul_f32 v24, 0x3ae38e39, v24
    v_mul_f32 v26, 0x3ae38e39, v26
    v_fma_f32 v26, -v24, v24, v26
    v_cvt_pk_bf16_f32 v24, v24, v24
    v_max_f32 v26, 0, v26
    v_lshlrev_b32 v24, 16, v24
    v_cvt_pk_bf16_f32 v26, v26, v26
    v_pk_add_f32 v[52:53], v[32:33], v[24:25] op_sel_hi:[1,0] neg_lo:[0,1] neg_hi:[0,1]
    v_lshlrev_b32 v26, 16, v26
    v_pk_add_f32 v[54:55], v[34:35], v[24:25] op_sel_hi:[1,0] neg_lo:[0,1] neg_hi:[0,1]
    v_add_f32 v26, 0x3727c5ac, v26
    v_pk_add_f32 v[56:57], v[36:37], v[24:25] op_sel_hi:[1,0] neg_lo:[0,1] neg_hi:[0,1]
    v_cvt_pk_bf16_f32 v26, v26, v26
    v_pk_add_f32 v[58:59], v[38:39], v[24:25] op_sel_hi:[1,0] neg_lo:[0,1] neg_hi:[0,1]
    v_lshlrev_b32 v26, 16, v26
    v_pk_add_f32 v[60:61], v[40:41], v[24:25] op_sel_hi:[1,0] neg_lo:[0,1] neg_hi:[0,1]
    v_sqrt_f32 v26, v26
    v_pk_add_f32 v[62:63], v[42:43], v[24:25] op_sel_hi:[1,0] neg_lo:[0,1] neg_hi:[0,1]
    v_cvt_pk_bf16_f32 v26, v26, v26
    v_pk_add_f32 v[64:65], v[44:45], v[24:25] op_sel_hi:[1,0] neg_lo:[0,1] neg_hi:[0,1]
    v_lshlrev_b32 v26, 16, v26
    v_pk_add_f32 v[66:67], v[46:47], v[24:25] op_sel_hi:[1,0] neg_lo:[0,1] neg_hi:[0,1]
    v_rcp_f32 v26, v26
    v_pk_add_f32 v[68:69], v[48:49], v[24:25] op_sel_hi:[1,0] neg_lo:[0,1] neg_hi:[0,1]
    v_pk_mul_f32 v[52:53], v[52:53], v[26:27] op_sel_hi:[1,0]
    v_pk_mul_f32 v[54:55], v[54:55], v[26:27] op_sel_hi:[1,0]
    v_pk_mul_f32 v[56:57], v[56:57], v[26:27] op_sel_hi:[1,0]
    v_pk_mul_f32 v[58:59], v[58:59], v[26:27] op_sel_hi:[1,0]
    v_pk_mul_f32 v[60:61], v[60:61], v[26:27] op_sel_hi:[1,0]
    v_pk_mul_f32 v[62:63], v[62:63], v[26:27] op_sel_hi:[1,0]
    v_pk_mul_f32 v[64:65], v[64:65], v[26:27] op_sel_hi:[1,0]
    v_pk_mul_f32 v[66:67], v[66:67], v[26:27] op_sel_hi:[1,0]
    v_pk_mul_f32 v[68:69], v[68:69], v[26:27] op_sel_hi:[1,0]
    v_cvt_pk_bf16_f32 v72, v52, v53
    v_cvt_pk_bf16_f32 v73, v54, v55
    v_cvt_pk_bf16_f32 v74, v56, v57
    v_cvt_pk_bf16_f32 v75, v58, v59
    v_cvt_pk_bf16_f32 v76, v60, v61
    v_cvt_pk_bf16_f32 v77, v62, v63
    v_cvt_pk_bf16_f32 v78, v64, v65
    v_cvt_pk_bf16_f32 v79, v66, v67
    v_cvt_pk_bf16_f32 v80, v68, v69
    s_add_u32 s48, s28, 0x1800000
    s_add_u32 s49, s48, 8192
    buffer_store_dwordx4 v[72:75], v217, s[8:11], s48 offen sc1
    buffer_store_dwordx4 v[76:79], v217, s[8:11], s49 offen sc1
    buffer_store_dword v80, v218, s[8:11], s48 offen sc1
    s_lshl_b32 s51, s2, 7
    s_add_u32 s51, s51, s7
    s_add_u32 s51, s51, 0x5810000
    s_and_b32 s48, s2, 0xe0
    s_lshl_b32 s48, s48, 7
    s_add_u32 s48, s48, s7
    s_add_u32 s48, s48, 0x5810000
    s_add_u32 s48, s48, s18
    s_add_u32 s42, s95, s7
    s_lshl_b32 s29, s24, 7
    s_add_u32 s29, s29, s23
    s_add_u32 s29, s29, s7
    s_lshl_b32 s26, s3, 28
    s_add_u32 s29, s29, s26
    v_mov_b32 v221, s6
    v_and_b32 v222, 3, v0
    v_lshlrev_b32 v222, 7, v222
    s_lshl_b32 s30, s2, 7
    s_add_u32 s30, s30, s26
    s_add_u32 s30, s30, s7
    s_add_u32 s30, s30, 0x5820000
    s_and_b32 s31, s2, 0xe0
    s_lshr_b32 s19, s24, 1
    s_add_u32 s31, s31, s19
    s_lshl_b32 s31, s31, 7
    s_add_u32 s31, s31, s18
    s_add_u32 s31, s31, s7
    s_add_u32 s31, s31, 0x5820000
    v_mov_b32 v16, s6
    s_lshl_b32 s47, s3, 28
    s_add_u32 s47, s47, s51
    s_waitcnt vmcnt(0) lgkmcnt(0)
    s_barrier
    buffer_store_dword v16, v4, s[8:11], s47 offen sc1
    s_cmp_lg_u32 s96, 0
    s_cbranch_scc1 PF_28
    s_add_u32 m0, s18, 0
    v_add_u32 v220, 0, v3
    global_load_lds_dwordx4 v220, s[72:73]
    s_add_u32 m0, s18, 4096
    v_add_u32 v220, 294912, v3
    global_load_lds_dwordx4 v220, s[72:73]
    s_add_u32 m0, s18, 8192
    v_add_u32 v220, 0, v3
    global_load_lds_dwordx4 v220, s[74:75]
    s_add_u32 m0, s18, 12288
    v_add_u32 v220, 294912, v3
    global_load_lds_dwordx4 v220, s[74:75]
    s_add_u32 m0, s18, 16384
    v_add_u32 v220, 589824, v3
    global_load_lds_dwordx4 v220, s[72:73]
    s_add_u32 m0, s18, 20480
    v_add_u32 v220, 884736, v3
    global_load_lds_dwordx4 v220, s[72:73]
    s_add_u32 m0, s18, 24576
    v_add_u32 v220, 589824, v3
    global_load_lds_dwordx4 v220, s[74:75]
    s_add_u32 m0, s18, 28672
    v_add_u32 v220, 884736, v3
    global_load_lds_dwordx4 v220, s[74:75]
    s_add_u32 m0, s18, 32768
    v_add_u32 v220, 1179648, v3
    global_load_lds_dwordx4 v220, s[72:73]
    s_add_u32 m0, s18, 36864
    v_add_u32 v220, 1474560, v3
    global_load_lds_dwordx4 v220, s[72:73]
    s_add_u32 m0, s18, 40960
    v_add_u32 v220, 1179648, v3
    global_load_lds_dwordx4 v220, s[74:75]
    s_add_u32 m0, s18, 45056
    v_add_u32 v220, 1474560, v3
    global_load_lds_dwordx4 v220, s[74:75]
PF_28:
    s_add_u32 m0, s18, 141312
    v_add_u32 v220, 0, v1
    global_load_lds_dwordx4 v220, s[86:87] sc1
    s_add_u32 m0, s18, 145408
    v_add_u32 v220, 221184, v1
    global_load_lds_dwordx4 v220, s[86:87] sc1
    s_add_u32 m0, s18, 149504
    v_add_u32 v220, 1024, v1
    global_load_lds_dwordx4 v220, s[86:87] sc1
    s_add_u32 m0, s18, 153600
    v_add_u32 v220, 222208, v1
    global_load_lds_dwordx4 v220, s[86:87] sc1
    s_and_b32 s19, s18, 1024
    s_add_u32 m0, s19, 157696
    v_add_u32 v220, 0, v1
    global_load_lds_dwordx4 v220, s[98:99] sc1
    s_and_b32 s19, s18, 1024
    s_add_u32 m0, s19, 161792
    v_add_u32 v220, 221184, v1
    global_load_lds_dwordx4 v220, s[98:99] sc1
    v_and_b32 v20, 63, v0
    v_lshlrev_b32 v20, 7, v20
    s_mov_b64 exec, 0xff
    s_mov_b32 s49, 0x80000
    buffer_load_dword v168, v20, s[8:11], s48 offen sc1
SP_29:
    s_waitcnt vmcnt(0)
    v_cmp_ne_u32 vcc, s6, v168
    s_cbranch_vccz SO_30
    s_mov_b64 exec, vcc
    buffer_load_dword v168, v20, s[8:11], s48 offen sc1
    s_sub_u32 s49, s49, 1
    s_cmp_lg_u32 s49, 0
    s_cbranch_scc1 SP_29
SO_30:
    s_mov_b64 exec, -1
    v_add_u32 v219, 0, v1
    global_load_dwordx4 a[0:3], v219, s[78:79] offset:0 sc1
    global_load_dwordx4 a[4:7], v219, s[78:79] offset:1024 sc1
    global_load_dwordx4 a[8:11], v219, s[78:79] offset:2048 sc1
    global_load_dwordx4 a[12:15], v219, s[78:79] offset:3072 sc1
    v_add_u32 v219, 4096, v1
    global_load_dwordx4 a[16:19], v219, s[78:79] offset:0 sc1
    global_load_dwordx4 a[20:23], v219, s[78:79] offset:1024 sc1
    global_load_dwordx4 a[24:27], v219, s[78:79] offset:2048 sc1
    global_load_dwordx4 a[28:31], v219, s[78:79] offset:3072 sc1
    v_add_u32 v219, 8192, v1
    global_load_dwordx4 a[32:35], v219, s[78:79] offset:0 sc1
    global_load_dwordx4 a[36:39], v219, s[78:79] offset:1024 sc1
    global_load_dwordx4 a[40:43], v219, s[78:79] offset:2048 sc1
    global_load_dwordx4 a[44:47], v219, s[78:79] offset:3072 sc1
    s_barrier
    ds_read_b64_tr_b16 v[16:17], v6 offset:0
    ds_read_b64_tr_b16 v[18:19], v6 offset:2048
    ds_read_b64_tr_b16 v[20:21], v6 offset:4096
    ds_read_b64_tr_b16 v[22:23], v6 offset:6144
    ds_read_b64_tr_b16 v[24:25], v6 offset:8192
    ds_read_b64_tr_b16 v[26:27], v6 offset:10240
    ds_read_b64_tr_b16 v[28:29], v6 offset:12288
    ds_read_b64_tr_b16 v[30:31], v6 offset:14336
    s_waitcnt lgkmcnt(4)
    s_waitcnt vmcnt(11)
    v_mfma_f32_16x16x32_bf16 v[40:43], v[16:19], a[0:3], 0
    ds_read_b64_tr_b16 v[32:33], v7 offset:0
    v_add_u32 v219, 12288, v1
    s_waitcnt vmcnt(7)
    v_mfma_f32_16x16x32_bf16 v[40:43], v[20:23], a[16:19], v[40:43]
    global_load_dwordx4 a[48:51], v219, s[78:79] offset:0 sc1
    s_waitcnt vmcnt(7)
    v_mfma_f32_16x16x32_bf16 v[44:47], v[20:23], a[20:23], 0
    ds_read_b64_tr_b16 v[34:35], v7 offset:2048
    v_mfma_f32_16x16x32_bf16 v[44:47], v[16:19], a[4:7], v[44:47]
    v_mfma_f32_16x16x32_bf16 v[48:51], v[16:19], a[8:11], 0
    ds_read_b64_tr_b16 v[36:37], v7 offset:4096
    s_waitcnt vmcnt(6)
    v_mfma_f32_16x16x32_bf16 v[48:51], v[20:23], a[24:27], v[48:51]
    global_load_dwordx4 a[52:55], v219, s[78:79] offset:1024 sc1
    s_waitcnt vmcnt(6)
    v_mfma_f32_16x16x32_bf16 v[52:55], v[20:23], a[28:31], 0
    ds_read_b64_tr_b16 v[38:39], v7 offset:6144
    v_mfma_f32_16x16x32_bf16 v[52:55], v[16:19], a[12:15], v[52:55]
    s_waitcnt lgkmcnt(4)
    v_mfma_f32_16x16x32_bf16 v[68:71], v[24:27], a[12:15], 0
    ds_read_b64_tr_b16 v[16:17], v7 offset:8192
    v_mfma_f32_16x16x32_bf16 v[68:71], v[28:31], a[28:31], v[68:71]
    global_load_dwordx4 a[56:59], v219, s[78:79] offset:2048 sc1
    v_mfma_f32_16x16x32_bf16 v[64:67], v[28:31], a[24:27], 0
    ds_read_b64_tr_b16 v[18:19], v7 offset:10240
    v_mfma_f32_16x16x32_bf16 v[64:67], v[24:27], a[8:11], v[64:67]
    v_mfma_f32_16x16x32_bf16 v[60:63], v[24:27], a[4:7], 0
    ds_read_b64_tr_b16 v[20:21], v7 offset:12288
    v_mfma_f32_16x16x32_bf16 v[60:63], v[28:31], a[20:23], v[60:63]
    v_mfma_f32_16x16x32_bf16 v[56:59], v[28:31], a[16:19], 0
    ds_read_b64_tr_b16 v[22:23], v7 offset:14336
    v_mfma_f32_16x16x32_bf16 v[56:59], v[24:27], a[0:3], v[56:59]
    global_load_dwordx4 a[60:63], v219, s[78:79] offset:3072 sc1
    s_waitcnt lgkmcnt(4)
    v_mfma_f32_16x16x32_bf16 v[72:75], v[32:35], a[0:3], 0
    ds_read_b64_tr_b16 v[24:25], v8 offset:0
    s_add_u32 m0, s18, 49152
    v_mfma_f32_16x16x32_bf16 v[72:75], v[36:39], a[16:19], v[72:75]
    v_add_u32 v220, 1769472, v3
    v_mfma_f32_16x16x32_bf16 v[76:79], v[36:39], a[20:23], 0
    ds_read_b64_tr_b16 v[26:27], v8 offset:2048
    v_mfma_f32_16x16x32_bf16 v[76:79], v[32:35], a[4:7], v[76:79]
    global_load_lds_dwordx4 v220, s[72:73]
    v_mfma_f32_16x16x32_bf16 v[80:83], v[32:35], a[8:11], 0
    ds_read_b64_tr_b16 v[28:29], v8 offset:4096
    s_add_u32 m0, s18, 53248
    v_mfma_f32_16x16x32_bf16 v[80:83], v[36:39], a[24:27], v[80:83]
    v_add_u32 v220, 2064384, v3
    v_mfma_f32_16x16x32_bf16 v[84:87], v[36:39], a[28:31], 0
    ds_read_b64_tr_b16 v[30:31], v8 offset:6144
    v_mfma_f32_16x16x32_bf16 v[84:87], v[32:35], a[12:15], v[84:87]
    s_waitcnt lgkmcnt(4)
    v_mfma_f32_16x16x32_bf16 v[100:103], v[16:19], a[12:15], 0
    ds_read_b64_tr_b16 v[32:33], v8 offset:8192
    v_mfma_f32_16x16x32_bf16 v[100:103], v[20:23], a[28:31], v[100:103]
    global_load_lds_dwordx4 v220, s[72:73]
    v_mfma_f32_16x16x32_bf16 v[96:99], v[20:23], a[24:27], 0
    ds_read_b64_tr_b16 v[34:35], v8 offset:10240
    s_add_u32 m0, s18, 57344
    v_mfma_f32_16x16x32_bf16 v[96:99], v[16:19], a[8:11], v[96:99]
    v_add_u32 v220, 1769472, v3
    v_mfma_f32_16x16x32_bf16 v[92:95], v[16:19], a[4:7], 0
    ds_read_b64_tr_b16 v[36:37], v8 offset:12288
    v_mfma_f32_16x16x32_bf16 v[92:95], v[20:23], a[20:23], v[92:95]
    global_load_lds_dwordx4 v220, s[74:75]
    v_mfma_f32_16x16x32_bf16 v[88:91], v[20:23], a[16:19], 0
    ds_read_b64_tr_b16 v[38:39], v8 offset:14336
    s_add_u32 m0, s18, 61440
    v_mfma_f32_16x16x32_bf16 v[88:91], v[16:19], a[0:3], v[88:91]
    v_add_u32 v220, 2064384, v3
    s_waitcnt lgkmcnt(4)
    v_mfma_f32_16x16x32_bf16 v[104:107], v[24:27], a[0:3], 0
    s_barrier
    ds_read_b64_tr_b16 v[16:17], v9 offset:0
    v_mfma_f32_16x16x32_bf16 v[104:107], v[28:31], a[16:19], v[104:107]
    v_mfma_f32_16x16x32_bf16 v[108:111], v[28:31], a[20:23], 0
    ds_read_b64_tr_b16 v[18:19], v9 offset:2048
    v_mfma_f32_16x16x32_bf16 v[108:111], v[24:27], a[4:7], v[108:111]
    global_load_lds_dwordx4 v220, s[74:75]
    v_mfma_f32_16x16x32_bf16 v[112:115], v[24:27], a[8:11], 0
    ds_read_b64_tr_b16 v[20:21], v9 offset:4096
    v_add_u32 v219, 16384, v1
    v_mfma_f32_16x16x32_bf16 v[112:115], v[28:31], a[24:27], v[112:115]
    v_mfma_f32_16x16x32_bf16 v[116:119], v[28:31], a[28:31], 0
    ds_read_b64_tr_b16 v[22:23], v9 offset:6144
    v_mfma_f32_16x16x32_bf16 v[116:119], v[24:27], a[12:15], v[116:119]
    global_load_dwordx4 a[64:67], v219, s[78:79] offset:0 sc1
    s_waitcnt lgkmcnt(4)
    v_mfma_f32_16x16x32_bf16 v[132:135], v[32:35], a[12:15], 0
    ds_read_b64_tr_b16 v[24:25], v9 offset:8192
    v_mfma_f32_16x16x32_bf16 v[132:135], v[36:39], a[28:31], v[132:135]
    v_mfma_f32_16x16x32_bf16 v[128:131], v[36:39], a[24:27], 0
    ds_read_b64_tr_b16 v[26:27], v9 offset:10240
    v_mfma_f32_16x16x32_bf16 v[128:131], v[32:35], a[8:11], v[128:131]
    v_mfma_f32_16x16x32_bf16 v[124:127], v[32:35], a[4:7], 0
    ds_read_b64_tr_b16 v[28:29], v9 offset:12288
    v_mfma_f32_16x16x32_bf16 v[124:127], v[36:39], a[20:23], v[124:127]
    global_load_dwordx4 a[68:71], v219, s[78:79] offset:1024 sc1
    v_mfma_f32_16x16x32_bf16 v[120:123], v[36:39], a[16:19], 0
    ds_read_b64_tr_b16 v[30:31], v9 offset:14336
    v_mfma_f32_16x16x32_bf16 v[120:123], v[32:35], a[0:3], v[120:123]
    s_waitcnt lgkmcnt(4)
    v_mfma_f32_16x16x32_bf16 v[136:139], v[16:19], a[0:3], 0
    ds_read_b64_tr_b16 v[32:33], v6 offset:16384
    v_mfma_f32_16x16x32_bf16 v[136:139], v[20:23], a[16:19], v[136:139]
    global_load_dwordx4 a[72:75], v219, s[78:79] offset:2048 sc1
    v_mfma_f32_16x16x32_bf16 v[140:143], v[20:23], a[20:23], 0
    ds_read_b64_tr_b16 v[34:35], v6 offset:18432
    v_mfma_f32_16x16x32_bf16 v[140:143], v[16:19], a[4:7], v[140:143]
    v_mfma_f32_16x16x32_bf16 v[144:147], v[16:19], a[8:11], 0
    ds_read_b64_tr_b16 v[36:37], v6 offset:20480
    v_mfma_f32_16x16x32_bf16 v[144:147], v[20:23], a[24:27], v[144:147]
    v_mfma_f32_16x16x32_bf16 v[148:151], v[20:23], a[28:31], 0
    ds_read_b64_tr_b16 v[38:39], v6 offset:22528
    v_mfma_f32_16x16x32_bf16 v[148:151], v[16:19], a[12:15], v[148:151]
    global_load_dwordx4 a[76:79], v219, s[78:79] offset:3072 sc1
    s_waitcnt lgkmcnt(4)
    v_mfma_f32_16x16x32_bf16 v[164:167], v[24:27], a[12:15], 0
    ds_read_b64_tr_b16 v[16:17], v6 offset:24576
    v_add_u32 v219, 20480, v1
    v_mfma_f32_16x16x32_bf16 v[164:167], v[28:31], a[28:31], v[164:167]
    v_mfma_f32_16x16x32_bf16 v[160:163], v[28:31], a[24:27], 0
    ds_read_b64_tr_b16 v[18:19], v6 offset:26624
    v_mfma_f32_16x16x32_bf16 v[160:163], v[24:27], a[8:11], v[160:163]
    global_load_dwordx4 a[80:83], v219, s[78:79] offset:0 sc1
    v_mfma_f32_16x16x32_bf16 v[156:159], v[24:27], a[4:7], 0
    ds_read_b64_tr_b16 v[20:21], v6 offset:28672
    v_mfma_f32_16x16x32_bf16 v[156:159], v[28:31], a[20:23], v[156:159]
    v_mfma_f32_16x16x32_bf16 v[152:155], v[28:31], a[16:19], 0
    ds_read_b64_tr_b16 v[22:23], v6 offset:30720
    v_mfma_f32_16x16x32_bf16 v[152:155], v[24:27], a[0:3], v[152:155]
    s_waitcnt vmcnt(9) lgkmcnt(4)
    v_mfma_f32_16x16x32_bf16 v[40:43], v[32:35], a[32:35], v[40:43]
    ds_read_b64_tr_b16 v[24:25], v7 offset:16384
    v_mfma_f32_16x16x32_bf16 v[40:43], v[36:39], a[48:51], v[40:43]
    global_load_dwordx4 a[84:87], v219, s[78:79] offset:1024 sc1
    v_mfma_f32_16x16x32_bf16 v[44:47], v[36:39], a[52:55], v[44:47]
    ds_read_b64_tr_b16 v[26:27], v7 offset:18432
    v_mfma_f32_16x16x32_bf16 v[44:47], v[32:35], a[36:39], v[44:47]
    v_mfma_f32_16x16x32_bf16 v[48:51], v[32:35], a[40:43], v[48:51]
    ds_read_b64_tr_b16 v[28:29], v7 offset:20480
    v_mfma_f32_16x16x32_bf16 v[48:51], v[36:39], a[56:59], v[48:51]
    global_load_dwordx4 a[88:91], v219, s[78:79] offset:2048 sc1
    v_mfma_f32_16x16x32_bf16 v[52:55], v[36:39], a[60:63], v[52:55]
    ds_read_b64_tr_b16 v[30:31], v7 offset:22528
    v_mfma_f32_16x16x32_bf16 v[52:55], v[32:35], a[44:47], v[52:55]
    s_waitcnt lgkmcnt(4)
    v_mfma_f32_16x16x32_bf16 v[68:71], v[16:19], a[44:47], v[68:71]
    ds_read_b64_tr_b16 v[32:33], v7 offset:24576
    v_mfma_f32_16x16x32_bf16 v[68:71], v[20:23], a[60:63], v[68:71]
    v_mfma_f32_16x16x32_bf16 v[64:67], v[20:23], a[56:59], v[64:67]
    ds_read_b64_tr_b16 v[34:35], v7 offset:26624
    v_mfma_f32_16x16x32_bf16 v[64:67], v[16:19], a[40:43], v[64:67]
    global_load_dwordx4 a[92:95], v219, s[78:79] offset:3072 sc1
    v_mfma_f32_16x16x32_bf16 v[60:63], v[16:19], a[36:39], v[60:63]
    ds_read_b64_tr_b16 v[36:37], v7 offset:28672
    s_add_u32 m0, s18, 65536
    v_mfma_f32_16x16x32_bf16 v[60:63], v[20:23], a[52:55], v[60:63]
    v_add_u32 v220, 2359296, v3
    v_mfma_f32_16x16x32_bf16 v[56:59], v[20:23], a[48:51], v[56:59]
    ds_read_b64_tr_b16 v[38:39], v7 offset:30720
    v_mfma_f32_16x16x32_bf16 v[56:59], v[16:19], a[32:35], v[56:59]
    global_load_lds_dwordx4 v220, s[72:73]
    s_waitcnt lgkmcnt(4)
    v_mfma_f32_16x16x32_bf16 v[72:75], v[24:27], a[32:35], v[72:75]
    s_barrier
    ds_read_b64_tr_b16 v[16:17], v8 offset:16384
    v_mfma_f32_16x16x32_bf16 v[72:75], v[28:31], a[48:51], v[72:75]
    s_add_u32 m0, s18, 69632
    v_add_u32 v220, 2654208, v3
    v_mfma_f32_16x16x32_bf16 v[76:79], v[28:31], a[52:55], v[76:79]
    ds_read_b64_tr_b16 v[18:19], v8 offset:18432
    v_mfma_f32_16x16x32_bf16 v[76:79], v[24:27], a[36:39], v[76:79]
    v_mfma_f32_16x16x32_bf16 v[80:83], v[24:27], a[40:43], v[80:83]
    ds_read_b64_tr_b16 v[20:21], v8 offset:20480
    v_mfma_f32_16x16x32_bf16 v[80:83], v[28:31], a[56:59], v[80:83]
    global_load_lds_dwordx4 v220, s[72:73]
    v_mfma_f32_16x16x32_bf16 v[84:87], v[28:31], a[60:63], v[84:87]
    ds_read_b64_tr_b16 v[22:23], v8 offset:22528
    s_add_u32 m0, s18, 73728
    v_mfma_f32_16x16x32_bf16 v[84:87], v[24:27], a[44:47], v[84:87]
    v_add_u32 v220, 2359296, v3
    s_waitcnt lgkmcnt(4)
    v_mfma_f32_16x16x32_bf16 v[100:103], v[32:35], a[44:47], v[100:103]
    ds_read_b64_tr_b16 v[24:25], v8 offset:24576
    v_mfma_f32_16x16x32_bf16 v[100:103], v[36:39], a[60:63], v[100:103]
    global_load_lds_dwordx4 v220, s[74:75]
    v_mfma_f32_16x16x32_bf16 v[96:99], v[36:39], a[56:59], v[96:99]
    ds_read_b64_tr_b16 v[26:27], v8 offset:26624
    s_add_u32 m0, s18, 77824
    v_mfma_f32_16x16x32_bf16 v[96:99], v[32:35], a[40:43], v[96:99]
    v_add_u32 v220, 2654208, v3
    v_mfma_f32_16x16x32_bf16 v[92:95], v[32:35], a[36:39], v[92:95]
    ds_read_b64_tr_b16 v[28:29], v8 offset:28672
    v_mfma_f32_16x16x32_bf16 v[92:95], v[36:39], a[52:55], v[92:95]
    v_mfma_f32_16x16x32_bf16 v[88:91], v[36:39], a[48:51], v[88:91]
    ds_read_b64_tr_b16 v[30:31], v8 offset:30720
    v_mfma_f32_16x16x32_bf16 v[88:91], v[32:35], a[32:35], v[88:91]
    global_load_lds_dwordx4 v220, s[74:75]
PAD_3:
    s_cbranch_execz PAD_6
    s_waitcnt lgkmcnt(4)
    v_mfma_f32_16x16x32_bf16 v[104:107], v[16:19], a[32:35], v[104:107]
    ds_read_b64_tr_b16 v[32:33], v9 offset:16384
    s_add_u32 m0, s18, 81920
    v_mfma_f32_16x16x32_bf16 v[104:107], v[20:23], a[48:51], v[104:107]
    v_add_u32 v220, 2949120, v3
    v_mfma_f32_16x16x32_bf16 v[108:111], v[20:23], a[52:55], v[108:111]
    ds_read_b64_tr_b16 v[34:35], v9 offset:18432
    v_mfma_f32_16x16x32_bf16 v[108:111], v[16:19], a[36:39], v[108:111]
    global_load_lds_dwordx4 v220, s[72:73]
    v_mfma_f32_16x16x32_bf16 v[112:115], v[16:19], a[40:43], v[112:115]
    ds_read_b64_tr_b16 v[36:37], v9 offset:20480
    s_add_u32 m0, s18, 86016
    v_mfma_f32_16x16x32_bf16 v[112:115], v[20:23], a[56:59], v[112:115]
    v_add_u32 v220, 3244032, v3
    v_mfma_f32_16x16x32_bf16 v[116:119], v[20:23], a[60:63], v[116:119]
    ds_read_b64_tr_b16 v[38:39], v9 offset:22528
    v_mfma_f32_16x16x32_bf16 v[116:119], v[16:19], a[44:47], v[116:119]
    s_waitcnt lgkmcnt(4)
    v_mfma_f32_16x16x32_bf16 v[132:135], v[24:27], a[44:47], v[132:135]
    ds_read_b64_tr_b16 v[16:17], v9 offset:24576
    v_mfma_f32_16x16x32_bf16 v[132:135], v[28:31], a[60:63], v[132:135]
    global_load_lds_dwordx4 v220, s[72:73]
    v_mfma_f32_16x16x32_bf16 v[128:131], v[28:31], a[56:59], v[128:131]
    ds_read_b64_tr_b16 v[18:19], v9 offset:26624
    s_add_u32 m0, s18, 90112
    v_mfma_f32_16x16x32_bf16 v[128:131], v[24:27], a[40:43], v[128:131]
    v_add_u32 v220, 2949120, v3
    v_mfma_f32_16x16x32_bf16 v[124:127], v[24:27], a[36:39], v[124:127]
    ds_read_b64_tr_b16 v[20:21], v9 offset:28672
    v_mfma_f32_16x16x32_bf16 v[124:127], v[28:31], a[52:55], v[124:127]
    global_load_lds_dwordx4 v220, s[74:75]
    v_mfma_f32_16x16x32_bf16 v[120:123], v[28:31], a[48:51], v[120:123]
    ds_read_b64_tr_b16 v[22:23], v9 offset:30720
    s_add_u32 m0, s18, 94208
    v_mfma_f32_16x16x32_bf16 v[120:123], v[24:27], a[32:35], v[120:123]
    v_add_u32 v220, 3244032, v3
    s_waitcnt lgkmcnt(4)
    v_mfma_f32_16x16x32_bf16 v[136:139], v[32:35], a[32:35], v[136:139]
    ds_read_b64_tr_b16 v[24:25], v6 offset:32768
    v_mfma_f32_16x16x32_bf16 v[136:139], v[36:39], a[48:51], v[136:139]
    v_mfma_f32_16x16x32_bf16 v[140:143], v[36:39], a[52:55], v[140:143]
    ds_read_b64_tr_b16 v[26:27], v6 offset:34816
    v_mfma_f32_16x16x32_bf16 v[140:143], v[32:35], a[36:39], v[140:143]
    global_load_lds_dwordx4 v220, s[74:75]
    v_mfma_f32_16x16x32_bf16 v[144:147], v[32:35], a[40:43], v[144:147]
    ds_read_b64_tr_b16 v[28:29], v6 offset:36864
    v_add_u32 v219, 24576, v1
    v_mfma_f32_16x16x32_bf16 v[144:147], v[36:39], a[56:59], v[144:147]
    v_mfma_f32_16x16x32_bf16 v[148:151], v[36:39], a[60:63], v[148:151]
    ds_read_b64_tr_b16 v[30:31], v6 offset:38912
    v_mfma_f32_16x16x32_bf16 v[148:151], v[32:35], a[44:47], v[148:151]
    global_load_dwordx4 a[96:99], v219, s[78:79] offset:0 sc1
    s_waitcnt lgkmcnt(4)
    v_mfma_f32_16x16x32_bf16 v[164:167], v[16:19], a[44:47], v[164:167]
    ds_read_b64_tr_b16 v[32:33], v6 offset:40960
    v_mfma_f32_16x16x32_bf16 v[164:167], v[20:23], a[60:63], v[164:167]
    v_mfma_f32_16x16x32_bf16 v[160:163], v[20:23], a[56:59], v[160:163]
    ds_read_b64_tr_b16 v[34:35], v6 offset:43008
    v_mfma_f32_16x16x32_bf16 v[160:163], v[16:19], a[40:43], v[160:163]
    v_mfma_f32_16x16x32_bf16 v[156:159], v[16:19], a[36:39], v[156:159]
    ds_read_b64_tr_b16 v[36:37], v6 offset:45056
    v_mfma_f32_16x16x32_bf16 v[156:159], v[20:23], a[52:55], v[156:159]
    global_load_dwordx4 a[100:103], v219, s[78:79] offset:1024 sc1
    v_mfma_f32_16x16x32_bf16 v[152:155], v[20:23], a[48:51], v[152:155]
    ds_read_b64_tr_b16 v[38:39], v6 offset:47104
    v_mfma_f32_16x16x32_bf16 v[152:155], v[16:19], a[32:35], v[152:155]
    s_waitcnt vmcnt(10) lgkmcnt(4)
    v_mfma_f32_16x16x32_bf16 v[40:43], v[24:27], a[64:67], v[40:43]
    s_barrier
    ds_read_b64_tr_b16 v[16:17], v7 offset:32768
    v_mfma_f32_16x16x32_bf16 v[40:43], v[28:31], a[80:83], v[40:43]
    global_load_dwordx4 a[104:107], v219, s[78:79] offset:2048 sc1
    v_mfma_f32_16x16x32_bf16 v[44:47], v[28:31], a[84:87], v[44:47]
    ds_read_b64_tr_b16 v[18:19], v7 offset:34816
    v_mfma_f32_16x16x32_bf16 v[44:47], v[24:27], a[68:71], v[44:47]
    v_mfma_f32_16x16x32_bf16 v[48:51], v[24:27], a[72:75], v[48:51]
    ds_read_b64_tr_b16 v[20:21], v7 offset:36864
    v_mfma_f32_16x16x32_bf16 v[48:51], v[28:31], a[88:91], v[48:51]
    v_mfma_f32_16x16x32_bf16 v[52:55], v[28:31], a[92:95], v[52:55]
    ds_read_b64_tr_b16 v[22:23], v7 offset:38912
    v_mfma_f32_16x16x32_bf16 v[52:55], v[24:27], a[76:79], v[52:55]
    global_load_dwordx4 a[108:111], v219, s[78:79] offset:3072 sc1
    s_waitcnt lgkmcnt(4)
    v_mfma_f32_16x16x32_bf16 v[68:71], v[32:35], a[76:79], v[68:71]
    ds_read_b64_tr_b16 v[24:25], v7 offset:40960
    v_add_u32 v219, 28672, v1
    v_mfma_f32_16x16x32_bf16 v[68:71], v[36:39], a[92:95], v[68:71]
    v_mfma_f32_16x16x32_bf16 v[64:67], v[36:39], a[88:91], v[64:67]
    ds_read_b64_tr_b16 v[26:27], v7 offset:43008
    v_mfma_f32_16x16x32_bf16 v[64:67], v[32:35], a[72:75], v[64:67]
    global_load_dwordx4 a[112:115], v219, s[78:79] offset:0 sc1
    v_mfma_f32_16x16x32_bf16 v[60:63], v[32:35], a[68:71], v[60:63]
    ds_read_b64_tr_b16 v[28:29], v7 offset:45056
    v_mfma_f32_16x16x32_bf16 v[60:63], v[36:39], a[84:87], v[60:63]
    v_mfma_f32_16x16x32_bf16 v[56:59], v[36:39], a[80:83], v[56:59]
    ds_read_b64_tr_b16 v[30:31], v7 offset:47104
    v_mfma_f32_16x16x32_bf16 v[56:59], v[32:35], a[64:67], v[56:59]
    s_waitcnt lgkmcnt(4)
    v_mfma_f32_16x16x32_bf16 v[72:75], v[16:19], a[64:67], v[72:75]
    ds_read_b64_tr_b16 v[32:33], v8 offset:32768
    v_mfma_f32_16x16x32_bf16 v[72:75], v[20:23], a[80:83], v[72:75]
    global_load_dwordx4 a[116:119], v219, s[78:79] offset:1024 sc1
    v_mfma_f32_16x16x32_bf16 v[76:79], v[20:23], a[84:87], v[76:79]
    ds_read_b64_tr_b16 v[34:35], v8 offset:34816
    v_mfma_f32_16x16x32_bf16 v[76:79], v[16:19], a[68:71], v[76:79]
    v_mfma_f32_16x16x32_bf16 v[80:83], v[16:19], a[72:75], v[80:83]
    ds_read_b64_tr_b16 v[36:37], v8 offset:36864
    v_mfma_f32_16x16x32_bf16 v[80:83], v[20:23], a[88:91], v[80:83]
    global_load_dwordx4 a[120:123], v219, s[78:79] offset:2048 sc1
    v_mfma_f32_16x16x32_bf16 v[84:87], v[20:23], a[92:95], v[84:87]
    ds_read_b64_tr_b16 v[38:39], v8 offset:38912
    v_mfma_f32_16x16x32_bf16 v[84:87], v[16:19], a[76:79], v[84:87]
    s_waitcnt lgkmcnt(4)
    v_mfma_f32_16x16x32_bf16 v[100:103], v[24:27], a[76:79], v[100:103]
    ds_read_b64_tr_b16 v[16:17], v8 offset:40960
    v_mfma_f32_16x16x32_bf16 v[100:103], v[28:31], a[92:95], v[100:103]
    v_mfma_f32_16x16x32_bf16 v[96:99], v[28:31], a[88:91], v[96:99]
    ds_read_b64_tr_b16 v[18:19], v8 offset:43008
    v_mfma_f32_16x16x32_bf16 v[96:99], v[24:27], a[72:75], v[96:99]
    global_load_dwordx4 a[124:127], v219, s[78:79] offset:3072 sc1
    v_mfma_f32_16x16x32_bf16 v[92:95], v[24:27], a[68:71], v[92:95]
    ds_read_b64_tr_b16 v[20:21], v8 offset:45056
    v_add_u32 v219, 32768, v1
    v_mfma_f32_16x16x32_bf16 v[92:95], v[28:31], a[84:87], v[92:95]
    v_mfma_f32_16x16x32_bf16 v[88:91], v[28:31], a[80:83], v[88:91]
    ds_read_b64_tr_b16 v[22:23], v8 offset:47104
    v_mfma_f32_16x16x32_bf16 v[88:91], v[24:27], a[64:67], v[88:91]
    global_load_dwordx4 a[128:131], v219, s[78:79] offset:0 sc1
    s_waitcnt lgkmcnt(4)
    v_mfma_f32_16x16x32_bf16 v[104:107], v[32:35], a[64:67], v[104:107]
    ds_read_b64_tr_b16 v[24:25], v9 offset:32768
    v_mfma_f32_16x16x32_bf16 v[104:107], v[36:39], a[80:83], v[104:107]
    v_mfma_f32_16x16x32_bf16 v[108:111], v[36:39], a[84:87], v[108:111]
    ds_read_b64_tr_b16 v[26:27], v9 offset:34816
    v_mfma_f32_16x16x32_bf16 v[108:111], v[32:35], a[68:71], v[108:111]
    v_mfma_f32_16x16x32_bf16 v[112:115], v[32:35], a[72:75], v[112:115]
    ds_read_b64_tr_b16 v[28:29], v9 offset:36864
    v_mfma_f32_16x16x32_bf16 v[112:115], v[36:39], a[88:91], v[112:115]
    global_load_dwordx4 a[132:135], v219, s[78:79] offset:1024 sc1
    v_mfma_f32_16x16x32_bf16 v[116:119], v[36:39], a[92:95], v[116:119]
    ds_read_b64_tr_b16 v[30:31], v9 offset:38912
    v_mfma_f32_16x16x32_bf16 v[116:119], v[32:35], a[76:79], v[116:119]
    s_waitcnt lgkmcnt(4)
    v_mfma_f32_16x16x32_bf16 v[132:135], v[16:19], a[76:79], v[132:135]
    ds_read_b64_tr_b16 v[32:33], v9 offset:40960
    v_mfma_f32_16x16x32_bf16 v[132:135], v[20:23], a[92:95], v[132:135]
    global_load_dwordx4 a[136:139], v219, s[78:79] offset:2048 sc1
    v_mfma_f32_16x16x32_bf16 v[128:131], v[20:23], a[88:91], v[128:131]
    ds_read_b64_tr_b16 v[34:35], v9 offset:43008
    v_mfma_f32_16x16x32_bf16 v[128:131], v[16:19], a[72:75], v[128:131]
    v_mfma_f32_16x16x32_bf16 v[124:127], v[16:19], a[68:71], v[124:127]
    ds_read_b64_tr_b16 v[36:37], v9 offset:45056
    v_mfma_f32_16x16x32_bf16 v[124:127], v[20:23], a[84:87], v[124:127]
    v_mfma_f32_16x16x32_bf16 v[120:123], v[20:23], a[80:83], v[120:123]
    ds_read_b64_tr_b16 v[38:39], v9 offset:47104
    v_mfma_f32_16x16x32_bf16 v[120:123], v[16:19], a[64:67], v[120:123]
    global_load_dwordx4 a[140:143], v219, s[78:79] offset:3072 sc1
    s_waitcnt lgkmcnt(4)
    v_mfma_f32_16x16x32_bf16 v[136:139], v[24:27], a[64:67], v[136:139]
    s_barrier
    ds_read_b64_tr_b16 v[16:17], v6 offset:49152
    v_mfma_f32_16x16x32_bf16 v[136:139], v[28:31], a[80:83], v[136:139]
    v_add_u32 v219, 36864, v1
    v_mfma_f32_16x16x32_bf16 v[140:143], v[28:31], a[84:87], v[140:143]
    ds_read_b64_tr_b16 v[18:19], v6 offset:51200
    v_mfma_f32_16x16x32_bf16 v[140:143], v[24:27], a[68:71], v[140:143]
    global_load_dwordx4 a[144:147], v219, s[78:79] offset:0 sc1
    v_mfma_f32_16x16x32_bf16 v[144:147], v[24:27], a[72:75], v[144:147]
    ds_read_b64_tr_b16 v[20:21], v6 offset:53248
    v_mfma_f32_16x16x32_bf16 v[144:147], v[28:31], a[88:91], v[144:147]
    v_mfma_f32_16x16x32_bf16 v[148:151], v[28:31], a[92:95], v[148:151]
    ds_read_b64_tr_b16 v[22:23], v6 offset:55296
    v_mfma_f32_16x16x32_bf16 v[148:151], v[24:27], a[76:79], v[148:151]
    s_waitcnt lgkmcnt(4)
    v_mfma_f32_16x16x32_bf16 v[164:167], v[32:35], a[76:79], v[164:167]
    ds_read_b64_tr_b16 v[24:25], v6 offset:57344
    v_mfma_f32_16x16x32_bf16 v[164:167], v[36:39], a[92:95], v[164:167]
    global_load_dwordx4 a[148:151], v219, s[78:79] offset:1024 sc1
    v_mfma_f32_16x16x32_bf16 v[160:163], v[36:39], a[88:91], v[160:163]
    ds_read_b64_tr_b16 v[26:27], v6 offset:59392
    v_mfma_f32_16x16x32_bf16 v[160:163], v[32:35], a[72:75], v[160:163]
    v_mfma_f32_16x16x32_bf16 v[156:159], v[32:35], a[68:71], v[156:159]
    ds_read_b64_tr_b16 v[28:29], v6 offset:61440
    v_mfma_f32_16x16x32_bf16 v[156:159], v[36:39], a[84:87], v[156:159]
    global_load_dwordx4 a[152:155], v219, s[78:79] offset:2048 sc1
    v_mfma_f32_16x16x32_bf16 v[152:155], v[36:39], a[80:83], v[152:155]
    ds_read_b64_tr_b16 v[30:31], v6 offset:63488
    v_mfma_f32_16x16x32_bf16 v[152:155], v[32:35], a[64:67], v[152:155]
    s_waitcnt vmcnt(7) lgkmcnt(4)
    v_mfma_f32_16x16x32_bf16 v[40:43], v[16:19], a[96:99], v[40:43]
    ds_read_b64_tr_b16 v[32:33], v7 offset:49152
    v_mfma_f32_16x16x32_bf16 v[40:43], v[20:23], a[112:115], v[40:43]
    v_mfma_f32_16x16x32_bf16 v[44:47], v[20:23], a[116:119], v[44:47]
    ds_read_b64_tr_b16 v[34:35], v7 offset:51200
    v_mfma_f32_16x16x32_bf16 v[44:47], v[16:19], a[100:103], v[44:47]
    global_load_dwordx4 a[156:159], v219, s[78:79] offset:3072 sc1
    v_mfma_f32_16x16x32_bf16 v[48:51], v[16:19], a[104:107], v[48:51]
    ds_read_b64_tr_b16 v[36:37], v7 offset:53248
    s_add_u32 m0, s18, 98304
    v_mfma_f32_16x16x32_bf16 v[48:51], v[20:23], a[120:123], v[48:51]
    v_add_u32 v220, 3538944, v3
    v_mfma_f32_16x16x32_bf16 v[52:55], v[20:23], a[124:127], v[52:55]
    ds_read_b64_tr_b16 v[38:39], v7 offset:55296
    v_mfma_f32_16x16x32_bf16 v[52:55], v[16:19], a[108:111], v[52:55]
    global_load_lds_dwordx4 v220, s[72:73]
    s_waitcnt lgkmcnt(4)
    v_mfma_f32_16x16x32_bf16 v[68:71], v[24:27], a[108:111], v[68:71]
    ds_read_b64_tr_b16 v[16:17], v7 offset:57344
    s_add_u32 m0, s18, 102400
    v_mfma_f32_16x16x32_bf16 v[68:71], v[28:31], a[124:127], v[68:71]
    v_add_u32 v220, 3833856, v3
    v_mfma_f32_16x16x32_bf16 v[64:67], v[28:31], a[120:123], v[64:67]
    ds_read_b64_tr_b16 v[18:19], v7 offset:59392
    v_mfma_f32_16x16x32_bf16 v[64:67], v[24:27], a[104:107], v[64:67]
    v_mfma_f32_16x16x32_bf16 v[60:63], v[24:27], a[100:103], v[60:63]
    ds_read_b64_tr_b16 v[20:21], v7 offset:61440
    v_mfma_f32_16x16x32_bf16 v[60:63], v[28:31], a[116:119], v[60:63]
    global_load_lds_dwordx4 v220, s[72:73]
    v_mfma_f32_16x16x32_bf16 v[56:59], v[28:31], a[112:115], v[56:59]
    ds_read_b64_tr_b16 v[22:23], v7 offset:63488
    s_add_u32 m0, s18, 106496
    v_mfma_f32_16x16x32_bf16 v[56:59], v[24:27], a[96:99], v[56:59]
    v_add_u32 v220, 3538944, v3
    s_waitcnt lgkmcnt(4)
    v_mfma_f32_16x16x32_bf16 v[72:75], v[32:35], a[96:99], v[72:75]
    ds_read_b64_tr_b16 v[24:25], v8 offset:49152
    v_mfma_f32_16x16x32_bf16 v[72:75], v[36:39], a[112:115], v[72:75]
    global_load_lds_dwordx4 v220, s[74:75]
    v_mfma_f32_16x16x32_bf16 v[76:79], v[36:39], a[116:119], v[76:79]
    ds_read_b64_tr_b16 v[26:27], v8 offset:51200
    s_add_u32 m0, s18, 110592
    v_mfma_f32_16x16x32_bf16 v[76:79], v[32:35], a[100:103], v[76:79]
    v_add_u32 v220, 3833856, v3
    v_mfma_f32_16x16x32_bf16 v[80:83], v[32:35], a[104:107], v[80:83]
    ds_read_b64_tr_b16 v[28:29], v8 offset:53248
    v_mfma_f32_16x16x32_bf16 v[80:83], v[36:39], a[120:123], v[80:83]
    v_mfma_f32_16x16x32_bf16 v[84:87], v[36:39], a[124:127], v[84:87]
    ds_read_b64_tr_b16 v[30:31], v8 offset:55296
    v_mfma_f32_16x16x32_bf16 v[84:87], v[32:35], a[108:111], v[84:87]
    global_load_lds_dwordx4 v220, s[74:75]
    s_waitcnt lgkmcnt(4)
    v_mfma_f32_16x16x32_bf16 v[100:103], v[16:19], a[108:111], v[100:103]
    ds_read_b64_tr_b16 v[32:33], v8 offset:57344
    v_add_u32 v219, 40960, v1
    v_mfma_f32_16x16x32_bf16 v[100:103], v[20:23], a[124:127], v[100:103]
    v_mfma_f32_16x16x32_bf16 v[96:99], v[20:23], a[120:123], v[96:99]
    ds_read_b64_tr_b16 v[34:35], v8 offset:59392
    v_mfma_f32_16x16x32_bf16 v[96:99], v[16:19], a[104:107], v[96:99]
    global_load_dwordx4 a[160:163], v219, s[78:79] offset:0 sc1
    v_mfma_f32_16x16x32_bf16 v[92:95], v[16:19], a[100:103], v[92:95]
    ds_read_b64_tr_b16 v[36:37], v8 offset:61440
    v_mfma_f32_16x16x32_bf16 v[92:95], v[20:23], a[116:119], v[92:95]
    v_mfma_f32_16x16x32_bf16 v[88:91], v[20:23], a[112:115], v[88:91]
    ds_read_b64_tr_b16 v[38:39], v8 offset:63488
    v_mfma_f32_16x16x32_bf16 v[88:91], v[16:19], a[96:99], v[88:91]
    s_waitcnt lgkmcnt(4)
    v_mfma_f32_16x16x32_bf16 v[104:107], v[24:27], a[96:99], v[104:107]
    s_barrier
    ds_read_b64_tr_b16 v[16:17], v9 offset:49152
    v_mfma_f32_16x16x32_bf16 v[104:107], v[28:31], a[112:115], v[104:107]
    global_load_dwordx4 a[164:167], v219, s[78:79] offset:1024 sc1
    v_mfma_f32_16x16x32_bf16 v[108:111], v[28:31], a[116:119], v[108:111]
    ds_read_b64_tr_b16 v[18:19], v9 offset:51200
    v_mfma_f32_16x16x32_bf16 v[108:111], v[24:27], a[100:103], v[108:111]
    v_mfma_f32_16x16x32_bf16 v[112:115], v[24:27], a[104:107], v[112:115]
    ds_read_b64_tr_b16 v[20:21], v9 offset:53248
    v_mfma_f32_16x16x32_bf16 v[112:115], v[28:31], a[120:123], v[112:115]
    global_load_dwordx4 a[168:171], v219, s[78:79] offset:2048 sc1
    v_mfma_f32_16x16x32_bf16 v[116:119], v[28:31], a[124:127], v[116:119]
    ds_read_b64_tr_b16 v[22:23], v9 offset:55296
    v_mfma_f32_16x16x32_bf16 v[116:119], v[24:27], a[108:111], v[116:119]
    s_waitcnt lgkmcnt(4)
    v_mfma_f32_16x16x32_bf16 v[132:135], v[32:35], a[108:111], v[132:135]
    ds_read_b64_tr_b16 v[24:25], v9 offset:57344
    v_mfma_f32_16x16x32_bf16 v[132:135], v[36:39], a[124:127], v[132:135]
    v_mfma_f32_16x16x32_bf16 v[128:131], v[36:39], a[120:123], v[128:131]
    ds_read_b64_tr_b16 v[26:27], v9 offset:59392
    v_mfma_f32_16x16x32_bf16 v[128:131], v[32:35], a[104:107], v[128:131]
    global_load_dwordx4 a[172:175], v219, s[78:79] offset:3072 sc1
    v_mfma_f32_16x16x32_bf16 v[124:127], v[32:35], a[100:103], v[124:127]
    ds_read_b64_tr_b16 v[28:29], v9 offset:61440
    v_add_u32 v219, 45056, v1
    v_mfma_f32_16x16x32_bf16 v[124:127], v[36:39], a[116:119], v[124:127]
    v_mfma_f32_16x16x32_bf16 v[120:123], v[36:39], a[112:115], v[120:123]
    ds_read_b64_tr_b16 v[30:31], v9 offset:63488
    v_mfma_f32_16x16x32_bf16 v[120:123], v[32:35], a[96:99], v[120:123]
    global_load_dwordx4 a[176:179], v219, s[78:79] offset:0 sc1
    s_waitcnt lgkmcnt(4)
    v_mfma_f32_16x16x32_bf16 v[136:139], v[16:19], a[96:99], v[136:139]
    ds_read_b64_tr_b16 v[32:33], v11 offset:0
    v_mfma_f32_16x16x32_bf16 v[136:139], v[20:23], a[112:115], v[136:139]
    v_mfma_f32_16x16x32_bf16 v[140:143], v[20:23], a[116:119], v[140:143]
    ds_read_b64_tr_b16 v[34:35], v11 offset:2048
    v_mfma_f32_16x16x32_bf16 v[140:143], v[16:19], a[100:103], v[140:143]
    v_mfma_f32_16x16x32_bf16 v[144:147], v[16:19], a[104:107], v[144:147]
    ds_read_b64_tr_b16 v[36:37], v11 offset:4096
    v_mfma_f32_16x16x32_bf16 v[144:147], v[20:23], a[120:123], v[144:147]
    global_load_dwordx4 a[180:183], v219, s[78:79] offset:1024 sc1
    v_mfma_f32_16x16x32_bf16 v[148:151], v[20:23], a[124:127], v[148:151]
    ds_read_b64_tr_b16 v[38:39], v11 offset:6144
    v_mfma_f32_16x16x32_bf16 v[148:151], v[16:19], a[108:111], v[148:151]
    s_waitcnt lgkmcnt(4)
    v_mfma_f32_16x16x32_bf16 v[164:167], v[24:27], a[108:111], v[164:167]
    ds_read_b64_tr_b16 v[16:17], v11 offset:8192
    v_mfma_f32_16x16x32_bf16 v[164:167], v[28:31], a[124:127], v[164:167]
    global_load_dwordx4 a[184:187], v219, s[78:79] offset:2048 sc1
    v_mfma_f32_16x16x32_bf16 v[160:163], v[28:31], a[120:123], v[160:163]
    ds_read_b64_tr_b16 v[18:19], v11 offset:10240
    v_mfma_f32_16x16x32_bf16 v[160:163], v[24:27], a[104:107], v[160:163]
    v_mfma_f32_16x16x32_bf16 v[156:159], v[24:27], a[100:103], v[156:159]
    ds_read_b64_tr_b16 v[20:21], v11 offset:12288
    v_mfma_f32_16x16x32_bf16 v[156:159], v[28:31], a[116:119], v[156:159]
    v_mfma_f32_16x16x32_bf16 v[152:155], v[28:31], a[112:115], v[152:155]
    ds_read_b64_tr_b16 v[22:23], v11 offset:14336
    v_mfma_f32_16x16x32_bf16 v[152:155], v[24:27], a[96:99], v[152:155]
    global_load_dwordx4 a[188:191], v219, s[78:79] offset:3072 sc1
    s_waitcnt vmcnt(12) lgkmcnt(4)
    v_mfma_f32_16x16x32_bf16 v[40:43], v[32:35], a[128:131], v[40:43]
    ds_read_b64_tr_b16 v[24:25], v12 offset:0
    s_add_u32 m0, s18, 114688
    v_mfma_f32_16x16x32_bf16 v[40:43], v[36:39], a[144:147], v[40:43]
    v_add_u32 v220, 4128768, v3
    v_mfma_f32_16x16x32_bf16 v[44:47], v[36:39], a[148:151], v[44:47]
    ds_read_b64_tr_b16 v[26:27], v12 offset:2048
    v_mfma_f32_16x16x32_bf16 v[44:47], v[32:35], a[132:135], v[44:47]
    global_load_lds_dwordx4 v220, s[72:73]
    v_mfma_f32_16x16x32_bf16 v[48:51], v[32:35], a[136:139], v[48:51]
    ds_read_b64_tr_b16 v[28:29], v12 offset:4096
    s_add_u32 m0, s18, 118784
    v_mfma_f32_16x16x32_bf16 v[48:51], v[36:39], a[152:155], v[48:51]
    v_add_u32 v220, 4423680, v3
    v_mfma_f32_16x16x32_bf16 v[52:55], v[36:39], a[156:159], v[52:55]
    ds_read_b64_tr_b16 v[30:31], v12 offset:6144
    v_mfma_f32_16x16x32_bf16 v[52:55], v[32:35], a[140:143], v[52:55]
    s_waitcnt lgkmcnt(4)
    v_mfma_f32_16x16x32_bf16 v[68:71], v[16:19], a[140:143], v[68:71]
    ds_read_b64_tr_b16 v[32:33], v12 offset:8192
    v_mfma_f32_16x16x32_bf16 v[68:71], v[20:23], a[156:159], v[68:71]
    global_load_lds_dwordx4 v220, s[72:73]
    v_mfma_f32_16x16x32_bf16 v[64:67], v[20:23], a[152:155], v[64:67]
    ds_read_b64_tr_b16 v[34:35], v12 offset:10240
    s_add_u32 m0, s18, 122880
    v_mfma_f32_16x16x32_bf16 v[64:67], v[16:19], a[136:139], v[64:67]
    v_add_u32 v220, 4128768, v3
    v_mfma_f32_16x16x32_bf16 v[60:63], v[16:19], a[132:135], v[60:63]
    ds_read_b64_tr_b16 v[36:37], v12 offset:12288
    v_mfma_f32_16x16x32_bf16 v[60:63], v[20:23], a[148:151], v[60:63]
    global_load_lds_dwordx4 v220, s[74:75]
    v_mfma_f32_16x16x32_bf16 v[56:59], v[20:23], a[144:147], v[56:59]
    ds_read_b64_tr_b16 v[38:39], v12 offset:14336
    s_add_u32 m0, s18, 126976
    v_mfma_f32_16x16x32_bf16 v[56:59], v[16:19], a[128:131], v[56:59]
    v_add_u32 v220, 4423680, v3
    s_waitcnt lgkmcnt(4)
    v_mfma_f32_16x16x32_bf16 v[72:75], v[24:27], a[128:131], v[72:75]
    s_barrier
    ds_read_b64_tr_b16 v[16:17], v13 offset:0
    v_mfma_f32_16x16x32_bf16 v[72:75], v[28:31], a[144:147], v[72:75]
    v_mfma_f32_16x16x32_bf16 v[76:79], v[28:31], a[148:151], v[76:79]
    ds_read_b64_tr_b16 v[18:19], v13 offset:2048
    v_mfma_f32_16x16x32_bf16 v[76:79], v[24:27], a[132:135], v[76:79]
    global_load_lds_dwordx4 v220, s[74:75]
    v_mfma_f32_16x16x32_bf16 v[80:83], v[24:27], a[136:139], v[80:83]
    ds_read_b64_tr_b16 v[20:21], v13 offset:4096
    s_add_u32 m0, s18, 0
    v_mfma_f32_16x16x32_bf16 v[80:83], v[28:31], a[152:155], v[80:83]
    v_add_u32 v220, 4718592, v3
    v_mfma_f32_16x16x32_bf16 v[84:87], v[28:31], a[156:159], v[84:87]
    ds_read_b64_tr_b16 v[22:23], v13 offset:6144
    v_mfma_f32_16x16x32_bf16 v[84:87], v[24:27], a[140:143], v[84:87]
    global_load_lds_dwordx4 v220, s[72:73]
    s_waitcnt lgkmcnt(4)
    v_mfma_f32_16x16x32_bf16 v[100:103], v[32:35], a[140:143], v[100:103]
    ds_read_b64_tr_b16 v[24:25], v13 offset:8192
    s_add_u32 m0, s18, 4096
    v_mfma_f32_16x16x32_bf16 v[100:103], v[36:39], a[156:159], v[100:103]
    v_add_u32 v220, 5013504, v3
    v_mfma_f32_16x16x32_bf16 v[96:99], v[36:39], a[152:155], v[96:99]
    ds_read_b64_tr_b16 v[26:27], v13 offset:10240
    v_mfma_f32_16x16x32_bf16 v[96:99], v[32:35], a[136:139], v[96:99]
    v_mfma_f32_16x16x32_bf16 v[92:95], v[32:35], a[132:135], v[92:95]
    ds_read_b64_tr_b16 v[28:29], v13 offset:12288
    v_mfma_f32_16x16x32_bf16 v[92:95], v[36:39], a[148:151], v[92:95]
    global_load_lds_dwordx4 v220, s[72:73]
    v_mfma_f32_16x16x32_bf16 v[88:91], v[36:39], a[144:147], v[88:91]
    ds_read_b64_tr_b16 v[30:31], v13 offset:14336
    s_add_u32 m0, s18, 8192
    v_mfma_f32_16x16x32_bf16 v[88:91], v[32:35], a[128:131], v[88:91]
    v_add_u32 v220, 4718592, v3
    s_waitcnt lgkmcnt(4)
    v_mfma_f32_16x16x32_bf16 v[104:107], v[16:19], a[128:131], v[104:107]
    ds_read_b64_tr_b16 v[32:33], v14 offset:0
    v_mfma_f32_16x16x32_bf16 v[104:107], v[20:23], a[144:147], v[104:107]
    global_load_lds_dwordx4 v220, s[74:75]
    v_mfma_f32_16x16x32_bf16 v[108:111], v[20:23], a[148:151], v[108:111]
    ds_read_b64_tr_b16 v[34:35], v14 offset:2048
    s_add_u32 m0, s18, 12288
    v_mfma_f32_16x16x32_bf16 v[108:111], v[16:19], a[132:135], v[108:111]
    v_add_u32 v220, 5013504, v3
    v_mfma_f32_16x16x32_bf16 v[112:115], v[16:19], a[136:139], v[112:115]
    ds_read_b64_tr_b16 v[36:37], v14 offset:4096
    v_mfma_f32_16x16x32_bf16 v[112:115], v[20:23], a[152:155], v[112:115]
    v_mfma_f32_16x16x32_bf16 v[116:119], v[20:23], a[156:159], v[116:119]
    ds_read_b64_tr_b16 v[38:39], v14 offset:6144
    v_mfma_f32_16x16x32_bf16 v[116:119], v[16:19], a[140:143], v[116:119]
    global_load_lds_dwordx4 v220, s[74:75]
    s_waitcnt lgkmcnt(4)
    v_mfma_f32_16x16x32_bf16 v[132:135], v[24:27], a[140:143], v[132:135]
    ds_read_b64_tr_b16 v[16:17], v14 offset:8192
    v_add_u32 v219, 49152, v1
    v_mfma_f32_16x16x32_bf16 v[132:135], v[28:31], a[156:159], v[132:135]
    v_mfma_f32_16x16x32_bf16 v[128:131], v[28:31], a[152:155], v[128:131]
    ds_read_b64_tr_b16 v[18:19], v14 offset:10240
    v_mfma_f32_16x16x32_bf16 v[128:131], v[24:27], a[136:139], v[128:131]
    global_load_dwordx4 a[192:195], v219, s[78:79] offset:0 sc1
    v_mfma_f32_16x16x32_bf16 v[124:127], v[24:27], a[132:135], v[124:127]
    ds_read_b64_tr_b16 v[20:21], v14 offset:12288
    v_mfma_f32_16x16x32_bf16 v[124:127], v[28:31], a[148:151], v[124:127]
    v_mfma_f32_16x16x32_bf16 v[120:123], v[28:31], a[144:147], v[120:123]
    ds_read_b64_tr_b16 v[22:23], v14 offset:14336
    v_mfma_f32_16x16x32_bf16 v[120:123], v[24:27], a[128:131], v[120:123]
    s_waitcnt lgkmcnt(4)
    v_mfma_f32_16x16x32_bf16 v[136:139], v[32:35], a[128:131], v[136:139]
    ds_read_b64_tr_b16 v[24:25], v11 offset:16384
    v_mfma_f32_16x16x32_bf16 v[136:139], v[36:39], a[144:147], v[136:139]
    global_load_dwordx4 a[196:199], v219, s[78:79] offset:1024 sc1
    v_mfma_f32_16x16x32_bf16 v[140:143], v[36:39], a[148:151], v[140:143]
    ds_read_b64_tr_b16 v[26:27], v11 offset:18432
    v_mfma_f32_16x16x32_bf16 v[140:143], v[32:35], a[132:135], v[140:143]
    v_mfma_f32_16x16x32_bf16 v[144:147], v[32:35], a[136:139], v[144:147]
    ds_read_b64_tr_b16 v[28:29], v11 offset:20480
    v_mfma_f32_16x16x32_bf16 v[144:147], v[36:39], a[152:155], v[144:147]
    global_load_dwordx4 a[200:203], v219, s[78:79] offset:2048 sc1
    v_mfma_f32_16x16x32_bf16 v[148:151], v[36:39], a[156:159], v[148:151]
    ds_read_b64_tr_b16 v[30:31], v11 offset:22528
    v_mfma_f32_16x16x32_bf16 v[148:151], v[32:35], a[140:143], v[148:151]
    s_waitcnt lgkmcnt(4)
    v_mfma_f32_16x16x32_bf16 v[164:167], v[16:19], a[140:143], v[164:167]
    ds_read_b64_tr_b16 v[32:33], v11 offset:24576
    v_mfma_f32_16x16x32_bf16 v[164:167], v[20:23], a[156:159], v[164:167]
    v_mfma_f32_16x16x32_bf16 v[160:163], v[20:23], a[152:155], v[160:163]
    ds_read_b64_tr_b16 v[34:35], v11 offset:26624
    v_mfma_f32_16x16x32_bf16 v[160:163], v[16:19], a[136:139], v[160:163]
    global_load_dwordx4 a[204:207], v219, s[78:79] offset:3072 sc1
    v_mfma_f32_16x16x32_bf16 v[156:159], v[16:19], a[132:135], v[156:159]
    ds_read_b64_tr_b16 v[36:37], v11 offset:28672
    v_add_u32 v219, 53248, v1
    v_mfma_f32_16x16x32_bf16 v[156:159], v[20:23], a[148:151], v[156:159]
    v_mfma_f32_16x16x32_bf16 v[152:155], v[20:23], a[144:147], v[152:155]
    ds_read_b64_tr_b16 v[38:39], v11 offset:30720
    v_mfma_f32_16x16x32_bf16 v[152:155], v[16:19], a[128:131], v[152:155]
    global_load_dwordx4 a[208:211], v219, s[78:79] offset:0 sc1
    s_waitcnt vmcnt(13) lgkmcnt(4)
    v_mfma_f32_16x16x32_bf16 v[40:43], v[24:27], a[160:163], v[40:43]
    s_barrier
    ds_read_b64_tr_b16 v[16:17], v12 offset:16384
    v_mfma_f32_16x16x32_bf16 v[40:43], v[28:31], a[176:179], v[40:43]
    v_mfma_f32_16x16x32_bf16 v[44:47], v[28:31], a[180:183], v[44:47]
    ds_read_b64_tr_b16 v[18:19], v12 offset:18432
    v_mfma_f32_16x16x32_bf16 v[44:47], v[24:27], a[164:167], v[44:47]
    v_mfma_f32_16x16x32_bf16 v[48:51], v[24:27], a[168:171], v[48:51]
    ds_read_b64_tr_b16 v[20:21], v12 offset:20480
    v_mfma_f32_16x16x32_bf16 v[48:51], v[28:31], a[184:187], v[48:51]
    global_load_dwordx4 a[212:215], v219, s[78:79] offset:1024 sc1
    v_mfma_f32_16x16x32_bf16 v[52:55], v[28:31], a[188:191], v[52:55]
    ds_read_b64_tr_b16 v[22:23], v12 offset:22528
    v_mfma_f32_16x16x32_bf16 v[52:55], v[24:27], a[172:175], v[52:55]
    s_waitcnt lgkmcnt(4)
    v_mfma_f32_16x16x32_bf16 v[68:71], v[32:35], a[172:175], v[68:71]
    ds_read_b64_tr_b16 v[24:25], v12 offset:24576
    v_mfma_f32_16x16x32_bf16 v[68:71], v[36:39], a[188:191], v[68:71]
    global_load_dwordx4 a[216:219], v219, s[78:79] offset:2048 sc1
    v_mfma_f32_16x16x32_bf16 v[64:67], v[36:39], a[184:187], v[64:67]
    ds_read_b64_tr_b16 v[26:27], v12 offset:26624
    v_mfma_f32_16x16x32_bf16 v[64:67], v[32:35], a[168:171], v[64:67]
    v_mfma_f32_16x16x32_bf16 v[60:63], v[32:35], a[164:167], v[60:63]
    ds_read_b64_tr_b16 v[28:29], v12 offset:28672
    v_mfma_f32_16x16x32_bf16 v[60:63], v[36:39], a[180:183], v[60:63]
    v_mfma_f32_16x16x32_bf16 v[56:59], v[36:39], a[176:179], v[56:59]
    ds_read_b64_tr_b16 v[30:31], v12 offset:30720
    v_mfma_f32_16x16x32_bf16 v[56:59], v[32:35], a[160:163], v[56:59]
    global_load_dwordx4 a[220:223], v219, s[78:79] offset:3072 sc1
    s_waitcnt lgkmcnt(4)
    v_mfma_f32_16x16x32_bf16 v[72:75], v[16:19], a[160:163], v[72:75]
    ds_read_b64_tr_b16 v[32:33], v13 offset:16384
    v_add_u32 v219, 57344, v1
    v_mfma_f32_16x16x32_bf16 v[72:75], v[20:23], a[176:179], v[72:75]
    v_mfma_f32_16x16x32_bf16 v[76:79], v[20:23], a[180:183], v[76:79]
    ds_read_b64_tr_b16 v[34:35], v13 offset:18432
    v_mfma_f32_16x16x32_bf16 v[76:79], v[16:19], a[164:167], v[76:79]
    global_load_dwordx4 a[224:227], v219, s[78:79] offset:0 sc1
    v_mfma_f32_16x16x32_bf16 v[80:83], v[16:19], a[168:171], v[80:83]
    ds_read_b64_tr_b16 v[36:37], v13 offset:20480
    v_mfma_f32_16x16x32_bf16 v[80:83], v[20:23], a[184:187], v[80:83]
    v_mfma_f32_16x16x32_bf16 v[84:87], v[20:23], a[188:191], v[84:87]
    ds_read_b64_tr_b16 v[38:39], v13 offset:22528
    v_mfma_f32_16x16x32_bf16 v[84:87], v[16:19], a[172:175], v[84:87]
    s_waitcnt lgkmcnt(4)
    v_mfma_f32_16x16x32_bf16 v[100:103], v[24:27], a[172:175], v[100:103]
    ds_read_b64_tr_b16 v[16:17], v13 offset:24576
    v_mfma_f32_16x16x32_bf16 v[100:103], v[28:31], a[188:191], v[100:103]
    global_load_dwordx4 a[228:231], v219, s[78:79] offset:1024 sc1
    v_mfma_f32_16x16x32_bf16 v[96:99], v[28:31], a[184:187], v[96:99]
    ds_read_b64_tr_b16 v[18:19], v13 offset:26624
    v_mfma_f32_16x16x32_bf16 v[96:99], v[24:27], a[168:171], v[96:99]
    v_mfma_f32_16x16x32_bf16 v[92:95], v[24:27], a[164:167], v[92:95]
    ds_read_b64_tr_b16 v[20:21], v13 offset:28672
    v_mfma_f32_16x16x32_bf16 v[92:95], v[28:31], a[180:183], v[92:95]
    global_load_dwordx4 a[232:235], v219, s[78:79] offset:2048 sc1
    v_mfma_f32_16x16x32_bf16 v[88:91], v[28:31], a[176:179], v[88:91]
    ds_read_b64_tr_b16 v[22:23], v13 offset:30720
    v_mfma_f32_16x16x32_bf16 v[88:91], v[24:27], a[160:163], v[88:91]
    s_waitcnt lgkmcnt(4)
    v_mfma_f32_16x16x32_bf16 v[104:107], v[32:35], a[160:163], v[104:107]
    ds_read_b64_tr_b16 v[24:25], v14 offset:16384
    v_mfma_f32_16x16x32_bf16 v[104:107], v[36:39], a[176:179], v[104:107]
    v_mfma_f32_16x16x32_bf16 v[108:111], v[36:39], a[180:183], v[108:111]
    ds_read_b64_tr_b16 v[26:27], v14 offset:18432
    v_mfma_f32_16x16x32_bf16 v[108:111], v[32:35], a[164:167], v[108:111]
    global_load_dwordx4 a[236:239], v219, s[78:79] offset:3072 sc1
    v_mfma_f32_16x16x32_bf16 v[112:115], v[32:35], a[168:171], v[112:115]
    ds_read_b64_tr_b16 v[28:29], v14 offset:20480
    v_add_u32 v219, 61440, v1
    v_mfma_f32_16x16x32_bf16 v[112:115], v[36:39], a[184:187], v[112:115]
    v_mfma_f32_16x16x32_bf16 v[116:119], v[36:39], a[188:191], v[116:119]
    ds_read_b64_tr_b16 v[30:31], v14 offset:22528
    v_mfma_f32_16x16x32_bf16 v[116:119], v[32:35], a[172:175], v[116:119]
    global_load_dwordx4 a[240:243], v219, s[78:79] offset:0 sc1
    s_waitcnt lgkmcnt(4)
    v_mfma_f32_16x16x32_bf16 v[132:135], v[16:19], a[172:175], v[132:135]
PAD_4:
    s_cbranch_execz PAD_7
    ds_read_b64_tr_b16 v[32:33], v14 offset:24576
    v_mfma_f32_16x16x32_bf16 v[132:135], v[20:23], a[188:191], v[132:135]
    v_mfma_f32_16x16x32_bf16 v[128:131], v[20:23], a[184:187], v[128:131]
    ds_read_b64_tr_b16 v[34:35], v14 offset:26624
    v_mfma_f32_16x16x32_bf16 v[128:131], v[16:19], a[168:171], v[128:131]
    v_mfma_f32_16x16x32_bf16 v[124:127], v[16:19], a[164:167], v[124:127]
    ds_read_b64_tr_b16 v[36:37], v14 offset:28672
    v_mfma_f32_16x16x32_bf16 v[124:127], v[20:23], a[180:183], v[124:127]
    global_load_dwordx4 a[244:247], v219, s[78:79] offset:1024 sc1
    v_mfma_f32_16x16x32_bf16 v[120:123], v[20:23], a[176:179], v[120:123]
    ds_read_b64_tr_b16 v[38:39], v14 offset:30720
    v_mfma_f32_16x16x32_bf16 v[120:123], v[16:19], a[160:163], v[120:123]
    s_waitcnt lgkmcnt(4)
    v_mfma_f32_16x16x32_bf16 v[136:139], v[24:27], a[160:163], v[136:139]
    s_barrier
    ds_read_b64_tr_b16 v[16:17], v11 offset:32768
    v_mfma_f32_16x16x32_bf16 v[136:139], v[28:31], a[176:179], v[136:139]
    global_load_dwordx4 a[248:251], v219, s[78:79] offset:2048 sc1
    v_mfma_f32_16x16x32_bf16 v[140:143], v[28:31], a[180:183], v[140:143]
    ds_read_b64_tr_b16 v[18:19], v11 offset:34816
    v_mfma_f32_16x16x32_bf16 v[140:143], v[24:27], a[164:167], v[140:143]
    v_mfma_f32_16x16x32_bf16 v[144:147], v[24:27], a[168:171], v[144:147]
    ds_read_b64_tr_b16 v[20:21], v11 offset:36864
    v_mfma_f32_16x16x32_bf16 v[144:147], v[28:31], a[184:187], v[144:147]
    v_mfma_f32_16x16x32_bf16 v[148:151], v[28:31], a[188:191], v[148:151]
    ds_read_b64_tr_b16 v[22:23], v11 offset:38912
    v_mfma_f32_16x16x32_bf16 v[148:151], v[24:27], a[172:175], v[148:151]
    global_load_dwordx4 a[252:255], v219, s[78:79] offset:3072 sc1
    s_waitcnt lgkmcnt(4)
    v_mfma_f32_16x16x32_bf16 v[164:167], v[32:35], a[172:175], v[164:167]
    ds_read_b64_tr_b16 v[24:25], v11 offset:40960
    s_add_u32 m0, s18, 16384
    v_mfma_f32_16x16x32_bf16 v[164:167], v[36:39], a[188:191], v[164:167]
    v_add_u32 v220, 0, v1
    v_mfma_f32_16x16x32_bf16 v[160:163], v[36:39], a[184:187], v[160:163]
    ds_read_b64_tr_b16 v[26:27], v11 offset:43008
    v_mfma_f32_16x16x32_bf16 v[160:163], v[32:35], a[168:171], v[160:163]
    global_load_lds_dwordx4 v220, s[84:85] sc1
    v_mfma_f32_16x16x32_bf16 v[156:159], v[32:35], a[164:167], v[156:159]
    ds_read_b64_tr_b16 v[28:29], v11 offset:45056
    s_add_u32 m0, s18, 20480
    v_mfma_f32_16x16x32_bf16 v[156:159], v[36:39], a[180:183], v[156:159]
    v_add_u32 v220, 2048, v1
    v_mfma_f32_16x16x32_bf16 v[152:155], v[36:39], a[176:179], v[152:155]
    ds_read_b64_tr_b16 v[30:31], v11 offset:47104
    v_mfma_f32_16x16x32_bf16 v[152:155], v[32:35], a[160:163], v[152:155]
    s_waitcnt vmcnt(9) lgkmcnt(4)
    v_mfma_f32_16x16x32_bf16 v[40:43], v[16:19], a[192:195], v[40:43]
    ds_read_b64_tr_b16 v[32:33], v12 offset:32768
    v_mfma_f32_16x16x32_bf16 v[40:43], v[20:23], a[208:211], v[40:43]
    global_load_lds_dwordx4 v220, s[84:85] sc1
    v_mfma_f32_16x16x32_bf16 v[44:47], v[20:23], a[212:215], v[44:47]
    ds_read_b64_tr_b16 v[34:35], v12 offset:34816
    s_add_u32 m0, s18, 24576
    v_mfma_f32_16x16x32_bf16 v[44:47], v[16:19], a[196:199], v[44:47]
    v_add_u32 v220, 4096, v1
    v_mfma_f32_16x16x32_bf16 v[48:51], v[16:19], a[200:203], v[48:51]
    ds_read_b64_tr_b16 v[36:37], v12 offset:36864
    v_mfma_f32_16x16x32_bf16 v[48:51], v[20:23], a[216:219], v[48:51]
    global_load_lds_dwordx4 v220, s[84:85] sc1
    v_mfma_f32_16x16x32_bf16 v[52:55], v[20:23], a[220:223], v[52:55]
    ds_read_b64_tr_b16 v[38:39], v12 offset:38912
    v_add_u32 v219, 65536, v1
    v_mfma_f32_16x16x32_bf16 v[52:55], v[16:19], a[204:207], v[52:55]
    s_waitcnt lgkmcnt(4)
    v_mfma_f32_16x16x32_bf16 v[68:71], v[24:27], a[204:207], v[68:71]
    ds_read_b64_tr_b16 v[16:17], v12 offset:40960
    v_mfma_f32_16x16x32_bf16 v[68:71], v[28:31], a[220:223], v[68:71]
    v_mfma_f32_16x16x32_bf16 v[64:67], v[28:31], a[216:219], v[64:67]
    ds_read_b64_tr_b16 v[18:19], v12 offset:43008
    v_mfma_f32_16x16x32_bf16 v[64:67], v[24:27], a[200:203], v[64:67]
    global_load_dwordx4 v[224:227], v219, s[78:79] offset:0 sc1
    v_mfma_f32_16x16x32_bf16 v[60:63], v[24:27], a[196:199], v[60:63]
    ds_read_b64_tr_b16 v[20:21], v12 offset:45056
    v_mfma_f32_16x16x32_bf16 v[60:63], v[28:31], a[212:215], v[60:63]
    v_mfma_f32_16x16x32_bf16 v[56:59], v[28:31], a[208:211], v[56:59]
    ds_read_b64_tr_b16 v[22:23], v12 offset:47104
    v_mfma_f32_16x16x32_bf16 v[56:59], v[24:27], a[192:195], v[56:59]
    global_load_dwordx4 v[228:231], v219, s[78:79] offset:1024 sc1
    s_waitcnt lgkmcnt(4)
    v_mfma_f32_16x16x32_bf16 v[72:75], v[32:35], a[192:195], v[72:75]
    ds_read_b64_tr_b16 v[24:25], v13 offset:32768
    v_mfma_f32_16x16x32_bf16 v[72:75], v[36:39], a[208:211], v[72:75]
    v_mfma_f32_16x16x32_bf16 v[76:79], v[36:39], a[212:215], v[76:79]
    ds_read_b64_tr_b16 v[26:27], v13 offset:34816
    v_mfma_f32_16x16x32_bf16 v[76:79], v[32:35], a[196:199], v[76:79]
    v_mfma_f32_16x16x32_bf16 v[80:83], v[32:35], a[200:203], v[80:83]
    ds_read_b64_tr_b16 v[28:29], v13 offset:36864
    v_mfma_f32_16x16x32_bf16 v[80:83], v[36:39], a[216:219], v[80:83]
    global_load_dwordx4 v[232:235], v219, s[78:79] offset:2048 sc1
    v_mfma_f32_16x16x32_bf16 v[84:87], v[36:39], a[220:223], v[84:87]
    ds_read_b64_tr_b16 v[30:31], v13 offset:38912
    v_mfma_f32_16x16x32_bf16 v[84:87], v[32:35], a[204:207], v[84:87]
    s_waitcnt lgkmcnt(4)
    v_mfma_f32_16x16x32_bf16 v[100:103], v[16:19], a[204:207], v[100:103]
    ds_read_b64_tr_b16 v[32:33], v13 offset:40960
    v_mfma_f32_16x16x32_bf16 v[100:103], v[20:23], a[220:223], v[100:103]
    global_load_dwordx4 v[236:239], v219, s[78:79] offset:3072 sc1
    v_mfma_f32_16x16x32_bf16 v[96:99], v[20:23], a[216:219], v[96:99]
    ds_read_b64_tr_b16 v[34:35], v13 offset:43008
    v_add_u32 v219, 69632, v1
    v_mfma_f32_16x16x32_bf16 v[96:99], v[16:19], a[200:203], v[96:99]
    v_mfma_f32_16x16x32_bf16 v[92:95], v[16:19], a[196:199], v[92:95]
    ds_read_b64_tr_b16 v[36:37], v13 offset:45056
    v_mfma_f32_16x16x32_bf16 v[92:95], v[20:23], a[212:215], v[92:95]
    v_mfma_f32_16x16x32_bf16 v[88:91], v[20:23], a[208:211], v[88:91]
    ds_read_b64_tr_b16 v[38:39], v13 offset:47104
    v_mfma_f32_16x16x32_bf16 v[88:91], v[16:19], a[192:195], v[88:91]
    global_load_dwordx4 v[240:243], v219, s[78:79] offset:0 sc1
    s_waitcnt lgkmcnt(4)
    v_mfma_f32_16x16x32_bf16 v[104:107], v[24:27], a[192:195], v[104:107]
    s_barrier
    ds_read_b64_tr_b16 v[16:17], v14 offset:32768
    v_mfma_f32_16x16x32_bf16 v[104:107], v[28:31], a[208:211], v[104:107]
    v_mfma_f32_16x16x32_bf16 v[108:111], v[28:31], a[212:215], v[108:111]
    ds_read_b64_tr_b16 v[18:19], v14 offset:34816
    v_mfma_f32_16x16x32_bf16 v[108:111], v[24:27], a[196:199], v[108:111]
    global_load_dwordx4 v[244:247], v219, s[78:79] offset:1024 sc1
    v_mfma_f32_16x16x32_bf16 v[112:115], v[24:27], a[200:203], v[112:115]
    ds_read_b64_tr_b16 v[20:21], v14 offset:36864
    v_mfma_f32_16x16x32_bf16 v[112:115], v[28:31], a[216:219], v[112:115]
    v_mfma_f32_16x16x32_bf16 v[116:119], v[28:31], a[220:223], v[116:119]
    ds_read_b64_tr_b16 v[22:23], v14 offset:38912
    v_mfma_f32_16x16x32_bf16 v[116:119], v[24:27], a[204:207], v[116:119]
    s_waitcnt lgkmcnt(4)
    v_mfma_f32_16x16x32_bf16 v[132:135], v[32:35], a[204:207], v[132:135]
    ds_read_b64_tr_b16 v[24:25], v14 offset:40960
    v_mfma_f32_16x16x32_bf16 v[132:135], v[36:39], a[220:223], v[132:135]
    global_load_dwordx4 v[248:251], v219, s[78:79] offset:2048 sc1
    v_mfma_f32_16x16x32_bf16 v[128:131], v[36:39], a[216:219], v[128:131]
    ds_read_b64_tr_b16 v[26:27], v14 offset:43008
    v_mfma_f32_16x16x32_bf16 v[128:131], v[32:35], a[200:203], v[128:131]
    v_mfma_f32_16x16x32_bf16 v[124:127], v[32:35], a[196:199], v[124:127]
    ds_read_b64_tr_b16 v[28:29], v14 offset:45056
    v_mfma_f32_16x16x32_bf16 v[124:127], v[36:39], a[212:215], v[124:127]
    global_load_dwordx4 v[252:255], v219, s[78:79] offset:3072 sc1
    v_mfma_f32_16x16x32_bf16 v[120:123], v[36:39], a[208:211], v[120:123]
    ds_read_b64_tr_b16 v[30:31], v14 offset:47104
    s_add_u32 m0, s18, 28672
    v_mfma_f32_16x16x32_bf16 v[120:123], v[32:35], a[192:195], v[120:123]
    v_add_u32 v220, 6144, v1
    s_waitcnt lgkmcnt(4)
    v_mfma_f32_16x16x32_bf16 v[136:139], v[16:19], a[192:195], v[136:139]
    ds_read_b64_tr_b16 v[32:33], v11 offset:49152
    v_mfma_f32_16x16x32_bf16 v[136:139], v[20:23], a[208:211], v[136:139]
    v_mfma_f32_16x16x32_bf16 v[140:143], v[20:23], a[212:215], v[140:143]
    ds_read_b64_tr_b16 v[34:35], v11 offset:51200
    v_mfma_f32_16x16x32_bf16 v[140:143], v[16:19], a[196:199], v[140:143]
    global_load_lds_dwordx4 v220, s[84:85] sc1
    v_mfma_f32_16x16x32_bf16 v[144:147], v[16:19], a[200:203], v[144:147]
    ds_read_b64_tr_b16 v[36:37], v11 offset:53248
    s_add_u32 m0, s18, 32768
    v_mfma_f32_16x16x32_bf16 v[144:147], v[20:23], a[216:219], v[144:147]
    v_add_u32 v220, 8192, v1
    v_mfma_f32_16x16x32_bf16 v[148:151], v[20:23], a[220:223], v[148:151]
    ds_read_b64_tr_b16 v[38:39], v11 offset:55296
    v_mfma_f32_16x16x32_bf16 v[148:151], v[16:19], a[204:207], v[148:151]
    global_load_lds_dwordx4 v220, s[84:85] sc1
    s_waitcnt lgkmcnt(4)
    v_mfma_f32_16x16x32_bf16 v[164:167], v[24:27], a[204:207], v[164:167]
    ds_read_b64_tr_b16 v[16:17], v11 offset:57344
    s_add_u32 m0, s18, 36864
    v_mfma_f32_16x16x32_bf16 v[164:167], v[28:31], a[220:223], v[164:167]
    v_add_u32 v220, 10240, v1
    v_mfma_f32_16x16x32_bf16 v[160:163], v[28:31], a[216:219], v[160:163]
    ds_read_b64_tr_b16 v[18:19], v11 offset:59392
    v_mfma_f32_16x16x32_bf16 v[160:163], v[24:27], a[200:203], v[160:163]
    v_mfma_f32_16x16x32_bf16 v[156:159], v[24:27], a[196:199], v[156:159]
    ds_read_b64_tr_b16 v[20:21], v11 offset:61440
    v_mfma_f32_16x16x32_bf16 v[156:159], v[28:31], a[212:215], v[156:159]
    global_load_lds_dwordx4 v220, s[84:85] sc1
    v_mfma_f32_16x16x32_bf16 v[152:155], v[28:31], a[208:211], v[152:155]
    ds_read_b64_tr_b16 v[22:23], v11 offset:63488
    s_add_u32 m0, s18, 40960
    v_mfma_f32_16x16x32_bf16 v[152:155], v[24:27], a[192:195], v[152:155]
    v_add_u32 v220, 12288, v1
    s_waitcnt vmcnt(14) lgkmcnt(4)
    v_mfma_f32_16x16x32_bf16 v[40:43], v[32:35], a[224:227], v[40:43]
    ds_read_b64_tr_b16 v[24:25], v12 offset:49152
    v_mfma_f32_16x16x32_bf16 v[40:43], v[36:39], a[240:243], v[40:43]
    global_load_lds_dwordx4 v220, s[84:85] sc1
    v_mfma_f32_16x16x32_bf16 v[44:47], v[36:39], a[244:247], v[44:47]
    ds_read_b64_tr_b16 v[26:27], v12 offset:51200
    s_add_u32 m0, s18, 45056
    v_mfma_f32_16x16x32_bf16 v[44:47], v[32:35], a[228:231], v[44:47]
    v_add_u32 v220, 14336, v1
    v_mfma_f32_16x16x32_bf16 v[48:51], v[32:35], a[232:235], v[48:51]
    ds_read_b64_tr_b16 v[28:29], v12 offset:53248
    v_mfma_f32_16x16x32_bf16 v[48:51], v[36:39], a[248:251], v[48:51]
    v_mfma_f32_16x16x32_bf16 v[52:55], v[36:39], a[252:255], v[52:55]
    ds_read_b64_tr_b16 v[30:31], v12 offset:55296
    v_mfma_f32_16x16x32_bf16 v[52:55], v[32:35], a[236:239], v[52:55]
    global_load_lds_dwordx4 v220, s[84:85] sc1
    s_waitcnt lgkmcnt(4)
    v_mfma_f32_16x16x32_bf16 v[68:71], v[16:19], a[236:239], v[68:71]
    ds_read_b64_tr_b16 v[32:33], v12 offset:57344
    s_add_u32 m0, s18, 49152
    v_mfma_f32_16x16x32_bf16 v[68:71], v[20:23], a[252:255], v[68:71]
    v_add_u32 v220, 16384, v1
    v_mfma_f32_16x16x32_bf16 v[64:67], v[20:23], a[248:251], v[64:67]
    ds_read_b64_tr_b16 v[34:35], v12 offset:59392
    v_mfma_f32_16x16x32_bf16 v[64:67], v[16:19], a[232:235], v[64:67]
    global_load_lds_dwordx4 v220, s[84:85] sc1
    v_mfma_f32_16x16x32_bf16 v[60:63], v[16:19], a[228:231], v[60:63]
    ds_read_b64_tr_b16 v[36:37], v12 offset:61440
    s_add_u32 m0, s18, 53248
    v_mfma_f32_16x16x32_bf16 v[60:63], v[20:23], a[244:247], v[60:63]
    v_add_u32 v220, 128, v3
    v_mfma_f32_16x16x32_bf16 v[56:59], v[20:23], a[240:243], v[56:59]
    ds_read_b64_tr_b16 v[38:39], v12 offset:63488
    v_mfma_f32_16x16x32_bf16 v[56:59], v[16:19], a[224:227], v[56:59]
    s_waitcnt lgkmcnt(4)
    v_mfma_f32_16x16x32_bf16 v[72:75], v[24:27], a[224:227], v[72:75]
    s_barrier
    ds_read_b64_tr_b16 v[16:17], v13 offset:49152
    v_mfma_f32_16x16x32_bf16 v[72:75], v[28:31], a[240:243], v[72:75]
    global_load_lds_dwordx4 v220, s[72:73]
    v_mfma_f32_16x16x32_bf16 v[76:79], v[28:31], a[244:247], v[76:79]
    ds_read_b64_tr_b16 v[18:19], v13 offset:51200
    s_add_u32 m0, s18, 57344
    v_mfma_f32_16x16x32_bf16 v[76:79], v[24:27], a[228:231], v[76:79]
    v_add_u32 v220, 295040, v3
    v_mfma_f32_16x16x32_bf16 v[80:83], v[24:27], a[232:235], v[80:83]
    ds_read_b64_tr_b16 v[20:21], v13 offset:53248
    v_mfma_f32_16x16x32_bf16 v[80:83], v[28:31], a[248:251], v[80:83]
    global_load_lds_dwordx4 v220, s[72:73]
    v_mfma_f32_16x16x32_bf16 v[84:87], v[28:31], a[252:255], v[84:87]
    ds_read_b64_tr_b16 v[22:23], v13 offset:55296
    s_add_u32 m0, s18, 61440
    v_mfma_f32_16x16x32_bf16 v[84:87], v[24:27], a[236:239], v[84:87]
    v_add_u32 v220, 128, v3
    s_waitcnt lgkmcnt(4)
    v_mfma_f32_16x16x32_bf16 v[100:103], v[32:35], a[236:239], v[100:103]
    ds_read_b64_tr_b16 v[24:25], v13 offset:57344
    v_mfma_f32_16x16x32_bf16 v[100:103], v[36:39], a[252:255], v[100:103]
    v_mfma_f32_16x16x32_bf16 v[96:99], v[36:39], a[248:251], v[96:99]
    ds_read_b64_tr_b16 v[26:27], v13 offset:59392
    v_mfma_f32_16x16x32_bf16 v[96:99], v[32:35], a[232:235], v[96:99]
    global_load_lds_dwordx4 v220, s[74:75]
    v_mfma_f32_16x16x32_bf16 v[92:95], v[32:35], a[228:231], v[92:95]
    ds_read_b64_tr_b16 v[28:29], v13 offset:61440
    s_add_u32 m0, s18, 65536
    v_mfma_f32_16x16x32_bf16 v[92:95], v[36:39], a[244:247], v[92:95]
    v_add_u32 v220, 295040, v3
    v_mfma_f32_16x16x32_bf16 v[88:91], v[36:39], a[240:243], v[88:91]
    ds_read_b64_tr_b16 v[30:31], v13 offset:63488
    v_mfma_f32_16x16x32_bf16 v[88:91], v[32:35], a[224:227], v[88:91]
    global_load_lds_dwordx4 v220, s[74:75]
    s_waitcnt lgkmcnt(4)
    v_mfma_f32_16x16x32_bf16 v[104:107], v[16:19], a[224:227], v[104:107]
    ds_read_b64_tr_b16 v[32:33], v14 offset:49152
    s_add_u32 m0, s18, 69632
    v_mfma_f32_16x16x32_bf16 v[104:107], v[20:23], a[240:243], v[104:107]
    v_add_u32 v220, 589952, v3
    v_mfma_f32_16x16x32_bf16 v[108:111], v[20:23], a[244:247], v[108:111]
    ds_read_b64_tr_b16 v[34:35], v14 offset:51200
    v_mfma_f32_16x16x32_bf16 v[108:111], v[16:19], a[228:231], v[108:111]
    v_mfma_f32_16x16x32_bf16 v[112:115], v[16:19], a[232:235], v[112:115]
    ds_read_b64_tr_b16 v[36:37], v14 offset:53248
    v_mfma_f32_16x16x32_bf16 v[112:115], v[20:23], a[248:251], v[112:115]
    global_load_lds_dwordx4 v220, s[72:73]
    v_mfma_f32_16x16x32_bf16 v[116:119], v[20:23], a[252:255], v[116:119]
    ds_read_b64_tr_b16 v[38:39], v14 offset:55296
    s_add_u32 m0, s18, 73728
    v_mfma_f32_16x16x32_bf16 v[116:119], v[16:19], a[236:239], v[116:119]
    v_add_u32 v220, 884864, v3
    s_waitcnt lgkmcnt(4)
    v_mfma_f32_16x16x32_bf16 v[132:135], v[24:27], a[236:239], v[132:135]
    ds_read_b64_tr_b16 v[16:17], v14 offset:57344
    v_mfma_f32_16x16x32_bf16 v[132:135], v[28:31], a[252:255], v[132:135]
    global_load_lds_dwordx4 v220, s[72:73]
    v_mfma_f32_16x16x32_bf16 v[128:131], v[28:31], a[248:251], v[128:131]
    ds_read_b64_tr_b16 v[18:19], v14 offset:59392
    s_add_u32 m0, s18, 77824
    v_mfma_f32_16x16x32_bf16 v[128:131], v[24:27], a[232:235], v[128:131]
    v_add_u32 v220, 589952, v3
    v_mfma_f32_16x16x32_bf16 v[124:127], v[24:27], a[228:231], v[124:127]
    ds_read_b64_tr_b16 v[20:21], v14 offset:61440
    v_mfma_f32_16x16x32_bf16 v[124:127], v[28:31], a[244:247], v[124:127]
    v_mfma_f32_16x16x32_bf16 v[120:123], v[28:31], a[240:243], v[120:123]
    ds_read_b64_tr_b16 v[22:23], v14 offset:63488
    v_mfma_f32_16x16x32_bf16 v[120:123], v[24:27], a[224:227], v[120:123]
    global_load_lds_dwordx4 v220, s[74:75]
    s_waitcnt lgkmcnt(4)
    v_mfma_f32_16x16x32_bf16 v[136:139], v[32:35], a[224:227], v[136:139]
    ds_read_b64_tr_b16 v[24:25], v6 offset:0
    s_add_u32 m0, s18, 81920
    v_mfma_f32_16x16x32_bf16 v[136:139], v[36:39], a[240:243], v[136:139]
    v_add_u32 v220, 884864, v3
    v_mfma_f32_16x16x32_bf16 v[140:143], v[36:39], a[244:247], v[140:143]
    ds_read_b64_tr_b16 v[26:27], v6 offset:2048
    v_mfma_f32_16x16x32_bf16 v[140:143], v[32:35], a[228:231], v[140:143]
    global_load_lds_dwordx4 v220, s[74:75]
    v_mfma_f32_16x16x32_bf16 v[144:147], v[32:35], a[232:235], v[144:147]
    ds_read_b64_tr_b16 v[28:29], v6 offset:4096
    s_add_u32 m0, s18, 86016
    v_mfma_f32_16x16x32_bf16 v[144:147], v[36:39], a[248:251], v[144:147]
    v_add_u32 v220, 1179776, v3
    v_mfma_f32_16x16x32_bf16 v[148:151], v[36:39], a[252:255], v[148:151]
    ds_read_b64_tr_b16 v[30:31], v6 offset:6144
    v_mfma_f32_16x16x32_bf16 v[148:151], v[32:35], a[236:239], v[148:151]
    s_waitcnt lgkmcnt(4)
    v_mfma_f32_16x16x32_bf16 v[164:167], v[16:19], a[236:239], v[164:167]
    ds_read_b64_tr_b16 v[32:33], v6 offset:8192
    v_mfma_f32_16x16x32_bf16 v[164:167], v[20:23], a[252:255], v[164:167]
    global_load_lds_dwordx4 v220, s[72:73]
    v_mfma_f32_16x16x32_bf16 v[160:163], v[20:23], a[248:251], v[160:163]
    ds_read_b64_tr_b16 v[34:35], v6 offset:10240
    s_add_u32 m0, s18, 90112
    v_mfma_f32_16x16x32_bf16 v[160:163], v[16:19], a[232:235], v[160:163]
    v_add_u32 v220, 1474688, v3
    v_mfma_f32_16x16x32_bf16 v[156:159], v[16:19], a[228:231], v[156:159]
    ds_read_b64_tr_b16 v[36:37], v6 offset:12288
    v_mfma_f32_16x16x32_bf16 v[156:159], v[20:23], a[244:247], v[156:159]
    global_load_lds_dwordx4 v220, s[72:73]
    v_mfma_f32_16x16x32_bf16 v[152:155], v[20:23], a[240:243], v[152:155]
    ds_read_b64_tr_b16 v[38:39], v6 offset:14336
    s_add_u32 m0, s18, 94208
    v_mfma_f32_16x16x32_bf16 v[152:155], v[16:19], a[224:227], v[152:155]
    v_add_u32 v220, 1179776, v3
    s_waitcnt vmcnt(16) lgkmcnt(4)
    v_mfma_f32_16x16x32_bf16 v[40:43], v[24:27], v[224:227], v[40:43]
    s_barrier
    ds_read_b64_tr_b16 v[16:17], v7 offset:0
    v_mfma_f32_16x16x32_bf16 v[40:43], v[28:31], v[240:243], v[40:43]
    v_mfma_f32_16x16x32_bf16 v[44:47], v[28:31], v[244:247], v[44:47]
    ds_read_b64_tr_b16 v[18:19], v7 offset:2048
    v_mfma_f32_16x16x32_bf16 v[44:47], v[24:27], v[228:231], v[44:47]
    global_load_lds_dwordx4 v220, s[74:75]
    v_mfma_f32_16x16x32_bf16 v[48:51], v[24:27], v[232:235], v[48:51]
    ds_read_b64_tr_b16 v[20:21], v7 offset:4096
    s_add_u32 m0, s18, 98304
    v_mfma_f32_16x16x32_bf16 v[48:51], v[28:31], v[248:251], v[48:51]
    v_add_u32 v220, 1474688, v3
    v_mfma_f32_16x16x32_bf16 v[52:55], v[28:31], v[252:255], v[52:55]
    ds_read_b64_tr_b16 v[22:23], v7 offset:6144
    v_mfma_f32_16x16x32_bf16 v[52:55], v[24:27], v[236:239], v[52:55]
    global_load_lds_dwordx4 v220, s[74:75]
    s_waitcnt lgkmcnt(4)
    v_mfma_f32_16x16x32_bf16 v[68:71], v[32:35], v[236:239], v[68:71]
    ds_read_b64_tr_b16 v[24:25], v7 offset:8192
    s_add_u32 m0, s18, 102400
    v_mfma_f32_16x16x32_bf16 v[68:71], v[36:39], v[252:255], v[68:71]
    v_add_u32 v220, 1769600, v3
    v_mfma_f32_16x16x32_bf16 v[64:67], v[36:39], v[248:251], v[64:67]
    ds_read_b64_tr_b16 v[26:27], v7 offset:10240
    v_mfma_f32_16x16x32_bf16 v[64:67], v[32:35], v[232:235], v[64:67]
    v_mfma_f32_16x16x32_bf16 v[60:63], v[32:35], v[228:231], v[60:63]
    ds_read_b64_tr_b16 v[28:29], v7 offset:12288
    v_mfma_f32_16x16x32_bf16 v[60:63], v[36:39], v[244:247], v[60:63]
    global_load_lds_dwordx4 v220, s[72:73]
    v_mfma_f32_16x16x32_bf16 v[56:59], v[36:39], v[240:243], v[56:59]
    ds_read_b64_tr_b16 v[30:31], v7 offset:14336
    s_add_u32 m0, s18, 106496
    v_mfma_f32_16x16x32_bf16 v[56:59], v[32:35], v[224:227], v[56:59]
    v_add_u32 v220, 2064512, v3
    s_waitcnt lgkmcnt(4)
    v_mfma_f32_16x16x32_bf16 v[72:75], v[16:19], v[224:227], v[72:75]
    ds_read_b64_tr_b16 v[32:33], v8 offset:0
    v_mfma_f32_16x16x32_bf16 v[72:75], v[20:23], v[240:243], v[72:75]
    global_load_lds_dwordx4 v220, s[72:73]
    v_mfma_f32_16x16x32_bf16 v[76:79], v[20:23], v[244:247], v[76:79]
    ds_read_b64_tr_b16 v[34:35], v8 offset:2048
    s_add_u32 m0, s18, 110592
    v_mfma_f32_16x16x32_bf16 v[76:79], v[16:19], v[228:231], v[76:79]
    v_add_u32 v220, 1769600, v3
    v_mfma_f32_16x16x32_bf16 v[80:83], v[16:19], v[232:235], v[80:83]
    ds_read_b64_tr_b16 v[36:37], v8 offset:4096
    v_mfma_f32_16x16x32_bf16 v[80:83], v[20:23], v[248:251], v[80:83]
    v_mfma_f32_16x16x32_bf16 v[84:87], v[20:23], v[252:255], v[84:87]
    ds_read_b64_tr_b16 v[38:39], v8 offset:6144
    v_mfma_f32_16x16x32_bf16 v[84:87], v[16:19], v[236:239], v[84:87]
    global_load_lds_dwordx4 v220, s[74:75]
    s_waitcnt lgkmcnt(4)
    v_mfma_f32_16x16x32_bf16 v[100:103], v[24:27], v[236:239], v[100:103]
    ds_read_b64_tr_b16 v[16:17], v8 offset:8192
    s_add_u32 m0, s18, 114688
    v_mfma_f32_16x16x32_bf16 v[100:103], v[28:31], v[252:255], v[100:103]
    v_add_u32 v220, 2064512, v3
    v_max_f32 v40, 0, v40
    v_mfma_f32_16x16x32_bf16 v[96:99], v[28:31], v[248:251], v[96:99]
    ds_read_b64_tr_b16 v[18:19], v8 offset:10240
    v_max_f32 v41, 0, v41
    v_mfma_f32_16x16x32_bf16 v[96:99], v[24:27], v[232:235], v[96:99]
    global_load_lds_dwordx4 v220, s[74:75]
    v_max_f32 v42, 0, v42
    v_mfma_f32_16x16x32_bf16 v[92:95], v[24:27], v[228:231], v[92:95]
    ds_read_b64_tr_b16 v[20:21], v8 offset:12288
    s_add_u32 m0, s18, 118784
    v_mfma_f32_16x16x32_bf16 v[92:95], v[28:31], v[244:247], v[92:95]
    v_add_u32 v220, 2359424, v3
    v_max_f32 v43, 0, v43
    v_mfma_f32_16x16x32_bf16 v[88:91], v[28:31], v[240:243], v[88:91]
    ds_read_b64_tr_b16 v[22:23], v8 offset:14336
    v_mul_f32 v40, v40, v56
    v_mfma_f32_16x16x32_bf16 v[88:91], v[24:27], v[224:227], v[88:91]
    v_mul_f32 v41, v41, v57
    s_waitcnt lgkmcnt(4)
    v_mfma_f32_16x16x32_bf16 v[104:107], v[32:35], v[224:227], v[104:107]
    ds_read_b64_tr_b16 v[24:25], v9 offset:0
    v_mul_f32 v42, v42, v58
    v_mfma_f32_16x16x32_bf16 v[104:107], v[36:39], v[240:243], v[104:107]
    global_load_lds_dwordx4 v220, s[72:73]
    v_mul_f32 v43, v43, v59
    v_mfma_f32_16x16x32_bf16 v[108:111], v[36:39], v[244:247], v[108:111]
    ds_read_b64_tr_b16 v[26:27], v9 offset:2048
    s_add_u32 m0, s18, 122880
    v_mfma_f32_16x16x32_bf16 v[108:111], v[32:35], v[228:231], v[108:111]
    v_add_u32 v220, 2654336, v3
    v_cvt_pk_bf16_f32 v168, v40, v41
    v_mfma_f32_16x16x32_bf16 v[112:115], v[32:35], v[232:235], v[112:115]
    ds_read_b64_tr_b16 v[28:29], v9 offset:4096
    v_cvt_pk_bf16_f32 v169, v42, v43
    v_mfma_f32_16x16x32_bf16 v[112:115], v[36:39], v[248:251], v[112:115]
    global_load_lds_dwordx4 v220, s[72:73]
    v_max_f32 v44, 0, v44
    v_mfma_f32_16x16x32_bf16 v[116:119], v[36:39], v[252:255], v[116:119]
    ds_read_b64_tr_b16 v[30:31], v9 offset:6144
    s_add_u32 m0, s18, 126976
    v_mfma_f32_16x16x32_bf16 v[116:119], v[32:35], v[236:239], v[116:119]
    v_add_u32 v220, 2359424, v3
    s_waitcnt lgkmcnt(4)
    v_mfma_f32_16x16x32_bf16 v[132:135], v[16:19], v[236:239], v[132:135]
    ds_read_b64_tr_b16 v[32:33], v9 offset:8192
    v_max_f32 v45, 0, v45
    v_mfma_f32_16x16x32_bf16 v[132:135], v[20:23], v[252:255], v[132:135]
    v_max_f32 v46, 0, v46
    v_max_f32 v47, 0, v47
    v_mfma_f32_16x16x32_bf16 v[128:131], v[20:23], v[248:251], v[128:131]
    ds_read_b64_tr_b16 v[34:35], v9 offset:10240
    v_mul_f32 v44, v44, v60
    v_mfma_f32_16x16x32_bf16 v[128:131], v[16:19], v[232:235], v[128:131]
    global_load_lds_dwordx4 v220, s[74:75]
    v_mul_f32 v45, v45, v61
    v_mfma_f32_16x16x32_bf16 v[124:127], v[16:19], v[228:231], v[124:127]
    ds_read_b64_tr_b16 v[36:37], v9 offset:12288
    v_mul_f32 v46, v46, v62
    v_mfma_f32_16x16x32_bf16 v[124:127], v[20:23], v[244:247], v[124:127]
    v_mul_f32 v47, v47, v63
    v_cvt_pk_bf16_f32 v172, v44, v45
    v_mfma_f32_16x16x32_bf16 v[120:123], v[20:23], v[240:243], v[120:123]
    ds_read_b64_tr_b16 v[38:39], v9 offset:14336
    v_cvt_pk_bf16_f32 v173, v46, v47
    v_mfma_f32_16x16x32_bf16 v[120:123], v[16:19], v[224:227], v[120:123]
    v_max_f32 v48, 0, v48
    s_waitcnt lgkmcnt(4)
    v_mfma_f32_16x16x32_bf16 v[136:139], v[24:27], v[224:227], v[136:139]
    s_barrier
    ds_read_b64_tr_b16 v[16:17], v10 offset:16384
    v_mfma_f32_16x16x32_bf16 v[136:139], v[28:31], v[240:243], v[136:139]
    v_max_f32 v49, 0, v49
    v_max_f32 v50, 0, v50
    v_mfma_f32_16x16x32_bf16 v[140:143], v[28:31], v[244:247], v[140:143]
    ds_read_b64_tr_b16 v[18:19], v10 offset:16896
    s_add_u32 m0, s18, 0
    v_mfma_f32_16x16x32_bf16 v[140:143], v[24:27], v[228:231], v[140:143]
    v_add_u32 v220, 2654336, v3
    v_max_f32 v51, 0, v51
    v_mfma_f32_16x16x32_bf16 v[144:147], v[24:27], v[232:235], v[144:147]
    ds_read_b64_tr_b16 v[20:21], v10 offset:18432
    v_mul_f32 v48, v48, v64
    v_mfma_f32_16x16x32_bf16 v[144:147], v[28:31], v[248:251], v[144:147]
    global_load_lds_dwordx4 v220, s[74:75]
    v_mul_f32 v49, v49, v65
    v_mfma_f32_16x16x32_bf16 v[148:151], v[28:31], v[252:255], v[148:151]
    ds_read_b64_tr_b16 v[22:23], v10 offset:18944
    v_mul_f32 v50, v50, v66
    v_mfma_f32_16x16x32_bf16 v[148:151], v[24:27], v[236:239], v[148:151]
    v_mul_f32 v51, v51, v67
    s_waitcnt lgkmcnt(4)
    v_mfma_f32_16x16x32_bf16 v[164:167], v[32:35], v[236:239], v[164:167]
    ds_read_b64_tr_b16 v[24:25], v10 offset:17408
    v_cvt_pk_bf16_f32 v176, v48, v49
    v_mfma_f32_16x16x32_bf16 v[164:167], v[36:39], v[252:255], v[164:167]
    v_cvt_pk_bf16_f32 v177, v50, v51
    v_max_f32 v52, 0, v52
    v_mfma_f32_16x16x32_bf16 v[160:163], v[36:39], v[248:251], v[160:163]
    ds_read_b64_tr_b16 v[26:27], v10 offset:17920
    v_max_f32 v53, 0, v53
    v_mfma_f32_16x16x32_bf16 v[160:163], v[32:35], v[232:235], v[160:163]
    v_max_f32 v54, 0, v54
    v_max_f32 v55, 0, v55
    v_mfma_f32_16x16x32_bf16 v[156:159], v[32:35], v[228:231], v[156:159]
    ds_read_b64_tr_b16 v[28:29], v10 offset:19456
    v_mul_f32 v52, v52, v68
    v_mfma_f32_16x16x32_bf16 v[156:159], v[36:39], v[244:247], v[156:159]
    v_mul_f32 v53, v53, v69
    v_mul_f32 v54, v54, v70
    v_mfma_f32_16x16x32_bf16 v[152:155], v[36:39], v[240:243], v[152:155]
    ds_read_b64_tr_b16 v[30:31], v10 offset:19968
    v_mul_f32 v55, v55, v71
    v_mfma_f32_16x16x32_bf16 v[152:155], v[32:35], v[224:227], v[152:155]
    v_cvt_pk_bf16_f32 v180, v52, v53
    s_waitcnt lgkmcnt(4)
    v_mfma_f32_16x16x32_bf16 v[184:187], v[16:19], a[0:3], 0
    ds_read_b64_tr_b16 v[32:33], v10 offset:20480
    v_cvt_pk_bf16_f32 v181, v54, v55
    v_mfma_f32_16x16x32_bf16 v[184:187], v[20:23], a[16:19], v[184:187]
    v_max_f32 v72, 0, v72
    v_max_f32 v73, 0, v73
    v_mfma_f32_16x16x32_bf16 v[188:191], v[20:23], a[20:23], 0
    ds_read_b64_tr_b16 v[34:35], v10 offset:20992
    v_max_f32 v74, 0, v74
    v_mfma_f32_16x16x32_bf16 v[188:191], v[16:19], a[4:7], v[188:191]
    v_max_f32 v75, 0, v75
    v_mul_f32 v72, v72, v88
    v_mfma_f32_16x16x32_bf16 v[192:195], v[16:19], a[8:11], 0
    ds_read_b64_tr_b16 v[36:37], v10 offset:22528
    v_mul_f32 v73, v73, v89
    v_mfma_f32_16x16x32_bf16 v[192:195], v[20:23], a[24:27], v[192:195]
    v_mul_f32 v74, v74, v90
    v_mul_f32 v75, v75, v91
    v_mfma_f32_16x16x32_bf16 v[196:199], v[20:23], a[28:31], 0
    ds_read_b64_tr_b16 v[38:39], v10 offset:23040
    v_cvt_pk_bf16_f32 v170, v72, v73
    v_mfma_f32_16x16x32_bf16 v[196:199], v[16:19], a[12:15], v[196:199]
    v_cvt_pk_bf16_f32 v171, v74, v75
    s_waitcnt lgkmcnt(4)
    v_mfma_f32_16x16x32_bf16 v[212:215], v[24:27], a[12:15], 0
    ds_read_b64_tr_b16 v[16:17], v10 offset:21504
    v_max_f32 v76, 0, v76
    v_mfma_f32_16x16x32_bf16 v[212:215], v[28:31], a[28:31], v[212:215]
    s_add_u32 s21, s25, 0
    v_max_f32 v77, 0, v77
    v_mfma_f32_16x16x32_bf16 v[208:211], v[28:31], a[24:27], 0
    ds_read_b64_tr_b16 v[18:19], v10 offset:22016
    v_max_f32 v78, 0, v78
    v_mfma_f32_16x16x32_bf16 v[208:211], v[24:27], a[8:11], v[208:211]
    buffer_store_dwordx4 v[168:171], v1, s[8:11], s21 offen offset:0 sc1
    v_max_f32 v79, 0, v79
    v_mfma_f32_16x16x32_bf16 v[204:207], v[24:27], a[4:7], 0
    ds_read_b64_tr_b16 v[20:21], v10 offset:23552
    v_mul_f32 v76, v76, v92
    v_mfma_f32_16x16x32_bf16 v[204:207], v[28:31], a[20:23], v[204:207]
    v_mul_f32 v77, v77, v93
    v_mul_f32 v78, v78, v94
    v_mfma_f32_16x16x32_bf16 v[200:203], v[28:31], a[16:19], 0
    ds_read_b64_tr_b16 v[22:23], v10 offset:24064
    v_mul_f32 v79, v79, v95
    v_mfma_f32_16x16x32_bf16 v[200:203], v[24:27], a[0:3], v[200:203]
    v_cvt_pk_bf16_f32 v174, v76, v77
    s_waitcnt lgkmcnt(4)
    v_mfma_f32_16x16x32_bf16 v[184:187], v[32:35], a[32:35], v[184:187]
    ds_read_b64_tr_b16 v[24:25], v10 offset:24576
    v_cvt_pk_bf16_f32 v175, v78, v79
    v_mfma_f32_16x16x32_bf16 v[184:187], v[36:39], a[48:51], v[184:187]
    v_max_f32 v80, 0, v80
    v_max_f32 v81, 0, v81
    v_mfma_f32_16x16x32_bf16 v[188:191], v[36:39], a[52:55], v[188:191]
    ds_read_b64_tr_b16 v[26:27], v10 offset:25088
    v_max_f32 v82, 0, v82
    v_mfma_f32_16x16x32_bf16 v[188:191], v[32:35], a[36:39], v[188:191]
    v_max_f32 v83, 0, v83
    v_mul_f32 v80, v80, v96
    v_mfma_f32_16x16x32_bf16 v[192:195], v[32:35], a[40:43], v[192:195]
    ds_read_b64_tr_b16 v[28:29], v10 offset:26624
    v_mul_f32 v81, v81, v97
PAD_5:
    s_cbranch_execz PAD_8
    v_mfma_f32_16x16x32_bf16 v[192:195], v[36:39], a[56:59], v[192:195]
    v_mul_f32 v82, v82, v98
    v_mul_f32 v83, v83, v99
    v_mfma_f32_16x16x32_bf16 v[196:199], v[36:39], a[60:63], v[196:199]
    ds_read_b64_tr_b16 v[30:31], v10 offset:27136
    v_cvt_pk_bf16_f32 v178, v80, v81
    v_mfma_f32_16x16x32_bf16 v[196:199], v[32:35], a[44:47], v[196:199]
    v_cvt_pk_bf16_f32 v179, v82, v83
    s_waitcnt lgkmcnt(4)
    v_mfma_f32_16x16x32_bf16 v[212:215], v[16:19], a[44:47], v[212:215]
    ds_read_b64_tr_b16 v[32:33], v10 offset:25600
    v_max_f32 v84, 0, v84
    v_mfma_f32_16x16x32_bf16 v[212:215], v[20:23], a[60:63], v[212:215]
    v_max_f32 v85, 0, v85
    v_max_f32 v86, 0, v86
    v_mfma_f32_16x16x32_bf16 v[208:211], v[20:23], a[56:59], v[208:211]
    ds_read_b64_tr_b16 v[34:35], v10 offset:26112
    v_max_f32 v87, 0, v87
    v_mfma_f32_16x16x32_bf16 v[208:211], v[16:19], a[40:43], v[208:211]
    v_mul_f32 v84, v84, v100
    v_mul_f32 v85, v85, v101
    v_mfma_f32_16x16x32_bf16 v[204:207], v[16:19], a[36:39], v[204:207]
    ds_read_b64_tr_b16 v[36:37], v10 offset:27648
    v_mul_f32 v86, v86, v102
    v_mfma_f32_16x16x32_bf16 v[204:207], v[20:23], a[52:55], v[204:207]
    v_mul_f32 v87, v87, v103
    v_cvt_pk_bf16_f32 v182, v84, v85
    v_mfma_f32_16x16x32_bf16 v[200:203], v[20:23], a[48:51], v[200:203]
    ds_read_b64_tr_b16 v[38:39], v10 offset:28160
    v_cvt_pk_bf16_f32 v183, v86, v87
    v_mfma_f32_16x16x32_bf16 v[200:203], v[16:19], a[32:35], v[200:203]
    v_max_f32 v136, 0, v136
    s_waitcnt lgkmcnt(4)
    v_mfma_f32_16x16x32_bf16 v[184:187], v[24:27], a[64:67], v[184:187]
    s_waitcnt vmcnt(24)
    s_barrier
    ds_read_b64_tr_b16 v[16:17], v10 offset:28672
    v_mfma_f32_16x16x32_bf16 v[184:187], v[28:31], a[80:83], v[184:187]
    buffer_store_dwordx4 v[172:175], v1, s[8:11], s21 offen offset:1024 sc1
    v_max_f32 v137, 0, v137
    v_mfma_f32_16x16x32_bf16 v[188:191], v[28:31], a[84:87], v[188:191]
    ds_read_b64_tr_b16 v[18:19], v10 offset:29184
    s_add_u32 m0, s18, 4096
    v_mfma_f32_16x16x32_bf16 v[188:191], v[24:27], a[68:71], v[188:191]
    v_add_u32 v220, 2949248, v3
    v_max_f32 v138, 0, v138
    v_mfma_f32_16x16x32_bf16 v[192:195], v[24:27], a[72:75], v[192:195]
    ds_read_b64_tr_b16 v[20:21], v10 offset:30720
    v_max_f32 v139, 0, v139
    v_mfma_f32_16x16x32_bf16 v[192:195], v[28:31], a[88:91], v[192:195]
    global_load_lds_dwordx4 v220, s[72:73]
    v_mul_f32 v136, v136, v152
    v_mfma_f32_16x16x32_bf16 v[196:199], v[28:31], a[92:95], v[196:199]
    ds_read_b64_tr_b16 v[22:23], v10 offset:31232
    s_add_u32 m0, s18, 8192
    v_mfma_f32_16x16x32_bf16 v[196:199], v[24:27], a[76:79], v[196:199]
    v_add_u32 v220, 3244160, v3
    s_waitcnt lgkmcnt(4)
    v_mfma_f32_16x16x32_bf16 v[212:215], v[32:35], a[76:79], v[212:215]
    ds_read_b64_tr_b16 v[24:25], v10 offset:29696
    v_mul_f32 v137, v137, v153
    v_mfma_f32_16x16x32_bf16 v[212:215], v[36:39], a[92:95], v[212:215]
    global_load_lds_dwordx4 v220, s[72:73]
    v_mul_f32 v138, v138, v154
    v_mfma_f32_16x16x32_bf16 v[208:211], v[36:39], a[88:91], v[208:211]
    ds_read_b64_tr_b16 v[26:27], v10 offset:30208
    s_add_u32 m0, s18, 12288
    v_mfma_f32_16x16x32_bf16 v[208:211], v[32:35], a[72:75], v[208:211]
    v_add_u32 v220, 2949248, v3
    v_mul_f32 v139, v139, v155
    v_mfma_f32_16x16x32_bf16 v[204:207], v[32:35], a[68:71], v[204:207]
    ds_read_b64_tr_b16 v[28:29], v10 offset:31744
    v_cvt_pk_bf16_f32 v154, v136, v137
    v_mfma_f32_16x16x32_bf16 v[204:207], v[36:39], a[84:87], v[204:207]
    v_cvt_pk_bf16_f32 v155, v138, v139
    v_max_f32 v140, 0, v140
    v_mfma_f32_16x16x32_bf16 v[200:203], v[36:39], a[80:83], v[200:203]
    ds_read_b64_tr_b16 v[30:31], v10 offset:32256
    v_max_f32 v141, 0, v141
    v_mfma_f32_16x16x32_bf16 v[200:203], v[32:35], a[64:67], v[200:203]
    global_load_lds_dwordx4 v220, s[74:75]
    s_waitcnt lgkmcnt(4)
    v_mfma_f32_16x16x32_bf16 v[184:187], v[16:19], a[96:99], v[184:187]
    ds_read_b64_tr_b16 v[32:33], v10 offset:32768
    s_add_u32 m0, s18, 16384
    v_mfma_f32_16x16x32_bf16 v[184:187], v[20:23], a[112:115], v[184:187]
    v_add_u32 v220, 3244160, v3
    v_max_f32 v142, 0, v142
    v_mfma_f32_16x16x32_bf16 v[188:191], v[20:23], a[116:119], v[188:191]
    ds_read_b64_tr_b16 v[34:35], v10 offset:33280
    v_max_f32 v143, 0, v143
    v_mfma_f32_16x16x32_bf16 v[188:191], v[16:19], a[100:103], v[188:191]
    global_load_lds_dwordx4 v220, s[74:75]
    v_mul_f32 v140, v140, v156
    v_mfma_f32_16x16x32_bf16 v[192:195], v[16:19], a[104:107], v[192:195]
    ds_read_b64_tr_b16 v[36:37], v10 offset:34816
    s_add_u32 m0, s18, 20480
    v_mfma_f32_16x16x32_bf16 v[192:195], v[20:23], a[120:123], v[192:195]
    v_add_u32 v220, 3539072, v3
    v_mul_f32 v141, v141, v157
    v_mfma_f32_16x16x32_bf16 v[196:199], v[20:23], a[124:127], v[196:199]
    ds_read_b64_tr_b16 v[38:39], v10 offset:35328
    v_mul_f32 v142, v142, v158
    v_mfma_f32_16x16x32_bf16 v[196:199], v[16:19], a[108:111], v[196:199]
    v_mul_f32 v143, v143, v159
    s_waitcnt lgkmcnt(4)
    v_mfma_f32_16x16x32_bf16 v[212:215], v[24:27], a[108:111], v[212:215]
    ds_read_b64_tr_b16 v[16:17], v10 offset:33792
    v_cvt_pk_bf16_f32 v158, v140, v141
    v_mfma_f32_16x16x32_bf16 v[212:215], v[28:31], a[124:127], v[212:215]
    global_load_lds_dwordx4 v220, s[72:73]
    v_cvt_pk_bf16_f32 v159, v142, v143
    v_mfma_f32_16x16x32_bf16 v[208:211], v[28:31], a[120:123], v[208:211]
    ds_read_b64_tr_b16 v[18:19], v10 offset:34304
    v_max_f32 v144, 0, v144
    v_mfma_f32_16x16x32_bf16 v[208:211], v[24:27], a[104:107], v[208:211]
    v_max_f32 v145, 0, v145
    v_max_f32 v146, 0, v146
    v_mfma_f32_16x16x32_bf16 v[204:207], v[24:27], a[100:103], v[204:207]
    ds_read_b64_tr_b16 v[20:21], v10 offset:35840
    v_max_f32 v147, 0, v147
    v_mfma_f32_16x16x32_bf16 v[204:207], v[28:31], a[116:119], v[204:207]
    buffer_store_dwordx4 v[176:179], v1, s[8:11], s21 offen offset:2048 sc1
    v_mul_f32 v144, v144, v160
    v_mfma_f32_16x16x32_bf16 v[200:203], v[28:31], a[112:115], v[200:203]
    ds_read_b64_tr_b16 v[22:23], v10 offset:36352
    v_mul_f32 v145, v145, v161
    v_mfma_f32_16x16x32_bf16 v[200:203], v[24:27], a[96:99], v[200:203]
    v_mul_f32 v146, v146, v162
    s_waitcnt lgkmcnt(4)
    v_mfma_f32_16x16x32_bf16 v[184:187], v[32:35], a[128:131], v[184:187]
    ds_read_b64_tr_b16 v[24:25], v10 offset:36864
    v_mul_f32 v147, v147, v163
    v_mfma_f32_16x16x32_bf16 v[184:187], v[36:39], a[144:147], v[184:187]
    v_cvt_pk_bf16_f32 v162, v144, v145
    v_cvt_pk_bf16_f32 v163, v146, v147
    v_mfma_f32_16x16x32_bf16 v[188:191], v[36:39], a[148:151], v[188:191]
    ds_read_b64_tr_b16 v[26:27], v10 offset:37376
    v_max_f32 v148, 0, v148
    v_mfma_f32_16x16x32_bf16 v[188:191], v[32:35], a[132:135], v[188:191]
    v_max_f32 v149, 0, v149
    v_max_f32 v150, 0, v150
    v_mfma_f32_16x16x32_bf16 v[192:195], v[32:35], a[136:139], v[192:195]
    ds_read_b64_tr_b16 v[28:29], v10 offset:38912
    v_max_f32 v151, 0, v151
    v_mfma_f32_16x16x32_bf16 v[192:195], v[36:39], a[152:155], v[192:195]
    v_mul_f32 v148, v148, v164
    v_mul_f32 v149, v149, v165
    v_mfma_f32_16x16x32_bf16 v[196:199], v[36:39], a[156:159], v[196:199]
    ds_read_b64_tr_b16 v[30:31], v10 offset:39424
    v_mul_f32 v150, v150, v166
    v_mfma_f32_16x16x32_bf16 v[196:199], v[32:35], a[140:143], v[196:199]
    v_mul_f32 v151, v151, v167
    s_waitcnt lgkmcnt(4)
    v_mfma_f32_16x16x32_bf16 v[212:215], v[16:19], a[140:143], v[212:215]
    ds_read_b64_tr_b16 v[32:33], v10 offset:37888
    v_cvt_pk_bf16_f32 v166, v148, v149
    v_mfma_f32_16x16x32_bf16 v[212:215], v[20:23], a[156:159], v[212:215]
    v_cvt_pk_bf16_f32 v167, v150, v151
    v_max_f32 v104, 0, v104
    v_mfma_f32_16x16x32_bf16 v[208:211], v[20:23], a[152:155], v[208:211]
    ds_read_b64_tr_b16 v[34:35], v10 offset:38400
    v_max_f32 v105, 0, v105
    v_mfma_f32_16x16x32_bf16 v[208:211], v[16:19], a[136:139], v[208:211]
    v_max_f32 v106, 0, v106
    v_max_f32 v107, 0, v107
    v_mfma_f32_16x16x32_bf16 v[204:207], v[16:19], a[132:135], v[204:207]
    ds_read_b64_tr_b16 v[36:37], v10 offset:39936
    v_mul_f32 v104, v104, v120
    v_mfma_f32_16x16x32_bf16 v[204:207], v[20:23], a[148:151], v[204:207]
    v_mul_f32 v105, v105, v121
    v_mul_f32 v106, v106, v122
    v_mfma_f32_16x16x32_bf16 v[200:203], v[20:23], a[144:147], v[200:203]
    ds_read_b64_tr_b16 v[38:39], v10 offset:40448
    v_mul_f32 v107, v107, v123
    v_mfma_f32_16x16x32_bf16 v[200:203], v[16:19], a[128:131], v[200:203]
    v_cvt_pk_bf16_f32 v152, v104, v105
    s_waitcnt lgkmcnt(4)
    v_mfma_f32_16x16x32_bf16 v[184:187], v[24:27], a[160:163], v[184:187]
    s_waitcnt vmcnt(28)
    s_barrier
    ds_read_b64_tr_b16 v[16:17], v10 offset:40960
    v_mfma_f32_16x16x32_bf16 v[184:187], v[28:31], a[176:179], v[184:187]
    buffer_store_dwordx4 v[180:183], v1, s[8:11], s21 offen offset:3072 sc1
    v_cvt_pk_bf16_f32 v153, v106, v107
    v_mfma_f32_16x16x32_bf16 v[188:191], v[28:31], a[180:183], v[188:191]
    ds_read_b64_tr_b16 v[18:19], v10 offset:41472
    s_add_u32 m0, s18, 24576
    v_mfma_f32_16x16x32_bf16 v[188:191], v[24:27], a[164:167], v[188:191]
    v_add_u32 v220, 3833984, v3
    v_max_f32 v108, 0, v108
    v_mfma_f32_16x16x32_bf16 v[192:195], v[24:27], a[168:171], v[192:195]
    ds_read_b64_tr_b16 v[20:21], v10 offset:43008
    v_max_f32 v109, 0, v109
    v_mfma_f32_16x16x32_bf16 v[192:195], v[28:31], a[184:187], v[192:195]
    global_load_lds_dwordx4 v220, s[72:73]
    v_max_f32 v110, 0, v110
    v_mfma_f32_16x16x32_bf16 v[196:199], v[28:31], a[188:191], v[196:199]
    ds_read_b64_tr_b16 v[22:23], v10 offset:43520
    s_add_u32 m0, s18, 28672
    v_mfma_f32_16x16x32_bf16 v[196:199], v[24:27], a[172:175], v[196:199]
    v_add_u32 v220, 3539072, v3
    s_waitcnt lgkmcnt(4)
    v_mfma_f32_16x16x32_bf16 v[212:215], v[32:35], a[172:175], v[212:215]
    ds_read_b64_tr_b16 v[24:25], v10 offset:41984
    v_max_f32 v111, 0, v111
    v_mfma_f32_16x16x32_bf16 v[212:215], v[36:39], a[188:191], v[212:215]
    global_load_lds_dwordx4 v220, s[74:75]
    v_mul_f32 v108, v108, v124
    v_mfma_f32_16x16x32_bf16 v[208:211], v[36:39], a[184:187], v[208:211]
    ds_read_b64_tr_b16 v[26:27], v10 offset:42496
    s_add_u32 m0, s18, 32768
    v_mfma_f32_16x16x32_bf16 v[208:211], v[32:35], a[168:171], v[208:211]
    v_add_u32 v220, 3833984, v3
    v_mul_f32 v109, v109, v125
    v_mfma_f32_16x16x32_bf16 v[204:207], v[32:35], a[164:167], v[204:207]
    ds_read_b64_tr_b16 v[28:29], v10 offset:44032
    v_mul_f32 v110, v110, v126
    v_mfma_f32_16x16x32_bf16 v[204:207], v[36:39], a[180:183], v[204:207]
    v_mul_f32 v111, v111, v127
    v_cvt_pk_bf16_f32 v156, v108, v109
    v_mfma_f32_16x16x32_bf16 v[200:203], v[36:39], a[176:179], v[200:203]
    ds_read_b64_tr_b16 v[30:31], v10 offset:44544
    v_cvt_pk_bf16_f32 v157, v110, v111
    v_mfma_f32_16x16x32_bf16 v[200:203], v[32:35], a[160:163], v[200:203]
    global_load_lds_dwordx4 v220, s[74:75]
    s_waitcnt lgkmcnt(4)
    v_mfma_f32_16x16x32_bf16 v[184:187], v[16:19], a[192:195], v[184:187]
    ds_read_b64_tr_b16 v[32:33], v10 offset:45056
    v_max_f32 v112, 0, v112
    v_mfma_f32_16x16x32_bf16 v[184:187], v[20:23], a[208:211], v[184:187]
    v_max_f32 v113, 0, v113
    v_max_f32 v114, 0, v114
    v_mfma_f32_16x16x32_bf16 v[188:191], v[20:23], a[212:215], v[188:191]
    ds_read_b64_tr_b16 v[34:35], v10 offset:45568
    v_max_f32 v115, 0, v115
    v_mfma_f32_16x16x32_bf16 v[188:191], v[16:19], a[196:199], v[188:191]
    v_mul_f32 v112, v112, v128
    v_mul_f32 v113, v113, v129
    v_mfma_f32_16x16x32_bf16 v[192:195], v[16:19], a[200:203], v[192:195]
    ds_read_b64_tr_b16 v[36:37], v10 offset:47104
    v_mul_f32 v114, v114, v130
    v_mfma_f32_16x16x32_bf16 v[192:195], v[20:23], a[216:219], v[192:195]
    v_mul_f32 v115, v115, v131
    v_cvt_pk_bf16_f32 v160, v112, v113
    v_mfma_f32_16x16x32_bf16 v[196:199], v[20:23], a[220:223], v[196:199]
    ds_read_b64_tr_b16 v[38:39], v10 offset:47616
    v_cvt_pk_bf16_f32 v161, v114, v115
    v_mfma_f32_16x16x32_bf16 v[196:199], v[16:19], a[204:207], v[196:199]
    v_max_f32 v116, 0, v116
    s_waitcnt lgkmcnt(4)
    v_mfma_f32_16x16x32_bf16 v[212:215], v[24:27], a[204:207], v[212:215]
    ds_read_b64_tr_b16 v[16:17], v10 offset:46080
    s_add_u32 s21, s25, 16384
    v_mfma_f32_16x16x32_bf16 v[212:215], v[28:31], a[220:223], v[212:215]
    buffer_store_dwordx4 v[152:155], v1, s[8:11], s21 offen offset:0 sc1
    v_max_f32 v117, 0, v117
    v_mfma_f32_16x16x32_bf16 v[208:211], v[28:31], a[216:219], v[208:211]
    ds_read_b64_tr_b16 v[18:19], v10 offset:46592
    v_max_f32 v118, 0, v118
    v_mfma_f32_16x16x32_bf16 v[208:211], v[24:27], a[200:203], v[208:211]
    v_max_f32 v119, 0, v119
    v_mul_f32 v116, v116, v132
    v_mfma_f32_16x16x32_bf16 v[204:207], v[24:27], a[196:199], v[204:207]
    ds_read_b64_tr_b16 v[20:21], v10 offset:48128
    v_mul_f32 v117, v117, v133
    v_mfma_f32_16x16x32_bf16 v[204:207], v[28:31], a[212:215], v[204:207]
    v_mul_f32 v118, v118, v134
    v_mul_f32 v119, v119, v135
    v_mfma_f32_16x16x32_bf16 v[200:203], v[28:31], a[208:211], v[200:203]
    ds_read_b64_tr_b16 v[22:23], v10 offset:48640
    v_cvt_pk_bf16_f32 v164, v116, v117
    v_mfma_f32_16x16x32_bf16 v[200:203], v[24:27], a[192:195], v[200:203]
    v_cvt_pk_bf16_f32 v165, v118, v119
    s_waitcnt lgkmcnt(4)
    v_mfma_f32_16x16x32_bf16 v[184:187], v[32:35], a[224:227], v[184:187]
    ds_read_b64_tr_b16 v[24:25], v10 offset:49152
    v_mfma_f32_16x16x32_bf16 v[184:187], v[36:39], a[240:243], v[184:187]
    v_mfma_f32_16x16x32_bf16 v[188:191], v[36:39], a[244:247], v[188:191]
    ds_read_b64_tr_b16 v[26:27], v10 offset:49664
    v_mfma_f32_16x16x32_bf16 v[188:191], v[32:35], a[228:231], v[188:191]
    v_mfma_f32_16x16x32_bf16 v[192:195], v[32:35], a[232:235], v[192:195]
    ds_read_b64_tr_b16 v[28:29], v10 offset:51200
    v_mfma_f32_16x16x32_bf16 v[192:195], v[36:39], a[248:251], v[192:195]
    v_mfma_f32_16x16x32_bf16 v[196:199], v[36:39], a[252:255], v[196:199]
    ds_read_b64_tr_b16 v[30:31], v10 offset:51712
    v_mfma_f32_16x16x32_bf16 v[196:199], v[32:35], a[236:239], v[196:199]
    s_waitcnt lgkmcnt(4)
    v_mfma_f32_16x16x32_bf16 v[212:215], v[16:19], a[236:239], v[212:215]
    ds_read_b64_tr_b16 v[32:33], v10 offset:50176
    v_mfma_f32_16x16x32_bf16 v[212:215], v[20:23], a[252:255], v[212:215]
    v_mfma_f32_16x16x32_bf16 v[208:211], v[20:23], a[248:251], v[208:211]
    ds_read_b64_tr_b16 v[34:35], v10 offset:50688
    v_mfma_f32_16x16x32_bf16 v[208:211], v[16:19], a[232:235], v[208:211]
    v_mfma_f32_16x16x32_bf16 v[204:207], v[16:19], a[228:231], v[204:207]
    ds_read_b64_tr_b16 v[36:37], v10 offset:52224
    v_mfma_f32_16x16x32_bf16 v[204:207], v[20:23], a[244:247], v[204:207]
    v_mfma_f32_16x16x32_bf16 v[200:203], v[20:23], a[240:243], v[200:203]
    ds_read_b64_tr_b16 v[38:39], v10 offset:52736
    v_mfma_f32_16x16x32_bf16 v[200:203], v[16:19], a[224:227], v[200:203]
    s_waitcnt lgkmcnt(4)
    v_mfma_f32_16x16x32_bf16 v[184:187], v[24:27], v[224:227], v[184:187]
    s_waitcnt vmcnt(25)
    s_barrier
    ds_read_b64_tr_b16 v[16:17], v6 offset:53248
    v_mfma_f32_16x16x32_bf16 v[184:187], v[28:31], v[240:243], v[184:187]
    buffer_store_dwordx4 v[156:159], v1, s[8:11], s21 offen offset:1024 sc1
    v_mfma_f32_16x16x32_bf16 v[188:191], v[28:31], v[244:247], v[188:191]
    ds_read_b64_tr_b16 v[18:19], v6 offset:55296
    s_add_u32 m0, s18, 36864
    v_mfma_f32_16x16x32_bf16 v[188:191], v[24:27], v[228:231], v[188:191]
    v_add_u32 v220, 4128896, v3
    v_mfma_f32_16x16x32_bf16 v[192:195], v[24:27], v[232:235], v[192:195]
    ds_read_b64_tr_b16 v[20:21], v6 offset:57344
    v_mfma_f32_16x16x32_bf16 v[192:195], v[28:31], v[248:251], v[192:195]
    global_load_lds_dwordx4 v220, s[72:73]
    v_mfma_f32_16x16x32_bf16 v[196:199], v[28:31], v[252:255], v[196:199]
    ds_read_b64_tr_b16 v[22:23], v6 offset:59392
    s_add_u32 m0, s18, 40960
    v_mfma_f32_16x16x32_bf16 v[196:199], v[24:27], v[236:239], v[196:199]
    v_add_u32 v220, 4423808, v3
    s_waitcnt lgkmcnt(4)
    v_mfma_f32_16x16x32_bf16 v[212:215], v[32:35], v[236:239], v[212:215]
    ds_read_b64_tr_b16 v[24:25], v6 offset:61440
    v_mfma_f32_16x16x32_bf16 v[212:215], v[36:39], v[252:255], v[212:215]
    global_load_lds_dwordx4 v220, s[72:73]
    v_mfma_f32_16x16x32_bf16 v[208:211], v[36:39], v[248:251], v[208:211]
    ds_read_b64_tr_b16 v[26:27], v6 offset:63488
    s_add_u32 m0, s18, 45056
    v_mfma_f32_16x16x32_bf16 v[208:211], v[32:35], v[232:235], v[208:211]
    v_add_u32 v220, 4128896, v3
    v_mfma_f32_16x16x32_bf16 v[204:207], v[32:35], v[228:231], v[204:207]
    ds_read_b64_tr_b16 v[28:29], v11 offset:0
    v_mfma_f32_16x16x32_bf16 v[204:207], v[36:39], v[244:247], v[204:207]
    v_mfma_f32_16x16x32_bf16 v[200:203], v[36:39], v[240:243], v[200:203]
    ds_read_b64_tr_b16 v[30:31], v11 offset:2048
    v_mfma_f32_16x16x32_bf16 v[200:203], v[32:35], v[224:227], v[200:203]
    global_load_lds_dwordx4 v220, s[74:75]
    s_waitcnt lgkmcnt(4)
    v_mfma_f32_16x16x32_bf16 v[40:43], v[16:19], a[0:3], 0
    ds_read_b64_tr_b16 v[32:33], v11 offset:4096
    v_mfma_f32_16x16x32_bf16 v[40:43], v[20:23], a[16:19], v[40:43]
    v_mfma_f32_16x16x32_bf16 v[44:47], v[20:23], a[20:23], 0
    ds_read_b64_tr_b16 v[34:35], v11 offset:6144
    v_mfma_f32_16x16x32_bf16 v[44:47], v[16:19], a[4:7], v[44:47]
    v_mfma_f32_16x16x32_bf16 v[48:51], v[16:19], a[8:11], 0
    ds_read_b64_tr_b16 v[36:37], v11 offset:8192
    v_mfma_f32_16x16x32_bf16 v[48:51], v[20:23], a[24:27], v[48:51]
    v_mfma_f32_16x16x32_bf16 v[52:55], v[20:23], a[28:31], 0
    ds_read_b64_tr_b16 v[38:39], v11 offset:10240
    v_mfma_f32_16x16x32_bf16 v[52:55], v[16:19], a[12:15], v[52:55]
    s_waitcnt lgkmcnt(4)
    v_mfma_f32_16x16x32_bf16 v[68:71], v[24:27], a[12:15], 0
    ds_read_b64_tr_b16 v[16:17], v11 offset:12288
    v_max_f32 v184, 0, v184
    v_mfma_f32_16x16x32_bf16 v[68:71], v[28:31], a[28:31], v[68:71]
    buffer_store_dwordx4 v[160:163], v1, s[8:11], s21 offen offset:2048 sc1
    v_max_f32 v185, 0, v185
    v_mfma_f32_16x16x32_bf16 v[64:67], v[28:31], a[24:27], 0
    ds_read_b64_tr_b16 v[18:19], v11 offset:14336
    v_max_f32 v186, 0, v186
    v_mfma_f32_16x16x32_bf16 v[64:67], v[24:27], a[8:11], v[64:67]
    v_max_f32 v187, 0, v187
    v_mul_f32 v184, v184, v200
    v_mfma_f32_16x16x32_bf16 v[60:63], v[24:27], a[4:7], 0
    ds_read_b64_tr_b16 v[20:21], v11 offset:16384
    v_mul_f32 v185, v185, v201
    v_mfma_f32_16x16x32_bf16 v[60:63], v[28:31], a[20:23], v[60:63]
    v_mul_f32 v186, v186, v202
    v_mul_f32 v187, v187, v203
    v_mfma_f32_16x16x32_bf16 v[56:59], v[28:31], a[16:19], 0
    ds_read_b64_tr_b16 v[22:23], v11 offset:18432
    v_cvt_pk_bf16_f32 v200, v184, v185
    v_mfma_f32_16x16x32_bf16 v[56:59], v[24:27], a[0:3], v[56:59]
    v_cvt_pk_bf16_f32 v201, v186, v187
    s_waitcnt lgkmcnt(4)
    v_mfma_f32_16x16x32_bf16 v[40:43], v[32:35], a[32:35], v[40:43]
    ds_read_b64_tr_b16 v[24:25], v7 offset:53248
    v_max_f32 v188, 0, v188
    v_mfma_f32_16x16x32_bf16 v[40:43], v[36:39], a[48:51], v[40:43]
    v_max_f32 v189, 0, v189
    v_max_f32 v190, 0, v190
    v_mfma_f32_16x16x32_bf16 v[44:47], v[36:39], a[52:55], v[44:47]
    ds_read_b64_tr_b16 v[26:27], v7 offset:55296
    v_max_f32 v191, 0, v191
    v_mfma_f32_16x16x32_bf16 v[44:47], v[32:35], a[36:39], v[44:47]
    v_mul_f32 v188, v188, v204
    v_mul_f32 v189, v189, v205
    v_mfma_f32_16x16x32_bf16 v[48:51], v[32:35], a[40:43], v[48:51]
    ds_read_b64_tr_b16 v[28:29], v7 offset:57344
    v_mul_f32 v190, v190, v206
    v_mfma_f32_16x16x32_bf16 v[48:51], v[36:39], a[56:59], v[48:51]
    v_mul_f32 v191, v191, v207
    v_cvt_pk_bf16_f32 v204, v188, v189
    v_mfma_f32_16x16x32_bf16 v[52:55], v[36:39], a[60:63], v[52:55]
    ds_read_b64_tr_b16 v[30:31], v7 offset:59392
    v_cvt_pk_bf16_f32 v205, v190, v191
    v_mfma_f32_16x16x32_bf16 v[52:55], v[32:35], a[44:47], v[52:55]
    v_max_f32 v192, 0, v192
    s_waitcnt lgkmcnt(4)
    v_mfma_f32_16x16x32_bf16 v[68:71], v[16:19], a[44:47], v[68:71]
    ds_read_b64_tr_b16 v[32:33], v7 offset:61440
    v_max_f32 v193, 0, v193
    v_mfma_f32_16x16x32_bf16 v[68:71], v[20:23], a[60:63], v[68:71]
    v_max_f32 v194, 0, v194
    v_max_f32 v195, 0, v195
    v_mfma_f32_16x16x32_bf16 v[64:67], v[20:23], a[56:59], v[64:67]
    ds_read_b64_tr_b16 v[34:35], v7 offset:63488
    v_mul_f32 v192, v192, v208
    v_mfma_f32_16x16x32_bf16 v[64:67], v[16:19], a[40:43], v[64:67]
    v_mul_f32 v193, v193, v209
    v_mul_f32 v194, v194, v210
    v_mfma_f32_16x16x32_bf16 v[60:63], v[16:19], a[36:39], v[60:63]
    ds_read_b64_tr_b16 v[36:37], v12 offset:0
    v_mul_f32 v195, v195, v211
    v_mfma_f32_16x16x32_bf16 v[60:63], v[20:23], a[52:55], v[60:63]
    v_cvt_pk_bf16_f32 v208, v192, v193
    v_cvt_pk_bf16_f32 v209, v194, v195
    v_mfma_f32_16x16x32_bf16 v[56:59], v[20:23], a[48:51], v[56:59]
    ds_read_b64_tr_b16 v[38:39], v12 offset:2048
    v_max_f32 v196, 0, v196
    v_mfma_f32_16x16x32_bf16 v[56:59], v[16:19], a[32:35], v[56:59]
    v_max_f32 v197, 0, v197
    s_waitcnt lgkmcnt(4)
    v_mfma_f32_16x16x32_bf16 v[72:75], v[24:27], a[0:3], 0
    s_barrier
    ds_read_b64_tr_b16 v[16:17], v12 offset:4096
    v_mfma_f32_16x16x32_bf16 v[72:75], v[28:31], a[16:19], v[72:75]
    buffer_store_dwordx4 v[164:167], v1, s[8:11], s21 offen offset:3072 sc1
    v_max_f32 v198, 0, v198
    v_mfma_f32_16x16x32_bf16 v[76:79], v[28:31], a[20:23], 0
    ds_read_b64_tr_b16 v[18:19], v12 offset:6144
    s_add_u32 m0, s18, 49152
    v_mfma_f32_16x16x32_bf16 v[76:79], v[24:27], a[4:7], v[76:79]
    v_add_u32 v220, 4423808, v3
    v_max_f32 v199, 0, v199
    v_mfma_f32_16x16x32_bf16 v[80:83], v[24:27], a[8:11], 0
    ds_read_b64_tr_b16 v[20:21], v12 offset:8192
    v_mul_f32 v196, v196, v212
    v_mfma_f32_16x16x32_bf16 v[80:83], v[28:31], a[24:27], v[80:83]
    global_load_lds_dwordx4 v220, s[74:75]
    v_mul_f32 v197, v197, v213
    v_mfma_f32_16x16x32_bf16 v[84:87], v[28:31], a[28:31], 0
    ds_read_b64_tr_b16 v[22:23], v12 offset:10240
    v_mul_f32 v198, v198, v214
    v_mfma_f32_16x16x32_bf16 v[84:87], v[24:27], a[12:15], v[84:87]
    v_mul_f32 v199, v199, v215
    s_waitcnt lgkmcnt(4)
    v_mfma_f32_16x16x32_bf16 v[100:103], v[32:35], a[12:15], 0
    ds_read_b64_tr_b16 v[24:25], v12 offset:12288
    v_cvt_pk_bf16_f32 v212, v196, v197
    v_mfma_f32_16x16x32_bf16 v[100:103], v[36:39], a[28:31], v[100:103]
    buffer_store_dwordx2 v[200:201], v2, s[8:11], s27 offen offset:0 sc1
    v_cvt_pk_bf16_f32 v213, v198, v199
    v_mfma_f32_16x16x32_bf16 v[96:99], v[36:39], a[24:27], 0
    ds_read_b64_tr_b16 v[26:27], v12 offset:14336
    v_mfma_f32_16x16x32_bf16 v[96:99], v[32:35], a[8:11], v[96:99]
    v_mfma_f32_16x16x32_bf16 v[92:95], v[32:35], a[4:7], 0
    ds_read_b64_tr_b16 v[28:29], v12 offset:16384
    v_mfma_f32_16x16x32_bf16 v[92:95], v[36:39], a[20:23], v[92:95]
    v_mfma_f32_16x16x32_bf16 v[88:91], v[36:39], a[16:19], 0
    ds_read_b64_tr_b16 v[30:31], v12 offset:18432
    v_mfma_f32_16x16x32_bf16 v[88:91], v[32:35], a[0:3], v[88:91]
    s_waitcnt lgkmcnt(4)
    v_mfma_f32_16x16x32_bf16 v[72:75], v[16:19], a[32:35], v[72:75]
    ds_read_b64_tr_b16 v[32:33], v8 offset:53248
    v_mfma_f32_16x16x32_bf16 v[72:75], v[20:23], a[48:51], v[72:75]
    buffer_store_dwordx2 v[204:205], v2, s[8:11], s27 offen offset:1024 sc1
    v_mfma_f32_16x16x32_bf16 v[76:79], v[20:23], a[52:55], v[76:79]
    ds_read_b64_tr_b16 v[34:35], v8 offset:55296
    v_mfma_f32_16x16x32_bf16 v[76:79], v[16:19], a[36:39], v[76:79]
    v_mfma_f32_16x16x32_bf16 v[80:83], v[16:19], a[40:43], v[80:83]
    ds_read_b64_tr_b16 v[36:37], v8 offset:57344
    v_mfma_f32_16x16x32_bf16 v[80:83], v[20:23], a[56:59], v[80:83]
    v_mfma_f32_16x16x32_bf16 v[84:87], v[20:23], a[60:63], v[84:87]
    ds_read_b64_tr_b16 v[38:39], v8 offset:59392
    v_mfma_f32_16x16x32_bf16 v[84:87], v[16:19], a[44:47], v[84:87]
    s_waitcnt lgkmcnt(4)
    v_mfma_f32_16x16x32_bf16 v[100:103], v[24:27], a[44:47], v[100:103]
    ds_read_b64_tr_b16 v[16:17], v8 offset:61440
    v_mfma_f32_16x16x32_bf16 v[100:103], v[28:31], a[60:63], v[100:103]
    buffer_store_dwordx2 v[208:209], v2, s[8:11], s27 offen offset:2048 sc1
    v_mfma_f32_16x16x32_bf16 v[96:99], v[28:31], a[56:59], v[96:99]
    ds_read_b64_tr_b16 v[18:19], v8 offset:63488
    v_mfma_f32_16x16x32_bf16 v[96:99], v[24:27], a[40:43], v[96:99]
    v_mfma_f32_16x16x32_bf16 v[92:95], v[24:27], a[36:39], v[92:95]
    ds_read_b64_tr_b16 v[20:21], v13 offset:0
    v_mfma_f32_16x16x32_bf16 v[92:95], v[28:31], a[52:55], v[92:95]
    v_mfma_f32_16x16x32_bf16 v[88:91], v[28:31], a[48:51], v[88:91]
    ds_read_b64_tr_b16 v[22:23], v13 offset:2048
    v_mfma_f32_16x16x32_bf16 v[88:91], v[24:27], a[32:35], v[88:91]
    s_waitcnt lgkmcnt(4)
    v_mfma_f32_16x16x32_bf16 v[104:107], v[32:35], a[0:3], 0
    ds_read_b64_tr_b16 v[24:25], v13 offset:4096
    v_mfma_f32_16x16x32_bf16 v[104:107], v[36:39], a[16:19], v[104:107]
    buffer_store_dwordx2 v[212:213], v2, s[8:11], s27 offen offset:3072 sc1
    v_mfma_f32_16x16x32_bf16 v[108:111], v[36:39], a[20:23], 0
    ds_read_b64_tr_b16 v[26:27], v13 offset:6144
    v_mfma_f32_16x16x32_bf16 v[108:111], v[32:35], a[4:7], v[108:111]
    v_mfma_f32_16x16x32_bf16 v[112:115], v[32:35], a[8:11], 0
    ds_read_b64_tr_b16 v[28:29], v13 offset:8192
    v_mfma_f32_16x16x32_bf16 v[112:115], v[36:39], a[24:27], v[112:115]
    v_mfma_f32_16x16x32_bf16 v[116:119], v[36:39], a[28:31], 0
    ds_read_b64_tr_b16 v[30:31], v13 offset:10240
    v_mfma_f32_16x16x32_bf16 v[116:119], v[32:35], a[12:15], v[116:119]
    s_waitcnt lgkmcnt(4)
    v_mfma_f32_16x16x32_bf16 v[132:135], v[16:19], a[12:15], 0
    ds_read_b64_tr_b16 v[32:33], v13 offset:12288
    v_mfma_f32_16x16x32_bf16 v[132:135], v[20:23], a[28:31], v[132:135]
    v_mfma_f32_16x16x32_bf16 v[128:131], v[20:23], a[24:27], 0
    ds_read_b64_tr_b16 v[34:35], v13 offset:14336
    v_mfma_f32_16x16x32_bf16 v[128:131], v[16:19], a[8:11], v[128:131]
    v_mfma_f32_16x16x32_bf16 v[124:127], v[16:19], a[4:7], 0
    ds_read_b64_tr_b16 v[36:37], v13 offset:16384
    v_mfma_f32_16x16x32_bf16 v[124:127], v[20:23], a[20:23], v[124:127]
    v_mfma_f32_16x16x32_bf16 v[120:123], v[20:23], a[16:19], 0
    ds_read_b64_tr_b16 v[38:39], v13 offset:18432
    v_mfma_f32_16x16x32_bf16 v[120:123], v[16:19], a[0:3], v[120:123]
    s_waitcnt lgkmcnt(4)
    v_mfma_f32_16x16x32_bf16 v[104:107], v[24:27], a[32:35], v[104:107]
    ds_read_b64_tr_b16 v[16:17], v9 offset:53248
    v_mfma_f32_16x16x32_bf16 v[104:107], v[28:31], a[48:51], v[104:107]
    v_mfma_f32_16x16x32_bf16 v[108:111], v[28:31], a[52:55], v[108:111]
    ds_read_b64_tr_b16 v[18:19], v9 offset:55296
    v_mfma_f32_16x16x32_bf16 v[108:111], v[24:27], a[36:39], v[108:111]
    v_mfma_f32_16x16x32_bf16 v[112:115], v[24:27], a[40:43], v[112:115]
    ds_read_b64_tr_b16 v[20:21], v9 offset:57344
    v_mfma_f32_16x16x32_bf16 v[112:115], v[28:31], a[56:59], v[112:115]
    v_mfma_f32_16x16x32_bf16 v[116:119], v[28:31], a[60:63], v[116:119]
    ds_read_b64_tr_b16 v[22:23], v9 offset:59392
    v_mfma_f32_16x16x32_bf16 v[116:119], v[24:27], a[44:47], v[116:119]
    s_waitcnt lgkmcnt(4)
    v_mfma_f32_16x16x32_bf16 v[132:135], v[32:35], a[44:47], v[132:135]
    ds_read_b64_tr_b16 v[24:25], v9 offset:61440
    v_mfma_f32_16x16x32_bf16 v[132:135], v[36:39], a[60:63], v[132:135]
    v_mfma_f32_16x16x32_bf16 v[128:131], v[36:39], a[56:59], v[128:131]
    ds_read_b64_tr_b16 v[26:27], v9 offset:63488
    v_mfma_f32_16x16x32_bf16 v[128:131], v[32:35], a[40:43], v[128:131]
    v_mfma_f32_16x16x32_bf16 v[124:127], v[32:35], a[36:39], v[124:127]
    ds_read_b64_tr_b16 v[28:29], v14 offset:0
    v_mfma_f32_16x16x32_bf16 v[124:127], v[36:39], a[52:55], v[124:127]
    v_mfma_f32_16x16x32_bf16 v[120:123], v[36:39], a[48:51], v[120:123]
    ds_read_b64_tr_b16 v[30:31], v14 offset:2048
    v_mfma_f32_16x16x32_bf16 v[120:123], v[32:35], a[32:35], v[120:123]
    s_waitcnt lgkmcnt(4)
    v_mfma_f32_16x16x32_bf16 v[136:139], v[16:19], a[0:3], 0
    ds_read_b64_tr_b16 v[32:33], v14 offset:4096
    v_mfma_f32_16x16x32_bf16 v[136:139], v[20:23], a[16:19], v[136:139]
    v_mfma_f32_16x16x32_bf16 v[140:143], v[20:23], a[20:23], 0
    ds_read_b64_tr_b16 v[34:35], v14 offset:6144
    v_mfma_f32_16x16x32_bf16 v[140:143], v[16:19], a[4:7], v[140:143]
    v_mfma_f32_16x16x32_bf16 v[144:147], v[16:19], a[8:11], 0
    ds_read_b64_tr_b16 v[36:37], v14 offset:8192
    v_mfma_f32_16x16x32_bf16 v[144:147], v[20:23], a[24:27], v[144:147]
    v_mfma_f32_16x16x32_bf16 v[148:151], v[20:23], a[28:31], 0
    ds_read_b64_tr_b16 v[38:39], v14 offset:10240
    v_mfma_f32_16x16x32_bf16 v[148:151], v[16:19], a[12:15], v[148:151]
    s_waitcnt lgkmcnt(4)
    v_mfma_f32_16x16x32_bf16 v[164:167], v[24:27], a[12:15], 0
    s_waitcnt vmcnt(5)
    s_barrier
    buffer_store_dword v221, v4, s[8:11], s29 offen sc1
    s_add_u32 s29, s29, 0x10000
    ds_read_b64_tr_b16 v[16:17], v14 offset:12288
    v_mfma_f32_16x16x32_bf16 v[164:167], v[28:31], a[28:31], v[164:167]
    v_mfma_f32_16x16x32_bf16 v[160:163], v[28:31], a[24:27], 0
    ds_read_b64_tr_b16 v[18:19], v14 offset:14336
    s_add_u32 m0, s18, 53248
    v_mfma_f32_16x16x32_bf16 v[160:163], v[24:27], a[8:11], v[160:163]
    v_add_u32 v220, 4718720, v3
    v_mfma_f32_16x16x32_bf16 v[156:159], v[24:27], a[4:7], 0
    ds_read_b64_tr_b16 v[20:21], v14 offset:16384
    v_mfma_f32_16x16x32_bf16 v[156:159], v[28:31], a[20:23], v[156:159]
    global_load_lds_dwordx4 v220, s[72:73]
    v_mfma_f32_16x16x32_bf16 v[152:155], v[28:31], a[16:19], 0
    ds_read_b64_tr_b16 v[22:23], v14 offset:18432
    s_add_u32 m0, s18, 57344
    v_mfma_f32_16x16x32_bf16 v[152:155], v[24:27], a[0:3], v[152:155]
    v_add_u32 v220, 5013632, v3
    s_waitcnt lgkmcnt(4)
    v_mfma_f32_16x16x32_bf16 v[136:139], v[32:35], a[32:35], v[136:139]
    ds_read_b64_tr_b16 v[24:25], v11 offset:20480
    v_mfma_f32_16x16x32_bf16 v[136:139], v[36:39], a[48:51], v[136:139]
    global_load_lds_dwordx4 v220, s[72:73]
PAD_6:
    s_cbranch_execz PAD_9
    v_mfma_f32_16x16x32_bf16 v[140:143], v[36:39], a[52:55], v[140:143]
    ds_read_b64_tr_b16 v[26:27], v11 offset:22528
    s_add_u32 m0, s18, 61440
    v_mfma_f32_16x16x32_bf16 v[140:143], v[32:35], a[36:39], v[140:143]
    v_add_u32 v220, 4718720, v3
    v_mfma_f32_16x16x32_bf16 v[144:147], v[32:35], a[40:43], v[144:147]
    ds_read_b64_tr_b16 v[28:29], v11 offset:24576
    v_mfma_f32_16x16x32_bf16 v[144:147], v[36:39], a[56:59], v[144:147]
    global_load_lds_dwordx4 v220, s[74:75]
    v_mfma_f32_16x16x32_bf16 v[148:151], v[36:39], a[60:63], v[148:151]
    ds_read_b64_tr_b16 v[30:31], v11 offset:26624
    v_mfma_f32_16x16x32_bf16 v[148:151], v[32:35], a[44:47], v[148:151]
    s_waitcnt lgkmcnt(4)
    v_mfma_f32_16x16x32_bf16 v[164:167], v[16:19], a[44:47], v[164:167]
    ds_read_b64_tr_b16 v[32:33], v11 offset:28672
    v_mfma_f32_16x16x32_bf16 v[164:167], v[20:23], a[60:63], v[164:167]
    v_mfma_f32_16x16x32_bf16 v[160:163], v[20:23], a[56:59], v[160:163]
    ds_read_b64_tr_b16 v[34:35], v11 offset:30720
    v_mfma_f32_16x16x32_bf16 v[160:163], v[16:19], a[40:43], v[160:163]
    v_mfma_f32_16x16x32_bf16 v[156:159], v[16:19], a[36:39], v[156:159]
    ds_read_b64_tr_b16 v[36:37], v11 offset:32768
    v_mfma_f32_16x16x32_bf16 v[156:159], v[20:23], a[52:55], v[156:159]
    v_mfma_f32_16x16x32_bf16 v[152:155], v[20:23], a[48:51], v[152:155]
    ds_read_b64_tr_b16 v[38:39], v11 offset:34816
    v_mfma_f32_16x16x32_bf16 v[152:155], v[16:19], a[32:35], v[152:155]
    s_waitcnt lgkmcnt(4)
    v_mfma_f32_16x16x32_bf16 v[40:43], v[24:27], a[64:67], v[40:43]
    s_barrier
    ds_read_b64_tr_b16 v[16:17], v12 offset:20480
    v_mfma_f32_16x16x32_bf16 v[40:43], v[28:31], a[80:83], v[40:43]
    v_mfma_f32_16x16x32_bf16 v[44:47], v[28:31], a[84:87], v[44:47]
    ds_read_b64_tr_b16 v[18:19], v12 offset:22528
    s_add_u32 m0, s18, 65536
    v_mfma_f32_16x16x32_bf16 v[44:47], v[24:27], a[68:71], v[44:47]
    v_add_u32 v220, 5013632, v3
    v_mfma_f32_16x16x32_bf16 v[48:51], v[24:27], a[72:75], v[48:51]
    ds_read_b64_tr_b16 v[20:21], v12 offset:24576
    v_mfma_f32_16x16x32_bf16 v[48:51], v[28:31], a[88:91], v[48:51]
    global_load_lds_dwordx4 v220, s[74:75]
    v_mfma_f32_16x16x32_bf16 v[52:55], v[28:31], a[92:95], v[52:55]
    ds_read_b64_tr_b16 v[22:23], v12 offset:26624
    s_add_u32 m0, s18, 73728
    v_mfma_f32_16x16x32_bf16 v[52:55], v[24:27], a[76:79], v[52:55]
    v_add_u32 v220, 0, v5
    s_waitcnt lgkmcnt(4)
    v_mfma_f32_16x16x32_bf16 v[68:71], v[32:35], a[76:79], v[68:71]
    ds_read_b64_tr_b16 v[24:25], v12 offset:28672
    v_mfma_f32_16x16x32_bf16 v[68:71], v[36:39], a[92:95], v[68:71]
    global_load_lds_dwordx4 v220, s[76:77]
    v_mfma_f32_16x16x32_bf16 v[64:67], v[36:39], a[88:91], v[64:67]
    ds_read_b64_tr_b16 v[26:27], v12 offset:30720
    s_add_u32 m0, s18, 77824
    v_mfma_f32_16x16x32_bf16 v[64:67], v[32:35], a[72:75], v[64:67]
    v_add_u32 v220, 663552, v5
    v_mfma_f32_16x16x32_bf16 v[60:63], v[32:35], a[68:71], v[60:63]
    ds_read_b64_tr_b16 v[28:29], v12 offset:32768
    v_mfma_f32_16x16x32_bf16 v[60:63], v[36:39], a[84:87], v[60:63]
    global_load_lds_dwordx4 v220, s[76:77]
    v_mfma_f32_16x16x32_bf16 v[56:59], v[36:39], a[80:83], v[56:59]
    ds_read_b64_tr_b16 v[30:31], v12 offset:34816
    v_mfma_f32_16x16x32_bf16 v[56:59], v[32:35], a[64:67], v[56:59]
    s_waitcnt lgkmcnt(4)
    v_mfma_f32_16x16x32_bf16 v[72:75], v[16:19], a[64:67], v[72:75]
    ds_read_b64_tr_b16 v[32:33], v13 offset:20480
    v_mfma_f32_16x16x32_bf16 v[72:75], v[20:23], a[80:83], v[72:75]
    v_mfma_f32_16x16x32_bf16 v[76:79], v[20:23], a[84:87], v[76:79]
    ds_read_b64_tr_b16 v[34:35], v13 offset:22528
    v_mfma_f32_16x16x32_bf16 v[76:79], v[16:19], a[68:71], v[76:79]
    v_mfma_f32_16x16x32_bf16 v[80:83], v[16:19], a[72:75], v[80:83]
    ds_read_b64_tr_b16 v[36:37], v13 offset:24576
    v_mfma_f32_16x16x32_bf16 v[80:83], v[20:23], a[88:91], v[80:83]
    v_mfma_f32_16x16x32_bf16 v[84:87], v[20:23], a[92:95], v[84:87]
    ds_read_b64_tr_b16 v[38:39], v13 offset:26624
    v_mfma_f32_16x16x32_bf16 v[84:87], v[16:19], a[76:79], v[84:87]
    s_waitcnt lgkmcnt(4)
    v_mfma_f32_16x16x32_bf16 v[100:103], v[24:27], a[76:79], v[100:103]
    ds_read_b64_tr_b16 v[16:17], v13 offset:28672
    v_mfma_f32_16x16x32_bf16 v[100:103], v[28:31], a[92:95], v[100:103]
    v_mfma_f32_16x16x32_bf16 v[96:99], v[28:31], a[88:91], v[96:99]
    ds_read_b64_tr_b16 v[18:19], v13 offset:30720
    v_mfma_f32_16x16x32_bf16 v[96:99], v[24:27], a[72:75], v[96:99]
    v_mfma_f32_16x16x32_bf16 v[92:95], v[24:27], a[68:71], v[92:95]
    ds_read_b64_tr_b16 v[20:21], v13 offset:32768
    v_mfma_f32_16x16x32_bf16 v[92:95], v[28:31], a[84:87], v[92:95]
    v_mfma_f32_16x16x32_bf16 v[88:91], v[28:31], a[80:83], v[88:91]
    ds_read_b64_tr_b16 v[22:23], v13 offset:34816
    v_mfma_f32_16x16x32_bf16 v[88:91], v[24:27], a[64:67], v[88:91]
    s_waitcnt lgkmcnt(4)
    v_mfma_f32_16x16x32_bf16 v[104:107], v[32:35], a[64:67], v[104:107]
    ds_read_b64_tr_b16 v[24:25], v14 offset:20480
    v_mfma_f32_16x16x32_bf16 v[104:107], v[36:39], a[80:83], v[104:107]
    v_mfma_f32_16x16x32_bf16 v[108:111], v[36:39], a[84:87], v[108:111]
    ds_read_b64_tr_b16 v[26:27], v14 offset:22528
    v_mfma_f32_16x16x32_bf16 v[108:111], v[32:35], a[68:71], v[108:111]
    v_mfma_f32_16x16x32_bf16 v[112:115], v[32:35], a[72:75], v[112:115]
    ds_read_b64_tr_b16 v[28:29], v14 offset:24576
    v_mfma_f32_16x16x32_bf16 v[112:115], v[36:39], a[88:91], v[112:115]
    v_mfma_f32_16x16x32_bf16 v[116:119], v[36:39], a[92:95], v[116:119]
    ds_read_b64_tr_b16 v[30:31], v14 offset:26624
    v_mfma_f32_16x16x32_bf16 v[116:119], v[32:35], a[76:79], v[116:119]
    s_waitcnt lgkmcnt(4)
    v_mfma_f32_16x16x32_bf16 v[132:135], v[16:19], a[76:79], v[132:135]
    ds_read_b64_tr_b16 v[32:33], v14 offset:28672
    v_mfma_f32_16x16x32_bf16 v[132:135], v[20:23], a[92:95], v[132:135]
    v_mfma_f32_16x16x32_bf16 v[128:131], v[20:23], a[88:91], v[128:131]
    ds_read_b64_tr_b16 v[34:35], v14 offset:30720
    v_mfma_f32_16x16x32_bf16 v[128:131], v[16:19], a[72:75], v[128:131]
    v_mfma_f32_16x16x32_bf16 v[124:127], v[16:19], a[68:71], v[124:127]
    ds_read_b64_tr_b16 v[36:37], v14 offset:32768
    v_mfma_f32_16x16x32_bf16 v[124:127], v[20:23], a[84:87], v[124:127]
    v_mfma_f32_16x16x32_bf16 v[120:123], v[20:23], a[80:83], v[120:123]
    ds_read_b64_tr_b16 v[38:39], v14 offset:34816
    v_mfma_f32_16x16x32_bf16 v[120:123], v[16:19], a[64:67], v[120:123]
    s_waitcnt lgkmcnt(4)
    v_mfma_f32_16x16x32_bf16 v[136:139], v[24:27], a[64:67], v[136:139]
    s_waitcnt vmcnt(7)
    s_barrier
    buffer_store_dword v221, v4, s[8:11], s29 offen sc1
    s_add_u32 s29, s29, 0x10000
    ds_read_b64_tr_b16 v[16:17], v11 offset:36864
    v_mfma_f32_16x16x32_bf16 v[136:139], v[28:31], a[80:83], v[136:139]
    v_mfma_f32_16x16x32_bf16 v[140:143], v[28:31], a[84:87], v[140:143]
    ds_read_b64_tr_b16 v[18:19], v11 offset:38912
    s_add_u32 m0, s18, 81920
    v_mfma_f32_16x16x32_bf16 v[140:143], v[24:27], a[68:71], v[140:143]
    v_add_u32 v220, 147456, v5
    v_mfma_f32_16x16x32_bf16 v[144:147], v[24:27], a[72:75], v[144:147]
    ds_read_b64_tr_b16 v[20:21], v11 offset:40960
    v_mfma_f32_16x16x32_bf16 v[144:147], v[28:31], a[88:91], v[144:147]
    global_load_lds_dwordx4 v220, s[76:77]
    v_mfma_f32_16x16x32_bf16 v[148:151], v[28:31], a[92:95], v[148:151]
    ds_read_b64_tr_b16 v[22:23], v11 offset:43008
    s_add_u32 m0, s18, 86016
    v_mfma_f32_16x16x32_bf16 v[148:151], v[24:27], a[76:79], v[148:151]
    v_add_u32 v220, 811008, v5
    buffer_load_dword v216, v222, s[8:11], s42 offen sc1
    s_waitcnt lgkmcnt(4)
    v_mfma_f32_16x16x32_bf16 v[164:167], v[32:35], a[76:79], v[164:167]
    ds_read_b64_tr_b16 v[24:25], v11 offset:45056
    v_mfma_f32_16x16x32_bf16 v[164:167], v[36:39], a[92:95], v[164:167]
    global_load_lds_dwordx4 v220, s[76:77]
    v_mfma_f32_16x16x32_bf16 v[160:163], v[36:39], a[88:91], v[160:163]
    ds_read_b64_tr_b16 v[26:27], v11 offset:47104
    v_mfma_f32_16x16x32_bf16 v[160:163], v[32:35], a[72:75], v[160:163]
    v_mfma_f32_16x16x32_bf16 v[156:159], v[32:35], a[68:71], v[156:159]
    ds_read_b64_tr_b16 v[28:29], v11 offset:49152
    v_mfma_f32_16x16x32_bf16 v[156:159], v[36:39], a[84:87], v[156:159]
    v_mfma_f32_16x16x32_bf16 v[152:155], v[36:39], a[80:83], v[152:155]
    ds_read_b64_tr_b16 v[30:31], v11 offset:51200
    v_mfma_f32_16x16x32_bf16 v[152:155], v[32:35], a[64:67], v[152:155]
    s_waitcnt lgkmcnt(4)
    v_mfma_f32_16x16x32_bf16 v[40:43], v[16:19], a[96:99], v[40:43]
    ds_read_b64_tr_b16 v[32:33], v12 offset:36864
    v_mfma_f32_16x16x32_bf16 v[40:43], v[20:23], a[112:115], v[40:43]
    v_mfma_f32_16x16x32_bf16 v[44:47], v[20:23], a[116:119], v[44:47]
    ds_read_b64_tr_b16 v[34:35], v12 offset:38912
    v_mfma_f32_16x16x32_bf16 v[44:47], v[16:19], a[100:103], v[44:47]
    v_mfma_f32_16x16x32_bf16 v[48:51], v[16:19], a[104:107], v[48:51]
    ds_read_b64_tr_b16 v[36:37], v12 offset:40960
    v_mfma_f32_16x16x32_bf16 v[48:51], v[20:23], a[120:123], v[48:51]
    v_mfma_f32_16x16x32_bf16 v[52:55], v[20:23], a[124:127], v[52:55]
    ds_read_b64_tr_b16 v[38:39], v12 offset:43008
    v_mfma_f32_16x16x32_bf16 v[52:55], v[16:19], a[108:111], v[52:55]
    s_waitcnt lgkmcnt(4)
    v_mfma_f32_16x16x32_bf16 v[68:71], v[24:27], a[108:111], v[68:71]
    ds_read_b64_tr_b16 v[16:17], v12 offset:45056
    v_mfma_f32_16x16x32_bf16 v[68:71], v[28:31], a[124:127], v[68:71]
    v_mfma_f32_16x16x32_bf16 v[64:67], v[28:31], a[120:123], v[64:67]
    ds_read_b64_tr_b16 v[18:19], v12 offset:47104
    v_mfma_f32_16x16x32_bf16 v[64:67], v[24:27], a[104:107], v[64:67]
    v_mfma_f32_16x16x32_bf16 v[60:63], v[24:27], a[100:103], v[60:63]
    ds_read_b64_tr_b16 v[20:21], v12 offset:49152
    v_mfma_f32_16x16x32_bf16 v[60:63], v[28:31], a[116:119], v[60:63]
    v_mfma_f32_16x16x32_bf16 v[56:59], v[28:31], a[112:115], v[56:59]
    ds_read_b64_tr_b16 v[22:23], v12 offset:51200
    v_mfma_f32_16x16x32_bf16 v[56:59], v[24:27], a[96:99], v[56:59]
    s_waitcnt lgkmcnt(4)
    v_mfma_f32_16x16x32_bf16 v[72:75], v[32:35], a[96:99], v[72:75]
    ds_read_b64_tr_b16 v[24:25], v13 offset:36864
    v_mfma_f32_16x16x32_bf16 v[72:75], v[36:39], a[112:115], v[72:75]
    v_mfma_f32_16x16x32_bf16 v[76:79], v[36:39], a[116:119], v[76:79]
    ds_read_b64_tr_b16 v[26:27], v13 offset:38912
    v_mfma_f32_16x16x32_bf16 v[76:79], v[32:35], a[100:103], v[76:79]
    v_mfma_f32_16x16x32_bf16 v[80:83], v[32:35], a[104:107], v[80:83]
    ds_read_b64_tr_b16 v[28:29], v13 offset:40960
    v_mfma_f32_16x16x32_bf16 v[80:83], v[36:39], a[120:123], v[80:83]
    v_mfma_f32_16x16x32_bf16 v[84:87], v[36:39], a[124:127], v[84:87]
    ds_read_b64_tr_b16 v[30:31], v13 offset:43008
    v_mfma_f32_16x16x32_bf16 v[84:87], v[32:35], a[108:111], v[84:87]
    s_waitcnt vmcnt(1)
    v_cmp_ne_u32 vcc, s6, v216
    s_cbranch_vccnz PS_34
PK_33:
    s_waitcnt lgkmcnt(4)
    v_mfma_f32_16x16x32_bf16 v[100:103], v[16:19], a[108:111], v[100:103]
    ds_read_b64_tr_b16 v[32:33], v13 offset:45056
    v_add_u32 v219, 0, v1
    v_mfma_f32_16x16x32_bf16 v[100:103], v[20:23], a[124:127], v[100:103]
    global_load_dwordx4 a[0:3], v219, s[80:81] offset:0 sc1
    v_mfma_f32_16x16x32_bf16 v[96:99], v[20:23], a[120:123], v[96:99]
    ds_read_b64_tr_b16 v[34:35], v13 offset:47104
    v_mfma_f32_16x16x32_bf16 v[96:99], v[16:19], a[104:107], v[96:99]
    v_mfma_f32_16x16x32_bf16 v[92:95], v[16:19], a[100:103], v[92:95]
    ds_read_b64_tr_b16 v[36:37], v13 offset:49152
    v_mfma_f32_16x16x32_bf16 v[92:95], v[20:23], a[116:119], v[92:95]
    global_load_dwordx4 a[4:7], v219, s[80:81] offset:1024 sc1
    v_mfma_f32_16x16x32_bf16 v[88:91], v[20:23], a[112:115], v[88:91]
    ds_read_b64_tr_b16 v[38:39], v13 offset:51200
    v_mfma_f32_16x16x32_bf16 v[88:91], v[16:19], a[96:99], v[88:91]
    s_waitcnt lgkmcnt(4)
    v_mfma_f32_16x16x32_bf16 v[104:107], v[24:27], a[96:99], v[104:107]
    s_barrier
    ds_read_b64_tr_b16 v[16:17], v14 offset:36864
    v_mfma_f32_16x16x32_bf16 v[104:107], v[28:31], a[112:115], v[104:107]
    global_load_dwordx4 a[8:11], v219, s[82:83] offset:2048 sc1
    v_mfma_f32_16x16x32_bf16 v[108:111], v[28:31], a[116:119], v[108:111]
    ds_read_b64_tr_b16 v[18:19], v14 offset:38912
    v_mfma_f32_16x16x32_bf16 v[108:111], v[24:27], a[100:103], v[108:111]
    v_mfma_f32_16x16x32_bf16 v[112:115], v[24:27], a[104:107], v[112:115]
    ds_read_b64_tr_b16 v[20:21], v14 offset:40960
    v_mfma_f32_16x16x32_bf16 v[112:115], v[28:31], a[120:123], v[112:115]
    v_mfma_f32_16x16x32_bf16 v[116:119], v[28:31], a[124:127], v[116:119]
    ds_read_b64_tr_b16 v[22:23], v14 offset:43008
    v_mfma_f32_16x16x32_bf16 v[116:119], v[24:27], a[108:111], v[116:119]
    global_load_dwordx4 a[12:15], v219, s[82:83] offset:3072 sc1
    s_waitcnt lgkmcnt(4)
    v_mfma_f32_16x16x32_bf16 v[132:135], v[32:35], a[108:111], v[132:135]
    ds_read_b64_tr_b16 v[24:25], v14 offset:45056
    v_add_u32 v219, 4096, v1
    v_mfma_f32_16x16x32_bf16 v[132:135], v[36:39], a[124:127], v[132:135]
    v_mfma_f32_16x16x32_bf16 v[128:131], v[36:39], a[120:123], v[128:131]
    ds_read_b64_tr_b16 v[26:27], v14 offset:47104
    v_mfma_f32_16x16x32_bf16 v[128:131], v[32:35], a[104:107], v[128:131]
    global_load_dwordx4 a[16:19], v219, s[80:81] offset:0 sc1
    v_mfma_f32_16x16x32_bf16 v[124:127], v[32:35], a[100:103], v[124:127]
    ds_read_b64_tr_b16 v[28:29], v14 offset:49152
    v_mfma_f32_16x16x32_bf16 v[124:127], v[36:39], a[116:119], v[124:127]
    v_mfma_f32_16x16x32_bf16 v[120:123], v[36:39], a[112:115], v[120:123]
    ds_read_b64_tr_b16 v[30:31], v14 offset:51200
    v_mfma_f32_16x16x32_bf16 v[120:123], v[32:35], a[96:99], v[120:123]
    s_waitcnt lgkmcnt(4)
    v_mfma_f32_16x16x32_bf16 v[136:139], v[16:19], a[96:99], v[136:139]
    ds_read_b64_tr_b16 v[32:33], v11 offset:53248
    v_mfma_f32_16x16x32_bf16 v[136:139], v[20:23], a[112:115], v[136:139]
    global_load_dwordx4 a[20:23], v219, s[80:81] offset:1024 sc1
    v_mfma_f32_16x16x32_bf16 v[140:143], v[20:23], a[116:119], v[140:143]
    ds_read_b64_tr_b16 v[34:35], v11 offset:55296
    v_mfma_f32_16x16x32_bf16 v[140:143], v[16:19], a[100:103], v[140:143]
    v_mfma_f32_16x16x32_bf16 v[144:147], v[16:19], a[104:107], v[144:147]
    ds_read_b64_tr_b16 v[36:37], v11 offset:57344
    v_mfma_f32_16x16x32_bf16 v[144:147], v[20:23], a[120:123], v[144:147]
    global_load_dwordx4 a[24:27], v219, s[82:83] offset:2048 sc1
    v_mfma_f32_16x16x32_bf16 v[148:151], v[20:23], a[124:127], v[148:151]
    ds_read_b64_tr_b16 v[38:39], v11 offset:59392
    v_mfma_f32_16x16x32_bf16 v[148:151], v[16:19], a[108:111], v[148:151]
    s_waitcnt lgkmcnt(4)
    v_mfma_f32_16x16x32_bf16 v[164:167], v[24:27], a[108:111], v[164:167]
    ds_read_b64_tr_b16 v[16:17], v11 offset:61440
    v_mfma_f32_16x16x32_bf16 v[164:167], v[28:31], a[124:127], v[164:167]
    v_mfma_f32_16x16x32_bf16 v[160:163], v[28:31], a[120:123], v[160:163]
    ds_read_b64_tr_b16 v[18:19], v11 offset:63488
    v_mfma_f32_16x16x32_bf16 v[160:163], v[24:27], a[104:107], v[160:163]
    global_load_dwordx4 a[28:31], v219, s[82:83] offset:3072 sc1
    v_mfma_f32_16x16x32_bf16 v[156:159], v[24:27], a[100:103], v[156:159]
    ds_read_b64_tr_b16 v[20:21], v6 offset:0
    v_add_u32 v219, 8192, v1
    v_mfma_f32_16x16x32_bf16 v[156:159], v[28:31], a[116:119], v[156:159]
    v_mfma_f32_16x16x32_bf16 v[152:155], v[28:31], a[112:115], v[152:155]
    ds_read_b64_tr_b16 v[22:23], v6 offset:2048
    v_mfma_f32_16x16x32_bf16 v[152:155], v[24:27], a[96:99], v[152:155]
    global_load_dwordx4 a[32:35], v219, s[80:81] offset:0 sc1
    s_waitcnt lgkmcnt(4)
    v_mfma_f32_16x16x32_bf16 v[40:43], v[32:35], a[128:131], v[40:43]
    ds_read_b64_tr_b16 v[24:25], v12 offset:53248
    v_mfma_f32_16x16x32_bf16 v[40:43], v[36:39], a[144:147], v[40:43]
    v_mfma_f32_16x16x32_bf16 v[44:47], v[36:39], a[148:151], v[44:47]
    ds_read_b64_tr_b16 v[26:27], v12 offset:55296
    v_mfma_f32_16x16x32_bf16 v[44:47], v[32:35], a[132:135], v[44:47]
    v_mfma_f32_16x16x32_bf16 v[48:51], v[32:35], a[136:139], v[48:51]
    ds_read_b64_tr_b16 v[28:29], v12 offset:57344
    v_mfma_f32_16x16x32_bf16 v[48:51], v[36:39], a[152:155], v[48:51]
    global_load_dwordx4 a[36:39], v219, s[80:81] offset:1024 sc1
    v_mfma_f32_16x16x32_bf16 v[52:55], v[36:39], a[156:159], v[52:55]
    ds_read_b64_tr_b16 v[30:31], v12 offset:59392
    v_mfma_f32_16x16x32_bf16 v[52:55], v[32:35], a[140:143], v[52:55]
    s_waitcnt lgkmcnt(4)
    v_mfma_f32_16x16x32_bf16 v[68:71], v[16:19], a[140:143], v[68:71]
    ds_read_b64_tr_b16 v[32:33], v12 offset:61440
    v_mfma_f32_16x16x32_bf16 v[68:71], v[20:23], a[156:159], v[68:71]
    global_load_dwordx4 a[40:43], v219, s[82:83] offset:2048 sc1
    v_mfma_f32_16x16x32_bf16 v[64:67], v[20:23], a[152:155], v[64:67]
    ds_read_b64_tr_b16 v[34:35], v12 offset:63488
    v_mfma_f32_16x16x32_bf16 v[64:67], v[16:19], a[136:139], v[64:67]
    v_mfma_f32_16x16x32_bf16 v[60:63], v[16:19], a[132:135], v[60:63]
    ds_read_b64_tr_b16 v[36:37], v7 offset:0
    v_mfma_f32_16x16x32_bf16 v[60:63], v[20:23], a[148:151], v[60:63]
    v_mfma_f32_16x16x32_bf16 v[56:59], v[20:23], a[144:147], v[56:59]
    ds_read_b64_tr_b16 v[38:39], v7 offset:2048
    v_mfma_f32_16x16x32_bf16 v[56:59], v[16:19], a[128:131], v[56:59]
    global_load_dwordx4 a[44:47], v219, s[82:83] offset:3072 sc1
    s_waitcnt lgkmcnt(4)
    v_mfma_f32_16x16x32_bf16 v[72:75], v[24:27], a[128:131], v[72:75]
    s_barrier
    ds_read_b64_tr_b16 v[16:17], v13 offset:53248
    v_mfma_f32_16x16x32_bf16 v[72:75], v[28:31], a[144:147], v[72:75]
    v_add_u32 v219, 12288, v1
    v_mfma_f32_16x16x32_bf16 v[76:79], v[28:31], a[148:151], v[76:79]
    ds_read_b64_tr_b16 v[18:19], v13 offset:55296
    v_mfma_f32_16x16x32_bf16 v[76:79], v[24:27], a[132:135], v[76:79]
    global_load_dwordx4 a[48:51], v219, s[80:81] offset:0 sc1
    v_mfma_f32_16x16x32_bf16 v[80:83], v[24:27], a[136:139], v[80:83]
    ds_read_b64_tr_b16 v[20:21], v13 offset:57344
    v_mfma_f32_16x16x32_bf16 v[80:83], v[28:31], a[152:155], v[80:83]
    v_mfma_f32_16x16x32_bf16 v[84:87], v[28:31], a[156:159], v[84:87]
    ds_read_b64_tr_b16 v[22:23], v13 offset:59392
    v_mfma_f32_16x16x32_bf16 v[84:87], v[24:27], a[140:143], v[84:87]
    s_add_u32 s42, s42, 0x10000
    buffer_load_dword v216, v222, s[8:11], s42 offen sc1
    s_waitcnt lgkmcnt(4)
    v_mfma_f32_16x16x32_bf16 v[100:103], v[32:35], a[140:143], v[100:103]
    ds_read_b64_tr_b16 v[24:25], v13 offset:61440
    v_mfma_f32_16x16x32_bf16 v[100:103], v[36:39], a[156:159], v[100:103]
    global_load_dwordx4 a[52:55], v219, s[80:81] offset:1024 sc1
    v_mfma_f32_16x16x32_bf16 v[96:99], v[36:39], a[152:155], v[96:99]
    ds_read_b64_tr_b16 v[26:27], v13 offset:63488
    v_mfma_f32_16x16x32_bf16 v[96:99], v[32:35], a[136:139], v[96:99]
    v_mfma_f32_16x16x32_bf16 v[92:95], v[32:35], a[132:135], v[92:95]
    ds_read_b64_tr_b16 v[28:29], v8 offset:0
    v_mfma_f32_16x16x32_bf16 v[92:95], v[36:39], a[148:151], v[92:95]
    global_load_dwordx4 a[56:59], v219, s[82:83] offset:2048 sc1
    v_mfma_f32_16x16x32_bf16 v[88:91], v[36:39], a[144:147], v[88:91]
    ds_read_b64_tr_b16 v[30:31], v8 offset:2048
    v_mfma_f32_16x16x32_bf16 v[88:91], v[32:35], a[128:131], v[88:91]
    s_waitcnt lgkmcnt(4)
    v_mfma_f32_16x16x32_bf16 v[104:107], v[16:19], a[128:131], v[104:107]
    ds_read_b64_tr_b16 v[32:33], v14 offset:53248
    v_mfma_f32_16x16x32_bf16 v[104:107], v[20:23], a[144:147], v[104:107]
    v_mfma_f32_16x16x32_bf16 v[108:111], v[20:23], a[148:151], v[108:111]
    ds_read_b64_tr_b16 v[34:35], v14 offset:55296
    v_mfma_f32_16x16x32_bf16 v[108:111], v[16:19], a[132:135], v[108:111]
    global_load_dwordx4 a[60:63], v219, s[82:83] offset:3072 sc1
    v_mfma_f32_16x16x32_bf16 v[112:115], v[16:19], a[136:139], v[112:115]
    ds_read_b64_tr_b16 v[36:37], v14 offset:57344
    v_add_u32 v219, 16384, v1
    v_mfma_f32_16x16x32_bf16 v[112:115], v[20:23], a[152:155], v[112:115]
    v_mfma_f32_16x16x32_bf16 v[116:119], v[20:23], a[156:159], v[116:119]
    ds_read_b64_tr_b16 v[38:39], v14 offset:59392
    v_mfma_f32_16x16x32_bf16 v[116:119], v[16:19], a[140:143], v[116:119]
    global_load_dwordx4 a[64:67], v219, s[80:81] offset:0 sc1
    s_waitcnt lgkmcnt(4)
    v_mfma_f32_16x16x32_bf16 v[132:135], v[24:27], a[140:143], v[132:135]
    ds_read_b64_tr_b16 v[16:17], v14 offset:61440
    v_mfma_f32_16x16x32_bf16 v[132:135], v[28:31], a[156:159], v[132:135]
    v_mfma_f32_16x16x32_bf16 v[128:131], v[28:31], a[152:155], v[128:131]
    ds_read_b64_tr_b16 v[18:19], v14 offset:63488
    v_mfma_f32_16x16x32_bf16 v[128:131], v[24:27], a[136:139], v[128:131]
    v_mfma_f32_16x16x32_bf16 v[124:127], v[24:27], a[132:135], v[124:127]
    ds_read_b64_tr_b16 v[20:21], v9 offset:0
    v_mfma_f32_16x16x32_bf16 v[124:127], v[28:31], a[148:151], v[124:127]
    global_load_dwordx4 a[68:71], v219, s[80:81] offset:1024 sc1
    v_mfma_f32_16x16x32_bf16 v[120:123], v[28:31], a[144:147], v[120:123]
    ds_read_b64_tr_b16 v[22:23], v9 offset:2048
    v_mfma_f32_16x16x32_bf16 v[120:123], v[24:27], a[128:131], v[120:123]
    s_waitcnt lgkmcnt(4)
    v_mfma_f32_16x16x32_bf16 v[136:139], v[32:35], a[128:131], v[136:139]
    ds_read_b64_tr_b16 v[24:25], v6 offset:4096
    v_mfma_f32_16x16x32_bf16 v[136:139], v[36:39], a[144:147], v[136:139]
    global_load_dwordx4 a[72:75], v219, s[82:83] offset:2048 sc1
    v_mfma_f32_16x16x32_bf16 v[140:143], v[36:39], a[148:151], v[140:143]
    ds_read_b64_tr_b16 v[26:27], v6 offset:6144
    v_mfma_f32_16x16x32_bf16 v[140:143], v[32:35], a[132:135], v[140:143]
    v_mfma_f32_16x16x32_bf16 v[144:147], v[32:35], a[136:139], v[144:147]
    ds_read_b64_tr_b16 v[28:29], v6 offset:8192
    v_mfma_f32_16x16x32_bf16 v[144:147], v[36:39], a[152:155], v[144:147]
    v_mfma_f32_16x16x32_bf16 v[148:151], v[36:39], a[156:159], v[148:151]
    ds_read_b64_tr_b16 v[30:31], v6 offset:10240
    v_mfma_f32_16x16x32_bf16 v[148:151], v[32:35], a[140:143], v[148:151]
    global_load_dwordx4 a[76:79], v219, s[82:83] offset:3072 sc1
    s_waitcnt lgkmcnt(4)
    v_mfma_f32_16x16x32_bf16 v[164:167], v[16:19], a[140:143], v[164:167]
    ds_read_b64_tr_b16 v[32:33], v6 offset:12288
    v_add_u32 v219, 20480, v1
    v_mfma_f32_16x16x32_bf16 v[164:167], v[20:23], a[156:159], v[164:167]
    v_mfma_f32_16x16x32_bf16 v[160:163], v[20:23], a[152:155], v[160:163]
    ds_read_b64_tr_b16 v[34:35], v6 offset:14336
    v_mfma_f32_16x16x32_bf16 v[160:163], v[16:19], a[136:139], v[160:163]
    global_load_dwordx4 a[80:83], v219, s[80:81] offset:0 sc1
    v_mfma_f32_16x16x32_bf16 v[156:159], v[16:19], a[132:135], v[156:159]
    ds_read_b64_tr_b16 v[36:37], v6 offset:16384
    v_mfma_f32_16x16x32_bf16 v[156:159], v[20:23], a[148:151], v[156:159]
    v_mfma_f32_16x16x32_bf16 v[152:155], v[20:23], a[144:147], v[152:155]
    ds_read_b64_tr_b16 v[38:39], v6 offset:18432
    v_mfma_f32_16x16x32_bf16 v[152:155], v[16:19], a[128:131], v[152:155]
    s_waitcnt vmcnt(8)
    v_cmp_ne_u32 vcc, s6, v216
    s_cbranch_vccnz PS_36
PK_35:
    s_waitcnt lgkmcnt(4)
    v_mfma_f32_16x16x32_bf16 v[40:43], v[24:27], a[160:163], v[40:43]
    s_barrier
    ds_read_b64_tr_b16 v[16:17], v7 offset:4096
    v_mfma_f32_16x16x32_bf16 v[40:43], v[28:31], a[176:179], v[40:43]
    global_load_dwordx4 a[84:87], v219, s[80:81] offset:1024 sc1
    v_mfma_f32_16x16x32_bf16 v[44:47], v[28:31], a[180:183], v[44:47]
    ds_read_b64_tr_b16 v[18:19], v7 offset:6144
    v_mfma_f32_16x16x32_bf16 v[44:47], v[24:27], a[164:167], v[44:47]
    v_mfma_f32_16x16x32_bf16 v[48:51], v[24:27], a[168:171], v[48:51]
    ds_read_b64_tr_b16 v[20:21], v7 offset:8192
    v_mfma_f32_16x16x32_bf16 v[48:51], v[28:31], a[184:187], v[48:51]
    global_load_dwordx4 a[88:91], v219, s[82:83] offset:2048 sc1
    v_mfma_f32_16x16x32_bf16 v[52:55], v[28:31], a[188:191], v[52:55]
    ds_read_b64_tr_b16 v[22:23], v7 offset:10240
    v_mfma_f32_16x16x32_bf16 v[52:55], v[24:27], a[172:175], v[52:55]
    s_waitcnt lgkmcnt(4)
    v_mfma_f32_16x16x32_bf16 v[68:71], v[32:35], a[172:175], v[68:71]
    ds_read_b64_tr_b16 v[24:25], v7 offset:12288
    v_mfma_f32_16x16x32_bf16 v[68:71], v[36:39], a[188:191], v[68:71]
    v_mfma_f32_16x16x32_bf16 v[64:67], v[36:39], a[184:187], v[64:67]
    ds_read_b64_tr_b16 v[26:27], v7 offset:14336
    v_mfma_f32_16x16x32_bf16 v[64:67], v[32:35], a[168:171], v[64:67]
    global_load_dwordx4 a[92:95], v219, s[82:83] offset:3072 sc1
    v_mfma_f32_16x16x32_bf16 v[60:63], v[32:35], a[164:167], v[60:63]
    ds_read_b64_tr_b16 v[28:29], v7 offset:16384
    v_add_u32 v219, 24576, v1
    v_mfma_f32_16x16x32_bf16 v[60:63], v[36:39], a[180:183], v[60:63]
    v_mfma_f32_16x16x32_bf16 v[56:59], v[36:39], a[176:179], v[56:59]
    ds_read_b64_tr_b16 v[30:31], v7 offset:18432
    v_mfma_f32_16x16x32_bf16 v[56:59], v[32:35], a[160:163], v[56:59]
    global_load_dwordx4 a[96:99], v219, s[80:81] offset:0 sc1
    s_waitcnt lgkmcnt(4)
    v_mfma_f32_16x16x32_bf16 v[72:75], v[16:19], a[160:163], v[72:75]
    ds_read_b64_tr_b16 v[32:33], v8 offset:4096
    v_mfma_f32_16x16x32_bf16 v[72:75], v[20:23], a[176:179], v[72:75]
    v_mfma_f32_16x16x32_bf16 v[76:79], v[20:23], a[180:183], v[76:79]
    ds_read_b64_tr_b16 v[34:35], v8 offset:6144
    v_mfma_f32_16x16x32_bf16 v[76:79], v[16:19], a[164:167], v[76:79]
    v_mfma_f32_16x16x32_bf16 v[80:83], v[16:19], a[168:171], v[80:83]
    ds_read_b64_tr_b16 v[36:37], v8 offset:8192
    v_mfma_f32_16x16x32_bf16 v[80:83], v[20:23], a[184:187], v[80:83]
    global_load_dwordx4 a[100:103], v219, s[80:81] offset:1024 sc1
    v_mfma_f32_16x16x32_bf16 v[84:87], v[20:23], a[188:191], v[84:87]
    ds_read_b64_tr_b16 v[38:39], v8 offset:10240
    v_mfma_f32_16x16x32_bf16 v[84:87], v[16:19], a[172:175], v[84:87]
    s_waitcnt lgkmcnt(4)
    v_mfma_f32_16x16x32_bf16 v[100:103], v[24:27], a[172:175], v[100:103]
    ds_read_b64_tr_b16 v[16:17], v8 offset:12288
    v_mfma_f32_16x16x32_bf16 v[100:103], v[28:31], a[188:191], v[100:103]
    global_load_dwordx4 a[104:107], v219, s[82:83] offset:2048 sc1
    v_mfma_f32_16x16x32_bf16 v[96:99], v[28:31], a[184:187], v[96:99]
    ds_read_b64_tr_b16 v[18:19], v8 offset:14336
    v_mfma_f32_16x16x32_bf16 v[96:99], v[24:27], a[168:171], v[96:99]
    v_mfma_f32_16x16x32_bf16 v[92:95], v[24:27], a[164:167], v[92:95]
    ds_read_b64_tr_b16 v[20:21], v8 offset:16384
    v_mfma_f32_16x16x32_bf16 v[92:95], v[28:31], a[180:183], v[92:95]
    v_mfma_f32_16x16x32_bf16 v[88:91], v[28:31], a[176:179], v[88:91]
    ds_read_b64_tr_b16 v[22:23], v8 offset:18432
    v_mfma_f32_16x16x32_bf16 v[88:91], v[24:27], a[160:163], v[88:91]
    global_load_dwordx4 a[108:111], v219, s[82:83] offset:3072 sc1
    s_waitcnt lgkmcnt(4)
    v_mfma_f32_16x16x32_bf16 v[104:107], v[32:35], a[160:163], v[104:107]
    ds_read_b64_tr_b16 v[24:25], v9 offset:4096
    v_add_u32 v219, 28672, v1
    v_mfma_f32_16x16x32_bf16 v[104:107], v[36:39], a[176:179], v[104:107]
    v_mfma_f32_16x16x32_bf16 v[108:111], v[36:39], a[180:183], v[108:111]
    ds_read_b64_tr_b16 v[26:27], v9 offset:6144
    v_mfma_f32_16x16x32_bf16 v[108:111], v[32:35], a[164:167], v[108:111]
    global_load_dwordx4 a[112:115], v219, s[80:81] offset:0 sc1
    v_mfma_f32_16x16x32_bf16 v[112:115], v[32:35], a[168:171], v[112:115]
    ds_read_b64_tr_b16 v[28:29], v9 offset:8192
    v_mfma_f32_16x16x32_bf16 v[112:115], v[36:39], a[184:187], v[112:115]
    v_mfma_f32_16x16x32_bf16 v[116:119], v[36:39], a[188:191], v[116:119]
    ds_read_b64_tr_b16 v[30:31], v9 offset:10240
    v_mfma_f32_16x16x32_bf16 v[116:119], v[32:35], a[172:175], v[116:119]
    s_waitcnt lgkmcnt(4)
    v_mfma_f32_16x16x32_bf16 v[132:135], v[16:19], a[172:175], v[132:135]
    ds_read_b64_tr_b16 v[32:33], v9 offset:12288
    v_mfma_f32_16x16x32_bf16 v[132:135], v[20:23], a[188:191], v[132:135]
    global_load_dwordx4 a[116:119], v219, s[80:81] offset:1024 sc1
    v_mfma_f32_16x16x32_bf16 v[128:131], v[20:23], a[184:187], v[128:131]
    ds_read_b64_tr_b16 v[34:35], v9 offset:14336
    v_mfma_f32_16x16x32_bf16 v[128:131], v[16:19], a[168:171], v[128:131]
    v_mfma_f32_16x16x32_bf16 v[124:127], v[16:19], a[164:167], v[124:127]
    ds_read_b64_tr_b16 v[36:37], v9 offset:16384
    v_mfma_f32_16x16x32_bf16 v[124:127], v[20:23], a[180:183], v[124:127]
    global_load_dwordx4 a[120:123], v219, s[82:83] offset:2048 sc1
    v_mfma_f32_16x16x32_bf16 v[120:123], v[20:23], a[176:179], v[120:123]
    ds_read_b64_tr_b16 v[38:39], v9 offset:18432
    v_mfma_f32_16x16x32_bf16 v[120:123], v[16:19], a[160:163], v[120:123]
    s_waitcnt lgkmcnt(4)
    v_mfma_f32_16x16x32_bf16 v[136:139], v[24:27], a[160:163], v[136:139]
    s_barrier
    ds_read_b64_tr_b16 v[16:17], v6 offset:20480
    v_mfma_f32_16x16x32_bf16 v[136:139], v[28:31], a[176:179], v[136:139]
    v_mfma_f32_16x16x32_bf16 v[140:143], v[28:31], a[180:183], v[140:143]
    ds_read_b64_tr_b16 v[18:19], v6 offset:22528
    v_mfma_f32_16x16x32_bf16 v[140:143], v[24:27], a[164:167], v[140:143]
    global_load_dwordx4 a[124:127], v219, s[82:83] offset:3072 sc1
    v_mfma_f32_16x16x32_bf16 v[144:147], v[24:27], a[168:171], v[144:147]
    ds_read_b64_tr_b16 v[20:21], v6 offset:24576
    v_add_u32 v219, 65536, v2
    v_mfma_f32_16x16x32_bf16 v[144:147], v[28:31], a[184:187], v[144:147]
    v_mfma_f32_16x16x32_bf16 v[148:151], v[28:31], a[188:191], v[148:151]
    ds_read_b64_tr_b16 v[22:23], v6 offset:26624
    v_mfma_f32_16x16x32_bf16 v[148:151], v[24:27], a[172:175], v[148:151]
    global_load_dwordx2 a[128:129], v219, s[80:81] offset:0 sc1
    s_waitcnt lgkmcnt(4)
    v_mfma_f32_16x16x32_bf16 v[164:167], v[32:35], a[172:175], v[164:167]
    ds_read_b64_tr_b16 v[24:25], v6 offset:28672
    v_mfma_f32_16x16x32_bf16 v[164:167], v[36:39], a[188:191], v[164:167]
    v_mfma_f32_16x16x32_bf16 v[160:163], v[36:39], a[184:187], v[160:163]
    ds_read_b64_tr_b16 v[26:27], v6 offset:30720
    v_mfma_f32_16x16x32_bf16 v[160:163], v[32:35], a[168:171], v[160:163]
    global_load_dwordx2 a[130:131], v219, s[80:81] offset:512 sc1
    v_mfma_f32_16x16x32_bf16 v[156:159], v[32:35], a[164:167], v[156:159]
    ds_read_b64_tr_b16 v[28:29], v6 offset:32768
    v_mfma_f32_16x16x32_bf16 v[156:159], v[36:39], a[180:183], v[156:159]
    global_load_dwordx2 a[132:133], v219, s[80:81] offset:1024 sc1
    v_mfma_f32_16x16x32_bf16 v[152:155], v[36:39], a[176:179], v[152:155]
    ds_read_b64_tr_b16 v[30:31], v6 offset:34816
    v_mfma_f32_16x16x32_bf16 v[152:155], v[32:35], a[160:163], v[152:155]
    s_waitcnt lgkmcnt(4)
    v_mfma_f32_16x16x32_bf16 v[40:43], v[16:19], a[192:195], v[40:43]
    ds_read_b64_tr_b16 v[32:33], v7 offset:20480
    v_mfma_f32_16x16x32_bf16 v[40:43], v[20:23], a[208:211], v[40:43]
    global_load_dwordx2 a[134:135], v219, s[80:81] offset:1536 sc1
    v_mfma_f32_16x16x32_bf16 v[44:47], v[20:23], a[212:215], v[44:47]
    ds_read_b64_tr_b16 v[34:35], v7 offset:22528
    v_mfma_f32_16x16x32_bf16 v[44:47], v[16:19], a[196:199], v[44:47]
    global_load_dwordx2 a[136:137], v219, s[82:83] offset:2048 sc1
    v_mfma_f32_16x16x32_bf16 v[48:51], v[16:19], a[200:203], v[48:51]
    ds_read_b64_tr_b16 v[36:37], v7 offset:24576
    v_mfma_f32_16x16x32_bf16 v[48:51], v[20:23], a[216:219], v[48:51]
    v_mfma_f32_16x16x32_bf16 v[52:55], v[20:23], a[220:223], v[52:55]
    ds_read_b64_tr_b16 v[38:39], v7 offset:26624
    v_mfma_f32_16x16x32_bf16 v[52:55], v[16:19], a[204:207], v[52:55]
    global_load_dwordx2 a[138:139], v219, s[82:83] offset:2560 sc1
    s_waitcnt lgkmcnt(4)
    v_mfma_f32_16x16x32_bf16 v[68:71], v[24:27], a[204:207], v[68:71]
    ds_read_b64_tr_b16 v[16:17], v7 offset:28672
PAD_7:
    s_cbranch_execz PAD_10
    v_mfma_f32_16x16x32_bf16 v[68:71], v[28:31], a[220:223], v[68:71]
    global_load_dwordx2 a[140:141], v219, s[82:83] offset:3072 sc1
    v_mfma_f32_16x16x32_bf16 v[64:67], v[28:31], a[216:219], v[64:67]
    ds_read_b64_tr_b16 v[18:19], v7 offset:30720
    v_mfma_f32_16x16x32_bf16 v[64:67], v[24:27], a[200:203], v[64:67]
    v_mfma_f32_16x16x32_bf16 v[60:63], v[24:27], a[196:199], v[60:63]
    ds_read_b64_tr_b16 v[20:21], v7 offset:32768
    v_mfma_f32_16x16x32_bf16 v[60:63], v[28:31], a[212:215], v[60:63]
    global_load_dwordx2 a[142:143], v219, s[82:83] offset:3584 sc1
    v_mfma_f32_16x16x32_bf16 v[56:59], v[28:31], a[208:211], v[56:59]
    ds_read_b64_tr_b16 v[22:23], v7 offset:34816
    v_add_u32 v219, 69632, v2
    v_mfma_f32_16x16x32_bf16 v[56:59], v[24:27], a[192:195], v[56:59]
    global_load_dwordx2 a[144:145], v219, s[80:81] offset:0 sc1
    s_waitcnt lgkmcnt(4)
    v_mfma_f32_16x16x32_bf16 v[72:75], v[32:35], a[192:195], v[72:75]
    ds_read_b64_tr_b16 v[24:25], v8 offset:20480
    v_mfma_f32_16x16x32_bf16 v[72:75], v[36:39], a[208:211], v[72:75]
    v_mfma_f32_16x16x32_bf16 v[76:79], v[36:39], a[212:215], v[76:79]
    ds_read_b64_tr_b16 v[26:27], v8 offset:22528
    v_mfma_f32_16x16x32_bf16 v[76:79], v[32:35], a[196:199], v[76:79]
    global_load_dwordx2 a[146:147], v219, s[80:81] offset:512 sc1
    v_mfma_f32_16x16x32_bf16 v[80:83], v[32:35], a[200:203], v[80:83]
    ds_read_b64_tr_b16 v[28:29], v8 offset:24576
    v_mfma_f32_16x16x32_bf16 v[80:83], v[36:39], a[216:219], v[80:83]
    global_load_dwordx2 a[148:149], v219, s[80:81] offset:1024 sc1
    v_mfma_f32_16x16x32_bf16 v[84:87], v[36:39], a[220:223], v[84:87]
    ds_read_b64_tr_b16 v[30:31], v8 offset:26624
    v_mfma_f32_16x16x32_bf16 v[84:87], v[32:35], a[204:207], v[84:87]
    s_waitcnt lgkmcnt(4)
    v_mfma_f32_16x16x32_bf16 v[100:103], v[16:19], a[204:207], v[100:103]
    ds_read_b64_tr_b16 v[32:33], v8 offset:28672
    v_mfma_f32_16x16x32_bf16 v[100:103], v[20:23], a[220:223], v[100:103]
    global_load_dwordx2 a[150:151], v219, s[80:81] offset:1536 sc1
    v_mfma_f32_16x16x32_bf16 v[96:99], v[20:23], a[216:219], v[96:99]
    ds_read_b64_tr_b16 v[34:35], v8 offset:30720
    v_mfma_f32_16x16x32_bf16 v[96:99], v[16:19], a[200:203], v[96:99]
    global_load_dwordx2 a[152:153], v219, s[82:83] offset:2048 sc1
    v_mfma_f32_16x16x32_bf16 v[92:95], v[16:19], a[196:199], v[92:95]
    ds_read_b64_tr_b16 v[36:37], v8 offset:32768
    v_mfma_f32_16x16x32_bf16 v[92:95], v[20:23], a[212:215], v[92:95]
    v_mfma_f32_16x16x32_bf16 v[88:91], v[20:23], a[208:211], v[88:91]
    ds_read_b64_tr_b16 v[38:39], v8 offset:34816
    v_mfma_f32_16x16x32_bf16 v[88:91], v[16:19], a[192:195], v[88:91]
    global_load_dwordx2 a[154:155], v219, s[82:83] offset:2560 sc1
    s_waitcnt lgkmcnt(4)
    v_mfma_f32_16x16x32_bf16 v[104:107], v[24:27], a[192:195], v[104:107]
    s_barrier
    ds_read_b64_tr_b16 v[16:17], v9 offset:20480
    v_mfma_f32_16x16x32_bf16 v[104:107], v[28:31], a[208:211], v[104:107]
    global_load_dwordx2 a[156:157], v219, s[82:83] offset:3072 sc1
    v_mfma_f32_16x16x32_bf16 v[108:111], v[28:31], a[212:215], v[108:111]
    ds_read_b64_tr_b16 v[18:19], v9 offset:22528
    v_mfma_f32_16x16x32_bf16 v[108:111], v[24:27], a[196:199], v[108:111]
    v_mfma_f32_16x16x32_bf16 v[112:115], v[24:27], a[200:203], v[112:115]
    ds_read_b64_tr_b16 v[20:21], v9 offset:24576
    v_mfma_f32_16x16x32_bf16 v[112:115], v[28:31], a[216:219], v[112:115]
    global_load_dwordx2 a[158:159], v219, s[82:83] offset:3584 sc1
    v_mfma_f32_16x16x32_bf16 v[116:119], v[28:31], a[220:223], v[116:119]
    ds_read_b64_tr_b16 v[22:23], v9 offset:26624
    s_add_u32 m0, s18, 90112
    v_mfma_f32_16x16x32_bf16 v[116:119], v[24:27], a[204:207], v[116:119]
    v_add_u32 v220, 128, v5
    s_waitcnt lgkmcnt(4)
    v_mfma_f32_16x16x32_bf16 v[132:135], v[32:35], a[204:207], v[132:135]
    ds_read_b64_tr_b16 v[24:25], v9 offset:28672
    v_mfma_f32_16x16x32_bf16 v[132:135], v[36:39], a[220:223], v[132:135]
    global_load_lds_dwordx4 v220, s[76:77]
    v_mfma_f32_16x16x32_bf16 v[128:131], v[36:39], a[216:219], v[128:131]
    ds_read_b64_tr_b16 v[26:27], v9 offset:30720
    s_add_u32 m0, s18, 94208
    v_mfma_f32_16x16x32_bf16 v[128:131], v[32:35], a[200:203], v[128:131]
    v_add_u32 v220, 663680, v5
    v_mfma_f32_16x16x32_bf16 v[124:127], v[32:35], a[196:199], v[124:127]
    ds_read_b64_tr_b16 v[28:29], v9 offset:32768
    v_mfma_f32_16x16x32_bf16 v[124:127], v[36:39], a[212:215], v[124:127]
    global_load_lds_dwordx4 v220, s[76:77]
    v_mfma_f32_16x16x32_bf16 v[120:123], v[36:39], a[208:211], v[120:123]
    ds_read_b64_tr_b16 v[30:31], v9 offset:34816
    s_add_u32 m0, s18, 98304
    v_mfma_f32_16x16x32_bf16 v[120:123], v[32:35], a[192:195], v[120:123]
    v_add_u32 v220, 147584, v5
    s_waitcnt lgkmcnt(4)
    v_mfma_f32_16x16x32_bf16 v[136:139], v[16:19], a[192:195], v[136:139]
    ds_read_b64_tr_b16 v[32:33], v6 offset:36864
    v_mfma_f32_16x16x32_bf16 v[136:139], v[20:23], a[208:211], v[136:139]
    global_load_lds_dwordx4 v220, s[76:77]
    v_mfma_f32_16x16x32_bf16 v[140:143], v[20:23], a[212:215], v[140:143]
    ds_read_b64_tr_b16 v[34:35], v6 offset:38912
    s_add_u32 m0, s18, 102400
    v_mfma_f32_16x16x32_bf16 v[140:143], v[16:19], a[196:199], v[140:143]
    v_add_u32 v220, 811136, v5
    v_mfma_f32_16x16x32_bf16 v[144:147], v[16:19], a[200:203], v[144:147]
    ds_read_b64_tr_b16 v[36:37], v6 offset:40960
    v_mfma_f32_16x16x32_bf16 v[144:147], v[20:23], a[216:219], v[144:147]
    v_mfma_f32_16x16x32_bf16 v[148:151], v[20:23], a[220:223], v[148:151]
    ds_read_b64_tr_b16 v[38:39], v6 offset:43008
    v_mfma_f32_16x16x32_bf16 v[148:151], v[16:19], a[204:207], v[148:151]
    global_load_lds_dwordx4 v220, s[76:77]
    s_waitcnt lgkmcnt(4)
    v_mfma_f32_16x16x32_bf16 v[164:167], v[24:27], a[204:207], v[164:167]
    ds_read_b64_tr_b16 v[16:17], v6 offset:45056
    s_add_u32 m0, s18, 106496
    v_mfma_f32_16x16x32_bf16 v[164:167], v[28:31], a[220:223], v[164:167]
    v_add_u32 v220, 294912, v5
    v_mfma_f32_16x16x32_bf16 v[160:163], v[28:31], a[216:219], v[160:163]
    ds_read_b64_tr_b16 v[18:19], v6 offset:47104
    v_mfma_f32_16x16x32_bf16 v[160:163], v[24:27], a[200:203], v[160:163]
    global_load_lds_dwordx4 v220, s[76:77]
    v_mfma_f32_16x16x32_bf16 v[156:159], v[24:27], a[196:199], v[156:159]
    ds_read_b64_tr_b16 v[20:21], v6 offset:49152
    s_add_u32 m0, s18, 110592
    v_mfma_f32_16x16x32_bf16 v[156:159], v[28:31], a[212:215], v[156:159]
    v_add_u32 v220, 958464, v5
    v_mfma_f32_16x16x32_bf16 v[152:155], v[28:31], a[208:211], v[152:155]
    ds_read_b64_tr_b16 v[22:23], v6 offset:51200
    v_mfma_f32_16x16x32_bf16 v[152:155], v[24:27], a[192:195], v[152:155]
    s_waitcnt lgkmcnt(4)
    v_mfma_f32_16x16x32_bf16 v[40:43], v[32:35], a[224:227], v[40:43]
    ds_read_b64_tr_b16 v[24:25], v6 offset:53248
    v_mfma_f32_16x16x32_bf16 v[40:43], v[36:39], a[240:243], v[40:43]
    global_load_lds_dwordx4 v220, s[76:77]
    v_mfma_f32_16x16x32_bf16 v[44:47], v[36:39], a[244:247], v[44:47]
    ds_read_b64_tr_b16 v[26:27], v6 offset:55296
    s_add_u32 m0, s18, 114688
    v_mfma_f32_16x16x32_bf16 v[44:47], v[32:35], a[228:231], v[44:47]
    v_add_u32 v220, 442368, v5
    v_mfma_f32_16x16x32_bf16 v[48:51], v[32:35], a[232:235], v[48:51]
    ds_read_b64_tr_b16 v[28:29], v6 offset:57344
    v_mfma_f32_16x16x32_bf16 v[48:51], v[36:39], a[248:251], v[48:51]
    global_load_lds_dwordx4 v220, s[76:77]
    v_mfma_f32_16x16x32_bf16 v[52:55], v[36:39], a[252:255], v[52:55]
    ds_read_b64_tr_b16 v[30:31], v6 offset:59392
    s_add_u32 m0, s18, 118784
    v_mfma_f32_16x16x32_bf16 v[52:55], v[32:35], a[236:239], v[52:55]
    v_add_u32 v220, 1105920, v5
    s_waitcnt lgkmcnt(4)
    v_mfma_f32_16x16x32_bf16 v[68:71], v[16:19], a[236:239], v[68:71]
    ds_read_b64_tr_b16 v[32:33], v6 offset:61440
    v_mfma_f32_16x16x32_bf16 v[68:71], v[20:23], a[252:255], v[68:71]
    v_mfma_f32_16x16x32_bf16 v[64:67], v[20:23], a[248:251], v[64:67]
    ds_read_b64_tr_b16 v[34:35], v6 offset:63488
    v_mfma_f32_16x16x32_bf16 v[64:67], v[16:19], a[232:235], v[64:67]
    global_load_lds_dwordx4 v220, s[76:77]
    v_mfma_f32_16x16x32_bf16 v[60:63], v[16:19], a[228:231], v[60:63]
    ds_read_b64_tr_b16 v[36:37], v11 offset:0
    s_add_u32 m0, s18, 122880
    v_mfma_f32_16x16x32_bf16 v[60:63], v[20:23], a[244:247], v[60:63]
    v_add_u32 v220, 295040, v5
    v_mfma_f32_16x16x32_bf16 v[56:59], v[20:23], a[240:243], v[56:59]
    ds_read_b64_tr_b16 v[38:39], v11 offset:2048
    v_mfma_f32_16x16x32_bf16 v[56:59], v[16:19], a[224:227], v[56:59]
    global_load_lds_dwordx4 v220, s[76:77]
    s_waitcnt lgkmcnt(4)
    v_mfma_f32_16x16x32_bf16 v[40:43], v[24:27], v[224:227], v[40:43]
    s_barrier
    ds_read_b64_tr_b16 v[16:17], v7 offset:36864
    v_mfma_f32_16x16x32_bf16 v[40:43], v[28:31], v[240:243], v[40:43]
    s_add_u32 m0, s18, 126976
    v_add_u32 v220, 958592, v5
    v_mfma_f32_16x16x32_bf16 v[44:47], v[28:31], v[244:247], v[44:47]
    ds_read_b64_tr_b16 v[18:19], v7 offset:38912
    v_mfma_f32_16x16x32_bf16 v[44:47], v[24:27], v[228:231], v[44:47]
    v_mfma_f32_16x16x32_bf16 v[48:51], v[24:27], v[232:235], v[48:51]
    ds_read_b64_tr_b16 v[20:21], v7 offset:40960
    v_mfma_f32_16x16x32_bf16 v[48:51], v[28:31], v[248:251], v[48:51]
    global_load_lds_dwordx4 v220, s[76:77]
    v_mfma_f32_16x16x32_bf16 v[52:55], v[28:31], v[252:255], v[52:55]
    ds_read_b64_tr_b16 v[22:23], v7 offset:43008
    s_add_u32 m0, s18, 0
    v_mfma_f32_16x16x32_bf16 v[52:55], v[24:27], v[236:239], v[52:55]
    v_add_u32 v220, 442496, v5
    s_waitcnt lgkmcnt(4)
    v_mfma_f32_16x16x32_bf16 v[68:71], v[32:35], v[236:239], v[68:71]
    ds_read_b64_tr_b16 v[24:25], v7 offset:45056
    v_mfma_f32_16x16x32_bf16 v[68:71], v[36:39], v[252:255], v[68:71]
    global_load_lds_dwordx4 v220, s[76:77]
    v_mfma_f32_16x16x32_bf16 v[64:67], v[36:39], v[248:251], v[64:67]
    ds_read_b64_tr_b16 v[26:27], v7 offset:47104
    s_add_u32 m0, s18, 4096
    v_mfma_f32_16x16x32_bf16 v[64:67], v[32:35], v[232:235], v[64:67]
    v_add_u32 v220, 1106048, v5
    v_mfma_f32_16x16x32_bf16 v[60:63], v[32:35], v[228:231], v[60:63]
    ds_read_b64_tr_b16 v[28:29], v7 offset:49152
    v_mfma_f32_16x16x32_bf16 v[60:63], v[36:39], v[244:247], v[60:63]
    v_mfma_f32_16x16x32_bf16 v[56:59], v[36:39], v[240:243], v[56:59]
    ds_read_b64_tr_b16 v[30:31], v7 offset:51200
    v_mfma_f32_16x16x32_bf16 v[56:59], v[32:35], v[224:227], v[56:59]
    global_load_lds_dwordx4 v220, s[76:77]
    s_waitcnt lgkmcnt(4)
    v_mfma_f32_16x16x32_bf16 v[72:75], v[16:19], a[224:227], v[72:75]
    ds_read_b64_tr_b16 v[32:33], v7 offset:53248
    s_add_u32 m0, s18, 8192
    v_mfma_f32_16x16x32_bf16 v[72:75], v[20:23], a[240:243], v[72:75]
    v_add_u32 v220, 36864, v5
    v_mfma_f32_16x16x32_bf16 v[76:79], v[20:23], a[244:247], v[76:79]
    ds_read_b64_tr_b16 v[34:35], v7 offset:55296
    v_mfma_f32_16x16x32_bf16 v[76:79], v[16:19], a[228:231], v[76:79]
    global_load_lds_dwordx4 v220, s[76:77]
    v_mfma_f32_16x16x32_bf16 v[80:83], v[16:19], a[232:235], v[80:83]
    ds_read_b64_tr_b16 v[36:37], v7 offset:57344
    s_add_u32 m0, s18, 12288
    v_mfma_f32_16x16x32_bf16 v[80:83], v[20:23], a[248:251], v[80:83]
    v_add_u32 v220, 700416, v5
    v_mfma_f32_16x16x32_bf16 v[84:87], v[20:23], a[252:255], v[84:87]
    ds_read_b64_tr_b16 v[38:39], v7 offset:59392
    v_mfma_f32_16x16x32_bf16 v[84:87], v[16:19], a[236:239], v[84:87]
    s_waitcnt lgkmcnt(4)
    v_mfma_f32_16x16x32_bf16 v[100:103], v[24:27], a[236:239], v[100:103]
    ds_read_b64_tr_b16 v[16:17], v7 offset:61440
    v_max_f32 v40, 0, v40
    v_mfma_f32_16x16x32_bf16 v[100:103], v[28:31], a[252:255], v[100:103]
    global_load_lds_dwordx4 v220, s[76:77]
    v_max_f32 v41, 0, v41
    v_mfma_f32_16x16x32_bf16 v[96:99], v[28:31], a[248:251], v[96:99]
    ds_read_b64_tr_b16 v[18:19], v7 offset:63488
    s_add_u32 m0, s18, 16384
    v_mfma_f32_16x16x32_bf16 v[96:99], v[24:27], a[232:235], v[96:99]
    v_add_u32 v220, 184320, v5
    v_max_f32 v42, 0, v42
    v_mfma_f32_16x16x32_bf16 v[92:95], v[24:27], a[228:231], v[92:95]
    ds_read_b64_tr_b16 v[20:21], v12 offset:0
    v_max_f32 v43, 0, v43
    v_mfma_f32_16x16x32_bf16 v[92:95], v[28:31], a[244:247], v[92:95]
    global_load_lds_dwordx4 v220, s[76:77]
    v_mul_f32 v40, v40, v56
    v_mfma_f32_16x16x32_bf16 v[88:91], v[28:31], a[240:243], v[88:91]
    ds_read_b64_tr_b16 v[22:23], v12 offset:2048
    s_add_u32 m0, s18, 20480
    v_mfma_f32_16x16x32_bf16 v[88:91], v[24:27], a[224:227], v[88:91]
    v_add_u32 v220, 847872, v5
    s_waitcnt lgkmcnt(4)
    v_mfma_f32_16x16x32_bf16 v[72:75], v[32:35], v[224:227], v[72:75]
    ds_read_b64_tr_b16 v[24:25], v8 offset:36864
    v_mul_f32 v41, v41, v57
    v_mfma_f32_16x16x32_bf16 v[72:75], v[36:39], v[240:243], v[72:75]
    v_mul_f32 v42, v42, v58
    v_mul_f32 v43, v43, v59
    v_mfma_f32_16x16x32_bf16 v[76:79], v[36:39], v[244:247], v[76:79]
    ds_read_b64_tr_b16 v[26:27], v8 offset:38912
    v_cvt_pk_bf16_f32 v56, v40, v41
    v_mfma_f32_16x16x32_bf16 v[76:79], v[32:35], v[228:231], v[76:79]
    global_load_lds_dwordx4 v220, s[76:77]
    v_cvt_pk_bf16_f32 v57, v42, v43
    v_mfma_f32_16x16x32_bf16 v[80:83], v[32:35], v[232:235], v[80:83]
    ds_read_b64_tr_b16 v[28:29], v8 offset:40960
    s_add_u32 m0, s18, 24576
    v_mfma_f32_16x16x32_bf16 v[80:83], v[36:39], v[248:251], v[80:83]
    v_add_u32 v220, 36992, v5
    v_max_f32 v44, 0, v44
    v_mfma_f32_16x16x32_bf16 v[84:87], v[36:39], v[252:255], v[84:87]
    ds_read_b64_tr_b16 v[30:31], v8 offset:43008
    v_max_f32 v45, 0, v45
    v_mfma_f32_16x16x32_bf16 v[84:87], v[32:35], v[236:239], v[84:87]
    global_load_lds_dwordx4 v220, s[76:77]
    s_waitcnt lgkmcnt(4)
    v_mfma_f32_16x16x32_bf16 v[100:103], v[16:19], v[236:239], v[100:103]
    ds_read_b64_tr_b16 v[32:33], v8 offset:45056
    s_add_u32 m0, s18, 28672
    v_mfma_f32_16x16x32_bf16 v[100:103], v[20:23], v[252:255], v[100:103]
    v_add_u32 v220, 700544, v5
    v_max_f32 v46, 0, v46
    v_mfma_f32_16x16x32_bf16 v[96:99], v[20:23], v[248:251], v[96:99]
    ds_read_b64_tr_b16 v[34:35], v8 offset:47104
    v_max_f32 v47, 0, v47
    v_mfma_f32_16x16x32_bf16 v[96:99], v[16:19], v[232:235], v[96:99]
    v_mul_f32 v44, v44, v60
    v_mul_f32 v45, v45, v61
    v_mfma_f32_16x16x32_bf16 v[92:95], v[16:19], v[228:231], v[92:95]
    ds_read_b64_tr_b16 v[36:37], v8 offset:49152
    v_mul_f32 v46, v46, v62
    v_mfma_f32_16x16x32_bf16 v[92:95], v[20:23], v[244:247], v[92:95]
    global_load_lds_dwordx4 v220, s[76:77]
    v_mul_f32 v47, v47, v63
    v_mfma_f32_16x16x32_bf16 v[88:91], v[20:23], v[240:243], v[88:91]
    ds_read_b64_tr_b16 v[38:39], v8 offset:51200
    v_cvt_pk_bf16_f32 v60, v44, v45
    v_mfma_f32_16x16x32_bf16 v[88:91], v[16:19], v[224:227], v[88:91]
    v_cvt_pk_bf16_f32 v61, v46, v47
    s_waitcnt lgkmcnt(4)
    v_mfma_f32_16x16x32_bf16 v[104:107], v[24:27], a[224:227], v[104:107]
    ds_read_b64_tr_b16 v[16:17], v8 offset:53248
    v_max_f32 v48, 0, v48
    v_mfma_f32_16x16x32_bf16 v[104:107], v[28:31], a[240:243], v[104:107]
    v_max_f32 v49, 0, v49
    v_max_f32 v50, 0, v50
    v_mfma_f32_16x16x32_bf16 v[108:111], v[28:31], a[244:247], v[108:111]
    ds_read_b64_tr_b16 v[18:19], v8 offset:55296
    v_max_f32 v51, 0, v51
    v_mfma_f32_16x16x32_bf16 v[108:111], v[24:27], a[228:231], v[108:111]
    v_mul_f32 v48, v48, v64
    v_mul_f32 v49, v49, v65
    v_mfma_f32_16x16x32_bf16 v[112:115], v[24:27], a[232:235], v[112:115]
    ds_read_b64_tr_b16 v[20:21], v8 offset:57344
    v_mul_f32 v50, v50, v66
    v_mfma_f32_16x16x32_bf16 v[112:115], v[28:31], a[248:251], v[112:115]
    v_mul_f32 v51, v51, v67
    v_cvt_pk_bf16_f32 v64, v48, v49
    v_mfma_f32_16x16x32_bf16 v[116:119], v[28:31], a[252:255], v[116:119]
    ds_read_b64_tr_b16 v[22:23], v8 offset:59392
    v_cvt_pk_bf16_f32 v65, v50, v51
    v_mfma_f32_16x16x32_bf16 v[116:119], v[24:27], a[236:239], v[116:119]
    v_max_f32 v52, 0, v52
    s_waitcnt lgkmcnt(4)
    v_mfma_f32_16x16x32_bf16 v[132:135], v[32:35], a[236:239], v[132:135]
    ds_read_b64_tr_b16 v[24:25], v8 offset:61440
    v_max_f32 v53, 0, v53
    v_mfma_f32_16x16x32_bf16 v[132:135], v[36:39], a[252:255], v[132:135]
    v_max_f32 v54, 0, v54
    v_max_f32 v55, 0, v55
    v_mfma_f32_16x16x32_bf16 v[128:131], v[36:39], a[248:251], v[128:131]
    ds_read_b64_tr_b16 v[26:27], v8 offset:63488
    v_mul_f32 v52, v52, v68
    v_mfma_f32_16x16x32_bf16 v[128:131], v[32:35], a[232:235], v[128:131]
    v_mul_f32 v53, v53, v69
    v_mul_f32 v54, v54, v70
    v_mfma_f32_16x16x32_bf16 v[124:127], v[32:35], a[228:231], v[124:127]
    ds_read_b64_tr_b16 v[28:29], v13 offset:0
    v_mul_f32 v55, v55, v71
    v_mfma_f32_16x16x32_bf16 v[124:127], v[36:39], a[244:247], v[124:127]
    v_cvt_pk_bf16_f32 v68, v52, v53
    v_cvt_pk_bf16_f32 v69, v54, v55
    v_mfma_f32_16x16x32_bf16 v[120:123], v[36:39], a[240:243], v[120:123]
    ds_read_b64_tr_b16 v[30:31], v13 offset:2048
    v_max_f32 v72, 0, v72
    v_mfma_f32_16x16x32_bf16 v[120:123], v[32:35], a[224:227], v[120:123]
    v_max_f32 v73, 0, v73
    s_waitcnt lgkmcnt(4)
    v_mfma_f32_16x16x32_bf16 v[104:107], v[16:19], v[224:227], v[104:107]
    ds_read_b64_tr_b16 v[32:33], v9 offset:36864
    v_max_f32 v74, 0, v74
    v_mfma_f32_16x16x32_bf16 v[104:107], v[20:23], v[240:243], v[104:107]
    v_max_f32 v75, 0, v75
    v_mul_f32 v72, v72, v88
    v_mfma_f32_16x16x32_bf16 v[108:111], v[20:23], v[244:247], v[108:111]
    ds_read_b64_tr_b16 v[34:35], v9 offset:38912
    v_mul_f32 v73, v73, v89
    v_mfma_f32_16x16x32_bf16 v[108:111], v[16:19], v[228:231], v[108:111]
    v_mul_f32 v74, v74, v90
    v_mul_f32 v75, v75, v91
    v_mfma_f32_16x16x32_bf16 v[112:115], v[16:19], v[232:235], v[112:115]
    ds_read_b64_tr_b16 v[36:37], v9 offset:40960
    v_cvt_pk_bf16_f32 v58, v72, v73
    v_mfma_f32_16x16x32_bf16 v[112:115], v[20:23], v[248:251], v[112:115]
    v_cvt_pk_bf16_f32 v59, v74, v75
    v_max_f32 v76, 0, v76
    v_mfma_f32_16x16x32_bf16 v[116:119], v[20:23], v[252:255], v[116:119]
    ds_read_b64_tr_b16 v[38:39], v9 offset:43008
    s_add_u32 s21, s25, 32768
    v_mfma_f32_16x16x32_bf16 v[116:119], v[16:19], v[236:239], v[116:119]
    buffer_store_dwordx4 v[56:59], v1, s[8:11], s21 offen offset:0 sc1
    s_waitcnt lgkmcnt(4)
    v_mfma_f32_16x16x32_bf16 v[132:135], v[24:27], v[236:239], v[132:135]
    ds_read_b64_tr_b16 v[16:17], v9 offset:45056
    v_max_f32 v77, 0, v77
    v_mfma_f32_16x16x32_bf16 v[132:135], v[28:31], v[252:255], v[132:135]
    v_max_f32 v78, 0, v78
    v_max_f32 v79, 0, v79
    v_mfma_f32_16x16x32_bf16 v[128:131], v[28:31], v[248:251], v[128:131]
    ds_read_b64_tr_b16 v[18:19], v9 offset:47104
    v_mul_f32 v76, v76, v92
    v_mfma_f32_16x16x32_bf16 v[128:131], v[24:27], v[232:235], v[128:131]
    v_mul_f32 v77, v77, v93
    v_mul_f32 v78, v78, v94
    v_mfma_f32_16x16x32_bf16 v[124:127], v[24:27], v[228:231], v[124:127]
    ds_read_b64_tr_b16 v[20:21], v9 offset:49152
    v_mul_f32 v79, v79, v95
    v_mfma_f32_16x16x32_bf16 v[124:127], v[28:31], v[244:247], v[124:127]
    v_cvt_pk_bf16_f32 v62, v76, v77
    v_cvt_pk_bf16_f32 v63, v78, v79
    v_mfma_f32_16x16x32_bf16 v[120:123], v[28:31], v[240:243], v[120:123]
    ds_read_b64_tr_b16 v[22:23], v9 offset:51200
    v_max_f32 v80, 0, v80
    v_mfma_f32_16x16x32_bf16 v[120:123], v[24:27], v[224:227], v[120:123]
    v_max_f32 v81, 0, v81
    s_waitcnt lgkmcnt(4)
    v_mfma_f32_16x16x32_bf16 v[136:139], v[32:35], a[224:227], v[136:139]
    ds_read_b64_tr_b16 v[24:25], v9 offset:53248
    v_max_f32 v82, 0, v82
    v_mfma_f32_16x16x32_bf16 v[136:139], v[36:39], a[240:243], v[136:139]
    buffer_store_dwordx4 v[60:63], v1, s[8:11], s21 offen offset:1024 sc1
    v_max_f32 v83, 0, v83
    v_mfma_f32_16x16x32_bf16 v[140:143], v[36:39], a[244:247], v[140:143]
    ds_read_b64_tr_b16 v[26:27], v9 offset:55296
    v_mul_f32 v80, v80, v96
    v_mfma_f32_16x16x32_bf16 v[140:143], v[32:35], a[228:231], v[140:143]
    v_mul_f32 v81, v81, v97
    v_mul_f32 v82, v82, v98
    v_mfma_f32_16x16x32_bf16 v[144:147], v[32:35], a[232:235], v[144:147]
    ds_read_b64_tr_b16 v[28:29], v9 offset:57344
    v_mul_f32 v83, v83, v99
    v_mfma_f32_16x16x32_bf16 v[144:147], v[36:39], a[248:251], v[144:147]
    v_cvt_pk_bf16_f32 v66, v80, v81
    v_cvt_pk_bf16_f32 v67, v82, v83
    v_mfma_f32_16x16x32_bf16 v[148:151], v[36:39], a[252:255], v[148:151]
    ds_read_b64_tr_b16 v[30:31], v9 offset:59392
    v_max_f32 v84, 0, v84
    v_mfma_f32_16x16x32_bf16 v[148:151], v[32:35], a[236:239], v[148:151]
    v_max_f32 v85, 0, v85
    s_waitcnt lgkmcnt(4)
    v_mfma_f32_16x16x32_bf16 v[164:167], v[16:19], a[236:239], v[164:167]
    ds_read_b64_tr_b16 v[32:33], v9 offset:61440
    v_max_f32 v86, 0, v86
    v_mfma_f32_16x16x32_bf16 v[164:167], v[20:23], a[252:255], v[164:167]
    v_max_f32 v87, 0, v87
    v_mul_f32 v84, v84, v100
    v_mfma_f32_16x16x32_bf16 v[160:163], v[20:23], a[248:251], v[160:163]
    ds_read_b64_tr_b16 v[34:35], v9 offset:63488
    v_mul_f32 v85, v85, v101
    v_mfma_f32_16x16x32_bf16 v[160:163], v[16:19], a[232:235], v[160:163]
    v_mul_f32 v86, v86, v102
    v_mul_f32 v87, v87, v103
    v_mfma_f32_16x16x32_bf16 v[156:159], v[16:19], a[228:231], v[156:159]
    ds_read_b64_tr_b16 v[36:37], v14 offset:0
    v_cvt_pk_bf16_f32 v70, v84, v85
    v_mfma_f32_16x16x32_bf16 v[156:159], v[20:23], a[244:247], v[156:159]
    buffer_store_dwordx4 v[64:67], v1, s[8:11], s21 offen offset:2048 sc1
    v_cvt_pk_bf16_f32 v71, v86, v87
    v_mfma_f32_16x16x32_bf16 v[152:155], v[20:23], a[240:243], v[152:155]
    ds_read_b64_tr_b16 v[38:39], v14 offset:2048
    v_max_f32 v104, 0, v104
    v_mfma_f32_16x16x32_bf16 v[152:155], v[16:19], a[224:227], v[152:155]
    v_max_f32 v105, 0, v105
    s_waitcnt lgkmcnt(4)
    v_mfma_f32_16x16x32_bf16 v[136:139], v[24:27], v[224:227], v[136:139]
    s_waitcnt vmcnt(17)
    s_barrier
    v_add_u32 v6, s93, v6
    v_add_u32 v7, s93, v7
    v_add_u32 v8, s93, v8
    v_add_u32 v9, s93, v9
    v_add_u32 v10, s93, v10
    v_add_u32 v11, s93, v11
    v_add_u32 v12, s93, v12
    v_add_u32 v13, s93, v13
    v_add_u32 v14, s93, v14
    v_add_u32 v15, s93, v15
    v_add_u32 v218, 0x10000, v15
    ds_read_b64_tr_b16 v[16:17], v11 offset:8192
    v_mfma_f32_16x16x32_bf16 v[136:139], v[28:31], v[240:243], v[136:139]
    v_max_f32 v106, 0, v106
    v_max_f32 v107, 0, v107
    v_mfma_f32_16x16x32_bf16 v[140:143], v[28:31], v[244:247], v[140:143]
    ds_read_b64_tr_b16 v[18:19], v11 offset:10240
    s_add_u32 m0, s18, 32768
    v_mfma_f32_16x16x32_bf16 v[140:143], v[24:27], v[228:231], v[140:143]
    v_add_u32 v220, 184448, v5
    v_mul_f32 v104, v104, v120
    v_mfma_f32_16x16x32_bf16 v[144:147], v[24:27], v[232:235], v[144:147]
    ds_read_b64_tr_b16 v[20:21], v11 offset:16384
    v_mul_f32 v105, v105, v121
    v_mfma_f32_16x16x32_bf16 v[144:147], v[28:31], v[248:251], v[144:147]
    global_load_lds_dwordx4 v220, s[76:77]
    v_mul_f32 v106, v106, v122
    v_mfma_f32_16x16x32_bf16 v[148:151], v[28:31], v[252:255], v[148:151]
    ds_read_b64_tr_b16 v[22:23], v11 offset:18432
    s_add_u32 m0, s18, 36864
    v_mfma_f32_16x16x32_bf16 v[148:151], v[24:27], v[236:239], v[148:151]
    v_add_u32 v220, 848000, v5
    s_waitcnt lgkmcnt(4)
    v_mfma_f32_16x16x32_bf16 v[164:167], v[32:35], v[236:239], v[164:167]
    ds_read_b64_tr_b16 v[24:25], v12 offset:8192
    v_mul_f32 v107, v107, v123
    v_mfma_f32_16x16x32_bf16 v[164:167], v[36:39], v[252:255], v[164:167]
    global_load_lds_dwordx4 v220, s[76:77]
    v_cvt_pk_bf16_f32 v120, v104, v105
    v_mfma_f32_16x16x32_bf16 v[160:163], v[36:39], v[248:251], v[160:163]
    ds_read_b64_tr_b16 v[26:27], v12 offset:10240
    v_cvt_pk_bf16_f32 v121, v106, v107
    v_mfma_f32_16x16x32_bf16 v[160:163], v[32:35], v[232:235], v[160:163]
    v_max_f32 v108, 0, v108
    v_max_f32 v109, 0, v109
    v_mfma_f32_16x16x32_bf16 v[156:159], v[32:35], v[228:231], v[156:159]
    ds_read_b64_tr_b16 v[28:29], v12 offset:16384
    v_max_f32 v110, 0, v110
    v_mfma_f32_16x16x32_bf16 v[156:159], v[36:39], v[244:247], v[156:159]
    buffer_store_dwordx4 v[68:71], v1, s[8:11], s21 offen offset:3072 sc1
    v_max_f32 v111, 0, v111
    v_mfma_f32_16x16x32_bf16 v[152:155], v[36:39], v[240:243], v[152:155]
    ds_read_b64_tr_b16 v[30:31], v12 offset:18432
    s_add_u32 m0, s18, 40960
    v_mfma_f32_16x16x32_bf16 v[152:155], v[32:35], v[224:227], v[152:155]
    v_add_u32 v220, 331776, v5
    s_waitcnt lgkmcnt(4)
    v_mfma_f32_16x16x32_bf16 v[184:187], v[16:19], a[0:3], 0
    ds_read_b64_tr_b16 v[32:33], v13 offset:8192
    v_mul_f32 v108, v108, v124
    v_mfma_f32_16x16x32_bf16 v[184:187], v[20:23], a[16:19], v[184:187]
    v_mul_f32 v109, v109, v125
    v_mul_f32 v110, v110, v126
    v_mfma_f32_16x16x32_bf16 v[188:191], v[20:23], a[20:23], 0
    ds_read_b64_tr_b16 v[34:35], v13 offset:10240
    v_mul_f32 v111, v111, v127
    v_mfma_f32_16x16x32_bf16 v[188:191], v[16:19], a[4:7], v[188:191]
    global_load_lds_dwordx4 v220, s[76:77]
    v_cvt_pk_bf16_f32 v124, v108, v109
    v_mfma_f32_16x16x32_bf16 v[192:195], v[16:19], a[8:11], 0
    ds_read_b64_tr_b16 v[36:37], v13 offset:16384
    s_add_u32 m0, s18, 45056
    v_mfma_f32_16x16x32_bf16 v[192:195], v[20:23], a[24:27], v[192:195]
    v_add_u32 v220, 995328, v5
    v_cvt_pk_bf16_f32 v125, v110, v111
    v_mfma_f32_16x16x32_bf16 v[196:199], v[20:23], a[28:31], 0
    ds_read_b64_tr_b16 v[38:39], v13 offset:18432
    v_max_f32 v112, 0, v112
    v_mfma_f32_16x16x32_bf16 v[196:199], v[16:19], a[12:15], v[196:199]
    global_load_lds_dwordx4 v220, s[76:77]
    s_waitcnt lgkmcnt(4)
    v_mfma_f32_16x16x32_bf16 v[212:215], v[24:27], a[12:15], 0
    ds_read_b64_tr_b16 v[16:17], v14 offset:8192
    s_add_u32 m0, s18, 49152
    v_mfma_f32_16x16x32_bf16 v[212:215], v[28:31], a[28:31], v[212:215]
    v_add_u32 v220, 479232, v5
    v_max_f32 v113, 0, v113
    v_mfma_f32_16x16x32_bf16 v[208:211], v[28:31], a[24:27], 0
    ds_read_b64_tr_b16 v[18:19], v14 offset:10240
    v_max_f32 v114, 0, v114
    v_mfma_f32_16x16x32_bf16 v[208:211], v[24:27], a[8:11], v[208:211]
    v_max_f32 v115, 0, v115
    v_mul_f32 v112, v112, v128
    v_mfma_f32_16x16x32_bf16 v[204:207], v[24:27], a[4:7], 0
    ds_read_b64_tr_b16 v[20:21], v14 offset:16384
    v_mul_f32 v113, v113, v129
    v_mfma_f32_16x16x32_bf16 v[204:207], v[28:31], a[20:23], v[204:207]
    global_load_lds_dwordx4 v220, s[76:77]
    v_mul_f32 v114, v114, v130
    v_mfma_f32_16x16x32_bf16 v[200:203], v[28:31], a[16:19], 0
    ds_read_b64_tr_b16 v[22:23], v14 offset:18432
    s_add_u32 m0, s18, 53248
    v_mfma_f32_16x16x32_bf16 v[200:203], v[24:27], a[0:3], v[200:203]
    v_add_u32 v220, 1142784, v5
    s_waitcnt lgkmcnt(4)
    v_mfma_f32_16x16x32_bf16 v[168:171], v[32:35], a[0:3], 0
    ds_read_b64_tr_b16 v[24:25], v11 offset:24576
    v_mul_f32 v115, v115, v131
    v_mfma_f32_16x16x32_bf16 v[168:171], v[36:39], a[16:19], v[168:171]
    global_load_lds_dwordx4 v220, s[76:77]
    v_cvt_pk_bf16_f32 v128, v112, v113
    v_mfma_f32_16x16x32_bf16 v[172:175], v[36:39], a[20:23], 0
    ds_read_b64_tr_b16 v[26:27], v11 offset:26624
    v_cvt_pk_bf16_f32 v129, v114, v115
    v_mfma_f32_16x16x32_bf16 v[172:175], v[32:35], a[4:7], v[172:175]
    v_max_f32 v116, 0, v116
    v_max_f32 v117, 0, v117
    v_mfma_f32_16x16x32_bf16 v[176:179], v[32:35], a[8:11], 0
    ds_read_b64_tr_b16 v[28:29], v11 offset:32768
    v_max_f32 v118, 0, v118
    v_mfma_f32_16x16x32_bf16 v[176:179], v[36:39], a[24:27], v[176:179]
    v_max_f32 v119, 0, v119
    v_mul_f32 v116, v116, v132
    v_mfma_f32_16x16x32_bf16 v[180:183], v[36:39], a[28:31], 0
    ds_read_b64_tr_b16 v[30:31], v11 offset:34816
    v_mul_f32 v117, v117, v133
    v_mfma_f32_16x16x32_bf16 v[180:183], v[32:35], a[12:15], v[180:183]
    v_mul_f32 v118, v118, v134
    s_waitcnt lgkmcnt(4)
    v_mfma_f32_16x16x32_bf16 v[84:87], v[16:19], a[12:15], 0
    ds_read_b64_tr_b16 v[32:33], v12 offset:24576
    v_mul_f32 v119, v119, v135
    v_mfma_f32_16x16x32_bf16 v[84:87], v[20:23], a[28:31], v[84:87]
    v_cvt_pk_bf16_f32 v132, v116, v117
    v_cvt_pk_bf16_f32 v133, v118, v119
    v_mfma_f32_16x16x32_bf16 v[80:83], v[20:23], a[24:27], 0
    ds_read_b64_tr_b16 v[34:35], v12 offset:26624
    v_max_f32 v136, 0, v136
    v_mfma_f32_16x16x32_bf16 v[80:83], v[16:19], a[8:11], v[80:83]
    v_max_f32 v137, 0, v137
    v_max_f32 v138, 0, v138
    v_mfma_f32_16x16x32_bf16 v[76:79], v[16:19], a[4:7], 0
    ds_read_b64_tr_b16 v[36:37], v12 offset:32768
    v_max_f32 v139, 0, v139
    v_mfma_f32_16x16x32_bf16 v[76:79], v[20:23], a[20:23], v[76:79]
    v_mul_f32 v136, v136, v152
    v_mul_f32 v137, v137, v153
    v_mfma_f32_16x16x32_bf16 v[72:75], v[20:23], a[16:19], 0
    ds_read_b64_tr_b16 v[38:39], v12 offset:34816
    v_mul_f32 v138, v138, v154
    v_mfma_f32_16x16x32_bf16 v[72:75], v[16:19], a[0:3], v[72:75]
    v_mul_f32 v139, v139, v155
    s_waitcnt lgkmcnt(4)
    v_mfma_f32_16x16x32_bf16 v[88:91], v[24:27], a[0:3], 0
    s_waitcnt vmcnt(20)
    s_barrier
    ds_read_b64_tr_b16 v[16:17], v13 offset:24576
    v_mfma_f32_16x16x32_bf16 v[88:91], v[28:31], a[16:19], v[88:91]
PAD_8:
    s_cbranch_execz PAD_11
    v_cvt_pk_bf16_f32 v122, v136, v137
    v_cvt_pk_bf16_f32 v123, v138, v139
    v_mfma_f32_16x16x32_bf16 v[92:95], v[28:31], a[20:23], 0
    ds_read_b64_tr_b16 v[18:19], v13 offset:26624
    s_add_u32 m0, s18, 57344
    v_mfma_f32_16x16x32_bf16 v[92:95], v[24:27], a[4:7], v[92:95]
    v_add_u32 v220, 331904, v5
    v_max_f32 v140, 0, v140
    v_mfma_f32_16x16x32_bf16 v[96:99], v[24:27], a[8:11], 0
    ds_read_b64_tr_b16 v[20:21], v13 offset:32768
    v_max_f32 v141, 0, v141
    v_mfma_f32_16x16x32_bf16 v[96:99], v[28:31], a[24:27], v[96:99]
    global_load_lds_dwordx4 v220, s[76:77]
    v_max_f32 v142, 0, v142
    v_mfma_f32_16x16x32_bf16 v[100:103], v[28:31], a[28:31], 0
    ds_read_b64_tr_b16 v[22:23], v13 offset:34816
    s_add_u32 s21, s25, 49152
    v_mfma_f32_16x16x32_bf16 v[100:103], v[24:27], a[12:15], v[100:103]
    v_max_f32 v143, 0, v143
    s_waitcnt lgkmcnt(4)
    v_mfma_f32_16x16x32_bf16 v[52:55], v[32:35], a[12:15], 0
    ds_read_b64_tr_b16 v[24:25], v14 offset:24576
    v_mul_f32 v140, v140, v156
    v_mfma_f32_16x16x32_bf16 v[52:55], v[36:39], a[28:31], v[52:55]
    buffer_store_dwordx4 v[120:123], v1, s[8:11], s21 offen offset:0 sc1
    v_mul_f32 v141, v141, v157
    v_mfma_f32_16x16x32_bf16 v[48:51], v[36:39], a[24:27], 0
    ds_read_b64_tr_b16 v[26:27], v14 offset:26624
    s_add_u32 m0, s18, 61440
    v_mfma_f32_16x16x32_bf16 v[48:51], v[32:35], a[8:11], v[48:51]
    v_add_u32 v220, 995456, v5
    v_mul_f32 v142, v142, v158
    v_mfma_f32_16x16x32_bf16 v[44:47], v[32:35], a[4:7], 0
    ds_read_b64_tr_b16 v[28:29], v14 offset:32768
    v_mul_f32 v143, v143, v159
    v_mfma_f32_16x16x32_bf16 v[44:47], v[36:39], a[20:23], v[44:47]
    global_load_lds_dwordx4 v220, s[76:77]
    v_cvt_pk_bf16_f32 v126, v140, v141
    v_mfma_f32_16x16x32_bf16 v[40:43], v[36:39], a[16:19], 0
    ds_read_b64_tr_b16 v[30:31], v14 offset:34816
    s_add_u32 m0, s18, 65536
    v_mfma_f32_16x16x32_bf16 v[40:43], v[32:35], a[0:3], v[40:43]
    v_add_u32 v220, 479360, v5
    s_waitcnt lgkmcnt(4)
    v_mfma_f32_16x16x32_bf16 v[56:59], v[16:19], a[0:3], 0
    ds_read_b64_tr_b16 v[32:33], v11 offset:40960
    v_cvt_pk_bf16_f32 v127, v142, v143
    v_mfma_f32_16x16x32_bf16 v[56:59], v[20:23], a[16:19], v[56:59]
    v_max_f32 v144, 0, v144
    v_max_f32 v145, 0, v145
    v_mfma_f32_16x16x32_bf16 v[60:63], v[20:23], a[20:23], 0
    ds_read_b64_tr_b16 v[34:35], v11 offset:43008
    v_max_f32 v146, 0, v146
    v_mfma_f32_16x16x32_bf16 v[60:63], v[16:19], a[4:7], v[60:63]
    global_load_lds_dwordx4 v220, s[76:77]
    v_max_f32 v147, 0, v147
    v_mfma_f32_16x16x32_bf16 v[64:67], v[16:19], a[8:11], 0
    ds_read_b64_tr_b16 v[36:37], v11 offset:49152
    v_mul_f32 v144, v144, v160
    v_mfma_f32_16x16x32_bf16 v[64:67], v[20:23], a[24:27], v[64:67]
    v_mul_f32 v145, v145, v161
    v_mul_f32 v146, v146, v162
    v_mfma_f32_16x16x32_bf16 v[68:71], v[20:23], a[28:31], 0
    ds_read_b64_tr_b16 v[38:39], v11 offset:51200
    v_mul_f32 v147, v147, v163
    v_mfma_f32_16x16x32_bf16 v[68:71], v[16:19], a[12:15], v[68:71]
    buffer_store_dwordx4 v[124:127], v1, s[8:11], s21 offen offset:1024 sc1
    s_waitcnt lgkmcnt(4)
    v_mfma_f32_16x16x32_bf16 v[116:119], v[24:27], a[12:15], 0
    s_waitcnt vmcnt(9)
    s_barrier
    buffer_store_dword v221, v4, s[8:11], s29 offen sc1
    s_add_u32 s29, s29, 0x10000
    ds_read_b64_tr_b16 v[16:17], v12 offset:40960
    v_mfma_f32_16x16x32_bf16 v[116:119], v[28:31], a[28:31], v[116:119]
    s_add_u32 m0, s18, 69632
    v_add_u32 v220, 1142912, v5
    v_mfma_f32_16x16x32_bf16 v[112:115], v[28:31], a[24:27], 0
    ds_read_b64_tr_b16 v[18:19], v12 offset:43008
    v_cvt_pk_bf16_f32 v130, v144, v145
    v_mfma_f32_16x16x32_bf16 v[112:115], v[24:27], a[8:11], v[112:115]
    v_cvt_pk_bf16_f32 v131, v146, v147
    v_max_f32 v148, 0, v148
    v_mfma_f32_16x16x32_bf16 v[108:111], v[24:27], a[4:7], 0
    ds_read_b64_tr_b16 v[20:21], v12 offset:49152
    v_max_f32 v149, 0, v149
    v_mfma_f32_16x16x32_bf16 v[108:111], v[28:31], a[20:23], v[108:111]
    global_load_lds_dwordx4 v220, s[76:77]
    v_max_f32 v150, 0, v150
    v_mfma_f32_16x16x32_bf16 v[104:107], v[28:31], a[16:19], 0
    ds_read_b64_tr_b16 v[22:23], v12 offset:51200
    v_max_f32 v151, 0, v151
    v_mfma_f32_16x16x32_bf16 v[104:107], v[24:27], a[0:3], v[104:107]
    v_mul_f32 v148, v148, v164
    s_waitcnt lgkmcnt(4)
    v_mfma_f32_16x16x32_bf16 v[184:187], v[32:35], a[32:35], v[184:187]
    ds_read_b64_tr_b16 v[24:25], v13 offset:40960
    v_mul_f32 v149, v149, v165
    v_mfma_f32_16x16x32_bf16 v[184:187], v[36:39], a[48:51], v[184:187]
    buffer_store_dwordx4 v[128:131], v1, s[8:11], s21 offen offset:2048 sc1
    v_mul_f32 v150, v150, v166
    v_mfma_f32_16x16x32_bf16 v[188:191], v[36:39], a[52:55], v[188:191]
    ds_read_b64_tr_b16 v[26:27], v13 offset:43008
    s_add_u32 m0, s18, 73728
    v_mfma_f32_16x16x32_bf16 v[188:191], v[32:35], a[36:39], v[188:191]
    v_add_u32 v220, 589824, v5
    v_mul_f32 v151, v151, v167
    v_mfma_f32_16x16x32_bf16 v[192:195], v[32:35], a[40:43], v[192:195]
    ds_read_b64_tr_b16 v[28:29], v13 offset:49152
    v_cvt_pk_bf16_f32 v134, v148, v149
    v_mfma_f32_16x16x32_bf16 v[192:195], v[36:39], a[56:59], v[192:195]
    v_cvt_pk_bf16_f32 v135, v150, v151
    v_mfma_f32_16x16x32_bf16 v[196:199], v[36:39], a[60:63], v[196:199]
    ds_read_b64_tr_b16 v[30:31], v13 offset:51200
    v_mfma_f32_16x16x32_bf16 v[196:199], v[32:35], a[44:47], v[196:199]
    global_load_lds_dwordx4 v220, s[76:77]
    s_waitcnt lgkmcnt(4)
    v_mfma_f32_16x16x32_bf16 v[212:215], v[16:19], a[44:47], v[212:215]
    ds_read_b64_tr_b16 v[32:33], v14 offset:40960
    v_mfma_f32_16x16x32_bf16 v[212:215], v[20:23], a[60:63], v[212:215]
    v_mfma_f32_16x16x32_bf16 v[208:211], v[20:23], a[56:59], v[208:211]
    ds_read_b64_tr_b16 v[34:35], v14 offset:43008
    v_mfma_f32_16x16x32_bf16 v[208:211], v[16:19], a[40:43], v[208:211]
    buffer_store_dwordx4 v[132:135], v1, s[8:11], s21 offen offset:3072 sc1
    v_mfma_f32_16x16x32_bf16 v[204:207], v[16:19], a[36:39], v[204:207]
    ds_read_b64_tr_b16 v[36:37], v14 offset:49152
    s_add_u32 m0, s18, 77824
    v_mfma_f32_16x16x32_bf16 v[204:207], v[20:23], a[52:55], v[204:207]
    v_add_u32 v220, 1253376, v5
    v_mfma_f32_16x16x32_bf16 v[200:203], v[20:23], a[48:51], v[200:203]
    ds_read_b64_tr_b16 v[38:39], v14 offset:51200
    v_mfma_f32_16x16x32_bf16 v[200:203], v[16:19], a[32:35], v[200:203]
    s_waitcnt lgkmcnt(4)
    v_mfma_f32_16x16x32_bf16 v[168:171], v[24:27], a[32:35], v[168:171]
    s_barrier
    ds_read_b64_tr_b16 v[16:17], v11 offset:57344
    v_mfma_f32_16x16x32_bf16 v[168:171], v[28:31], a[48:51], v[168:171]
    global_load_lds_dwordx4 v220, s[76:77]
    v_mfma_f32_16x16x32_bf16 v[172:175], v[28:31], a[52:55], v[172:175]
    ds_read_b64_tr_b16 v[18:19], v11 offset:59392
    s_add_u32 m0, s18, 81920
    v_mfma_f32_16x16x32_bf16 v[172:175], v[24:27], a[36:39], v[172:175]
    v_add_u32 v220, 626688, v5
    v_mfma_f32_16x16x32_bf16 v[176:179], v[24:27], a[40:43], v[176:179]
    ds_read_b64_tr_b16 v[20:21], v6 offset:0
    v_mfma_f32_16x16x32_bf16 v[176:179], v[28:31], a[56:59], v[176:179]
    global_load_lds_dwordx4 v220, s[76:77]
    v_mfma_f32_16x16x32_bf16 v[180:183], v[28:31], a[60:63], v[180:183]
    ds_read_b64_tr_b16 v[22:23], v6 offset:2048
    s_add_u32 m0, s18, 86016
    v_mfma_f32_16x16x32_bf16 v[180:183], v[24:27], a[44:47], v[180:183]
    v_add_u32 v220, 1290240, v5
    s_waitcnt lgkmcnt(4)
    v_mfma_f32_16x16x32_bf16 v[84:87], v[32:35], a[44:47], v[84:87]
    ds_read_b64_tr_b16 v[24:25], v12 offset:57344
    v_mfma_f32_16x16x32_bf16 v[84:87], v[36:39], a[60:63], v[84:87]
    v_mfma_f32_16x16x32_bf16 v[80:83], v[36:39], a[56:59], v[80:83]
    ds_read_b64_tr_b16 v[26:27], v12 offset:59392
    v_mfma_f32_16x16x32_bf16 v[80:83], v[32:35], a[40:43], v[80:83]
    global_load_lds_dwordx4 v220, s[76:77]
    v_mfma_f32_16x16x32_bf16 v[76:79], v[32:35], a[36:39], v[76:79]
    ds_read_b64_tr_b16 v[28:29], v7 offset:0
    s_add_u32 m0, s18, 90112
    v_mfma_f32_16x16x32_bf16 v[76:79], v[36:39], a[52:55], v[76:79]
    v_add_u32 v220, 589952, v5
    v_mfma_f32_16x16x32_bf16 v[72:75], v[36:39], a[48:51], v[72:75]
    ds_read_b64_tr_b16 v[30:31], v7 offset:2048
    v_mfma_f32_16x16x32_bf16 v[72:75], v[32:35], a[32:35], v[72:75]
    global_load_lds_dwordx4 v220, s[76:77]
    s_waitcnt lgkmcnt(4)
    v_mfma_f32_16x16x32_bf16 v[88:91], v[16:19], a[32:35], v[88:91]
    ds_read_b64_tr_b16 v[32:33], v13 offset:57344
    s_add_u32 m0, s18, 94208
    v_mfma_f32_16x16x32_bf16 v[88:91], v[20:23], a[48:51], v[88:91]
    v_add_u32 v220, 1253504, v5
    v_mfma_f32_16x16x32_bf16 v[92:95], v[20:23], a[52:55], v[92:95]
    ds_read_b64_tr_b16 v[34:35], v13 offset:59392
    v_mfma_f32_16x16x32_bf16 v[92:95], v[16:19], a[36:39], v[92:95]
    v_mfma_f32_16x16x32_bf16 v[96:99], v[16:19], a[40:43], v[96:99]
    ds_read_b64_tr_b16 v[36:37], v8 offset:0
    v_mfma_f32_16x16x32_bf16 v[96:99], v[20:23], a[56:59], v[96:99]
    global_load_lds_dwordx4 v220, s[76:77]
    v_mfma_f32_16x16x32_bf16 v[100:103], v[20:23], a[60:63], v[100:103]
    ds_read_b64_tr_b16 v[38:39], v8 offset:2048
    s_add_u32 m0, s18, 98304
    v_mfma_f32_16x16x32_bf16 v[100:103], v[16:19], a[44:47], v[100:103]
    v_add_u32 v220, 626816, v5
    s_waitcnt lgkmcnt(4)
    v_mfma_f32_16x16x32_bf16 v[52:55], v[24:27], a[44:47], v[52:55]
    ds_read_b64_tr_b16 v[16:17], v14 offset:57344
    v_mfma_f32_16x16x32_bf16 v[52:55], v[28:31], a[60:63], v[52:55]
    global_load_lds_dwordx4 v220, s[76:77]
    v_mfma_f32_16x16x32_bf16 v[48:51], v[28:31], a[56:59], v[48:51]
    ds_read_b64_tr_b16 v[18:19], v14 offset:59392
    s_add_u32 m0, s18, 102400
    v_mfma_f32_16x16x32_bf16 v[48:51], v[24:27], a[40:43], v[48:51]
    v_add_u32 v220, 1290368, v5
    v_mfma_f32_16x16x32_bf16 v[44:47], v[24:27], a[36:39], v[44:47]
    ds_read_b64_tr_b16 v[20:21], v9 offset:0
    v_mfma_f32_16x16x32_bf16 v[44:47], v[28:31], a[52:55], v[44:47]
    v_mfma_f32_16x16x32_bf16 v[40:43], v[28:31], a[48:51], v[40:43]
    ds_read_b64_tr_b16 v[22:23], v9 offset:2048
    v_mfma_f32_16x16x32_bf16 v[40:43], v[24:27], a[32:35], v[40:43]
    global_load_lds_dwordx4 v220, s[76:77]
    s_waitcnt lgkmcnt(4)
    v_mfma_f32_16x16x32_bf16 v[56:59], v[32:35], a[32:35], v[56:59]
    ds_read_b64_tr_b16 v[24:25], v218 offset:10240
    v_mfma_f32_16x16x32_bf16 v[56:59], v[36:39], a[48:51], v[56:59]
    v_mfma_f32_16x16x32_bf16 v[60:63], v[36:39], a[52:55], v[60:63]
    ds_read_b64_tr_b16 v[26:27], v218 offset:10752
    v_mfma_f32_16x16x32_bf16 v[60:63], v[32:35], a[36:39], v[60:63]
    v_mfma_f32_16x16x32_bf16 v[64:67], v[32:35], a[40:43], v[64:67]
    ds_read_b64_tr_b16 v[28:29], v218 offset:11264
    v_mfma_f32_16x16x32_bf16 v[64:67], v[36:39], a[56:59], v[64:67]
    v_mfma_f32_16x16x32_bf16 v[68:71], v[36:39], a[60:63], v[68:71]
    ds_read_b64_tr_b16 v[30:31], v218 offset:11776
    v_mfma_f32_16x16x32_bf16 v[68:71], v[32:35], a[44:47], v[68:71]
    s_waitcnt lgkmcnt(4)
    v_mfma_f32_16x16x32_bf16 v[116:119], v[16:19], a[44:47], v[116:119]
    ds_read_b64_tr_b16 v[32:33], v218 offset:12288
    v_mfma_f32_16x16x32_bf16 v[116:119], v[20:23], a[60:63], v[116:119]
    v_mfma_f32_16x16x32_bf16 v[112:115], v[20:23], a[56:59], v[112:115]
    ds_read_b64_tr_b16 v[34:35], v218 offset:12800
    v_mfma_f32_16x16x32_bf16 v[112:115], v[16:19], a[40:43], v[112:115]
    v_mfma_f32_16x16x32_bf16 v[108:111], v[16:19], a[36:39], v[108:111]
    ds_read_b64_tr_b16 v[36:37], v218 offset:13312
    v_mfma_f32_16x16x32_bf16 v[108:111], v[20:23], a[52:55], v[108:111]
    v_mfma_f32_16x16x32_bf16 v[104:107], v[20:23], a[48:51], v[104:107]
    ds_read_b64_tr_b16 v[38:39], v218 offset:13824
    v_mfma_f32_16x16x32_bf16 v[104:107], v[16:19], a[32:35], v[104:107]
    s_waitcnt lgkmcnt(4)
    v_mfma_f32_16x16x32_bf16 v[136:139], v[24:27], a[0:3], 0
    s_barrier
    ds_read_b64_tr_b16 v[16:17], v6 offset:8192
    v_mfma_f32_16x16x32_bf16 v[136:139], v[28:31], a[16:19], v[136:139]
    v_mfma_f32_16x16x32_bf16 v[140:143], v[28:31], a[20:23], 0
    ds_read_b64_tr_b16 v[18:19], v6 offset:10240
    s_add_u32 m0, s18, 106496
    v_mfma_f32_16x16x32_bf16 v[140:143], v[24:27], a[4:7], v[140:143]
    v_add_u32 v220, 73728, v5
    v_mfma_f32_16x16x32_bf16 v[144:147], v[24:27], a[8:11], 0
    ds_read_b64_tr_b16 v[20:21], v6 offset:16384
    v_mfma_f32_16x16x32_bf16 v[144:147], v[28:31], a[24:27], v[144:147]
    global_load_lds_dwordx4 v220, s[76:77]
    v_mfma_f32_16x16x32_bf16 v[148:151], v[28:31], a[28:31], 0
    ds_read_b64_tr_b16 v[22:23], v6 offset:18432
    s_add_u32 m0, s18, 110592
    v_mfma_f32_16x16x32_bf16 v[148:151], v[24:27], a[12:15], v[148:151]
    v_add_u32 v220, 737280, v5
    s_waitcnt lgkmcnt(4)
    v_mfma_f32_16x16x32_bf16 v[148:151], v[32:35], a[44:47], v[148:151]
    ds_read_b64_tr_b16 v[24:25], v7 offset:8192
    v_mfma_f32_16x16x32_bf16 v[148:151], v[36:39], a[60:63], v[148:151]
    global_load_lds_dwordx4 v220, s[76:77]
    v_mfma_f32_16x16x32_bf16 v[144:147], v[36:39], a[56:59], v[144:147]
    ds_read_b64_tr_b16 v[26:27], v7 offset:10240
    s_add_u32 m0, s18, 114688
    v_mfma_f32_16x16x32_bf16 v[144:147], v[32:35], a[40:43], v[144:147]
    v_add_u32 v220, 221184, v5
    v_mfma_f32_16x16x32_bf16 v[140:143], v[32:35], a[36:39], v[140:143]
    ds_read_b64_tr_b16 v[28:29], v7 offset:16384
    v_mfma_f32_16x16x32_bf16 v[140:143], v[36:39], a[52:55], v[140:143]
    global_load_lds_dwordx4 v220, s[76:77]
    v_mfma_f32_16x16x32_bf16 v[136:139], v[36:39], a[48:51], v[136:139]
    ds_read_b64_tr_b16 v[30:31], v7 offset:18432
    s_add_u32 m0, s18, 118784
    v_mfma_f32_16x16x32_bf16 v[136:139], v[32:35], a[32:35], v[136:139]
    v_add_u32 v220, 884736, v5
    s_waitcnt lgkmcnt(4)
    v_mfma_f32_16x16x32_bf16 v[184:187], v[16:19], a[64:67], v[184:187]
    ds_read_b64_tr_b16 v[32:33], v8 offset:8192
    v_mfma_f32_16x16x32_bf16 v[184:187], v[20:23], a[80:83], v[184:187]
    v_mfma_f32_16x16x32_bf16 v[188:191], v[20:23], a[84:87], v[188:191]
    ds_read_b64_tr_b16 v[34:35], v8 offset:10240
    v_mfma_f32_16x16x32_bf16 v[188:191], v[16:19], a[68:71], v[188:191]
    global_load_lds_dwordx4 v220, s[76:77]
    v_mfma_f32_16x16x32_bf16 v[192:195], v[16:19], a[72:75], v[192:195]
    ds_read_b64_tr_b16 v[36:37], v8 offset:16384
    s_add_u32 m0, s18, 122880
    v_mfma_f32_16x16x32_bf16 v[192:195], v[20:23], a[88:91], v[192:195]
    v_add_u32 v220, 73856, v5
    v_mfma_f32_16x16x32_bf16 v[196:199], v[20:23], a[92:95], v[196:199]
    ds_read_b64_tr_b16 v[38:39], v8 offset:18432
    v_mfma_f32_16x16x32_bf16 v[196:199], v[16:19], a[76:79], v[196:199]
    global_load_lds_dwordx4 v220, s[76:77]
    s_waitcnt lgkmcnt(4)
    v_mfma_f32_16x16x32_bf16 v[212:215], v[24:27], a[76:79], v[212:215]
    ds_read_b64_tr_b16 v[16:17], v9 offset:8192
    s_add_u32 m0, s18, 126976
    v_mfma_f32_16x16x32_bf16 v[212:215], v[28:31], a[92:95], v[212:215]
    v_add_u32 v220, 737408, v5
    v_mfma_f32_16x16x32_bf16 v[208:211], v[28:31], a[88:91], v[208:211]
    ds_read_b64_tr_b16 v[18:19], v9 offset:10240
    v_mfma_f32_16x16x32_bf16 v[208:211], v[24:27], a[72:75], v[208:211]
    v_mfma_f32_16x16x32_bf16 v[204:207], v[24:27], a[68:71], v[204:207]
    ds_read_b64_tr_b16 v[20:21], v9 offset:16384
    v_mfma_f32_16x16x32_bf16 v[204:207], v[28:31], a[84:87], v[204:207]
    global_load_lds_dwordx4 v220, s[76:77]
    v_mfma_f32_16x16x32_bf16 v[200:203], v[28:31], a[80:83], v[200:203]
    ds_read_b64_tr_b16 v[22:23], v9 offset:18432
    s_add_u32 m0, s18, 0
    v_mfma_f32_16x16x32_bf16 v[200:203], v[24:27], a[64:67], v[200:203]
    v_add_u32 v220, 221312, v5
    s_add_u32 s42, s42, 0x10000
    buffer_load_dword v216, v222, s[8:11], s42 offen sc1
    s_waitcnt lgkmcnt(4)
    v_mfma_f32_16x16x32_bf16 v[168:171], v[32:35], a[64:67], v[168:171]
    ds_read_b64_tr_b16 v[24:25], v6 offset:24576
    v_mfma_f32_16x16x32_bf16 v[168:171], v[36:39], a[80:83], v[168:171]
    global_load_lds_dwordx4 v220, s[76:77]
    v_mfma_f32_16x16x32_bf16 v[172:175], v[36:39], a[84:87], v[172:175]
    ds_read_b64_tr_b16 v[26:27], v6 offset:26624
    s_add_u32 m0, s18, 4096
    v_mfma_f32_16x16x32_bf16 v[172:175], v[32:35], a[68:71], v[172:175]
    v_add_u32 v220, 884864, v5
    v_mfma_f32_16x16x32_bf16 v[176:179], v[32:35], a[72:75], v[176:179]
    ds_read_b64_tr_b16 v[28:29], v6 offset:32768
    v_mfma_f32_16x16x32_bf16 v[176:179], v[36:39], a[88:91], v[176:179]
    v_mfma_f32_16x16x32_bf16 v[180:183], v[36:39], a[92:95], v[180:183]
    ds_read_b64_tr_b16 v[30:31], v6 offset:34816
    v_mfma_f32_16x16x32_bf16 v[180:183], v[32:35], a[76:79], v[180:183]
    global_load_lds_dwordx4 v220, s[76:77]
    s_waitcnt lgkmcnt(4)
    v_mfma_f32_16x16x32_bf16 v[84:87], v[16:19], a[76:79], v[84:87]
    ds_read_b64_tr_b16 v[32:33], v7 offset:24576
    v_mfma_f32_16x16x32_bf16 v[84:87], v[20:23], a[92:95], v[84:87]
    v_mfma_f32_16x16x32_bf16 v[80:83], v[20:23], a[88:91], v[80:83]
    ds_read_b64_tr_b16 v[34:35], v7 offset:26624
    v_mfma_f32_16x16x32_bf16 v[80:83], v[16:19], a[72:75], v[80:83]
    v_mfma_f32_16x16x32_bf16 v[76:79], v[16:19], a[68:71], v[76:79]
    ds_read_b64_tr_b16 v[36:37], v7 offset:32768
    v_mfma_f32_16x16x32_bf16 v[76:79], v[20:23], a[84:87], v[76:79]
    v_mfma_f32_16x16x32_bf16 v[72:75], v[20:23], a[80:83], v[72:75]
    ds_read_b64_tr_b16 v[38:39], v7 offset:34816
    v_mfma_f32_16x16x32_bf16 v[72:75], v[16:19], a[64:67], v[72:75]
    s_waitcnt lgkmcnt(4)
    v_mfma_f32_16x16x32_bf16 v[88:91], v[24:27], a[64:67], v[88:91]
    s_barrier
    ds_read_b64_tr_b16 v[16:17], v8 offset:24576
    v_mfma_f32_16x16x32_bf16 v[88:91], v[28:31], a[80:83], v[88:91]
    v_mfma_f32_16x16x32_bf16 v[92:95], v[28:31], a[84:87], v[92:95]
    ds_read_b64_tr_b16 v[18:19], v8 offset:26624
    s_add_u32 m0, s18, 8192
    v_mfma_f32_16x16x32_bf16 v[92:95], v[24:27], a[68:71], v[92:95]
    v_add_u32 v220, 2048, v1
    v_mfma_f32_16x16x32_bf16 v[96:99], v[24:27], a[72:75], v[96:99]
    ds_read_b64_tr_b16 v[20:21], v8 offset:32768
    v_mfma_f32_16x16x32_bf16 v[96:99], v[28:31], a[88:91], v[96:99]
    global_load_lds_dwordx4 v220, s[86:87] sc1
    v_mfma_f32_16x16x32_bf16 v[100:103], v[28:31], a[92:95], v[100:103]
    ds_read_b64_tr_b16 v[22:23], v8 offset:34816
    s_add_u32 m0, s18, 12288
    v_mfma_f32_16x16x32_bf16 v[100:103], v[24:27], a[76:79], v[100:103]
    v_add_u32 v220, 223232, v1
    s_waitcnt lgkmcnt(4)
    v_mfma_f32_16x16x32_bf16 v[52:55], v[32:35], a[76:79], v[52:55]
    s_waitcnt vmcnt(17)
    s_barrier
    buffer_store_dword v221, v4, s[8:11], s29 offen sc1
    s_add_u32 s29, s29, 0x10000
    ds_read_b64_tr_b16 v[24:25], v9 offset:24576
    v_mfma_f32_16x16x32_bf16 v[52:55], v[36:39], a[92:95], v[52:55]
    global_load_lds_dwordx4 v220, s[86:87] sc1
    v_mfma_f32_16x16x32_bf16 v[48:51], v[36:39], a[88:91], v[48:51]
    ds_read_b64_tr_b16 v[26:27], v9 offset:26624
    s_add_u32 m0, s18, 16384
    v_mfma_f32_16x16x32_bf16 v[48:51], v[32:35], a[72:75], v[48:51]
    v_add_u32 v220, 368640, v5
    v_mfma_f32_16x16x32_bf16 v[44:47], v[32:35], a[68:71], v[44:47]
    ds_read_b64_tr_b16 v[28:29], v9 offset:32768
    v_mfma_f32_16x16x32_bf16 v[44:47], v[36:39], a[84:87], v[44:47]
    global_load_lds_dwordx4 v220, s[76:77]
    v_mfma_f32_16x16x32_bf16 v[40:43], v[36:39], a[80:83], v[40:43]
    ds_read_b64_tr_b16 v[30:31], v9 offset:34816
    s_add_u32 m0, s18, 20480
    v_mfma_f32_16x16x32_bf16 v[40:43], v[32:35], a[64:67], v[40:43]
    v_add_u32 v220, 1032192, v5
    s_waitcnt vmcnt(6)
    v_cmp_ne_u32 vcc, s6, v216
    s_cbranch_vccnz PS_38
PK_37:
    s_waitcnt lgkmcnt(4)
    v_mfma_f32_16x16x32_bf16 v[56:59], v[16:19], a[64:67], v[56:59]
    ds_read_b64_tr_b16 v[32:33], v218 offset:18432
    v_mfma_f32_16x16x32_bf16 v[56:59], v[20:23], a[80:83], v[56:59]
    v_mfma_f32_16x16x32_bf16 v[60:63], v[20:23], a[84:87], v[60:63]
    ds_read_b64_tr_b16 v[34:35], v218 offset:18944
    v_mfma_f32_16x16x32_bf16 v[60:63], v[16:19], a[68:71], v[60:63]
    global_load_lds_dwordx4 v220, s[76:77]
    v_mfma_f32_16x16x32_bf16 v[64:67], v[16:19], a[72:75], v[64:67]
    ds_read_b64_tr_b16 v[36:37], v218 offset:19456
    v_add_u32 v219, 32768, v1
    v_mfma_f32_16x16x32_bf16 v[64:67], v[20:23], a[88:91], v[64:67]
    v_mfma_f32_16x16x32_bf16 v[68:71], v[20:23], a[92:95], v[68:71]
    ds_read_b64_tr_b16 v[38:39], v218 offset:19968
    v_mfma_f32_16x16x32_bf16 v[68:71], v[16:19], a[76:79], v[68:71]
    global_load_dwordx4 a[160:163], v219, s[80:81] offset:0 sc1
    s_waitcnt lgkmcnt(4)
    v_mfma_f32_16x16x32_bf16 v[116:119], v[24:27], a[76:79], v[116:119]
    ds_read_b64_tr_b16 v[16:17], v6 offset:40960
    v_mfma_f32_16x16x32_bf16 v[116:119], v[28:31], a[92:95], v[116:119]
    v_mfma_f32_16x16x32_bf16 v[112:115], v[28:31], a[88:91], v[112:115]
    ds_read_b64_tr_b16 v[18:19], v6 offset:43008
    v_mfma_f32_16x16x32_bf16 v[112:115], v[24:27], a[72:75], v[112:115]
    v_mfma_f32_16x16x32_bf16 v[108:111], v[24:27], a[68:71], v[108:111]
    ds_read_b64_tr_b16 v[20:21], v6 offset:49152
    v_mfma_f32_16x16x32_bf16 v[108:111], v[28:31], a[84:87], v[108:111]
    global_load_dwordx4 a[164:167], v219, s[80:81] offset:1024 sc1
    v_mfma_f32_16x16x32_bf16 v[104:107], v[28:31], a[80:83], v[104:107]
    ds_read_b64_tr_b16 v[22:23], v6 offset:51200
    v_mfma_f32_16x16x32_bf16 v[104:107], v[24:27], a[64:67], v[104:107]
    s_waitcnt lgkmcnt(4)
    v_mfma_f32_16x16x32_bf16 v[136:139], v[32:35], a[64:67], v[136:139]
    ds_read_b64_tr_b16 v[24:25], v7 offset:40960
    v_mfma_f32_16x16x32_bf16 v[136:139], v[36:39], a[80:83], v[136:139]
    global_load_dwordx4 a[168:171], v219, s[82:83] offset:2048 sc1
    v_mfma_f32_16x16x32_bf16 v[140:143], v[36:39], a[84:87], v[140:143]
    ds_read_b64_tr_b16 v[26:27], v7 offset:43008
    v_mfma_f32_16x16x32_bf16 v[140:143], v[32:35], a[68:71], v[140:143]
    v_mfma_f32_16x16x32_bf16 v[144:147], v[32:35], a[72:75], v[144:147]
    ds_read_b64_tr_b16 v[28:29], v7 offset:49152
    v_mfma_f32_16x16x32_bf16 v[144:147], v[36:39], a[88:91], v[144:147]
    v_mfma_f32_16x16x32_bf16 v[148:151], v[36:39], a[92:95], v[148:151]
    ds_read_b64_tr_b16 v[30:31], v7 offset:51200
    v_mfma_f32_16x16x32_bf16 v[148:151], v[32:35], a[76:79], v[148:151]
    global_load_dwordx4 a[172:175], v219, s[82:83] offset:3072 sc1
    s_waitcnt lgkmcnt(4)
    v_mfma_f32_16x16x32_bf16 v[196:199], v[16:19], a[108:111], v[196:199]
    ds_read_b64_tr_b16 v[32:33], v8 offset:40960
    v_add_u32 v219, 36864, v1
    v_mfma_f32_16x16x32_bf16 v[196:199], v[20:23], a[124:127], v[196:199]
    v_mfma_f32_16x16x32_bf16 v[192:195], v[20:23], a[120:123], v[192:195]
    ds_read_b64_tr_b16 v[34:35], v8 offset:43008
    v_mfma_f32_16x16x32_bf16 v[192:195], v[16:19], a[104:107], v[192:195]
    global_load_dwordx4 a[176:179], v219, s[80:81] offset:0 sc1
    v_mfma_f32_16x16x32_bf16 v[188:191], v[16:19], a[100:103], v[188:191]
    ds_read_b64_tr_b16 v[36:37], v8 offset:49152
    v_mfma_f32_16x16x32_bf16 v[188:191], v[20:23], a[116:119], v[188:191]
    v_mfma_f32_16x16x32_bf16 v[184:187], v[20:23], a[112:115], v[184:187]
    ds_read_b64_tr_b16 v[38:39], v8 offset:51200
    v_mfma_f32_16x16x32_bf16 v[184:187], v[16:19], a[96:99], v[184:187]
    s_waitcnt lgkmcnt(4)
    v_mfma_f32_16x16x32_bf16 v[200:203], v[24:27], a[96:99], v[200:203]
    s_barrier
    ds_read_b64_tr_b16 v[16:17], v9 offset:40960
    v_mfma_f32_16x16x32_bf16 v[200:203], v[28:31], a[112:115], v[200:203]
    global_load_dwordx4 a[180:183], v219, s[80:81] offset:1024 sc1
    v_mfma_f32_16x16x32_bf16 v[204:207], v[28:31], a[116:119], v[204:207]
    ds_read_b64_tr_b16 v[18:19], v9 offset:43008
    v_mfma_f32_16x16x32_bf16 v[204:207], v[24:27], a[100:103], v[204:207]
    v_mfma_f32_16x16x32_bf16 v[208:211], v[24:27], a[104:107], v[208:211]
    ds_read_b64_tr_b16 v[20:21], v9 offset:49152
    v_mfma_f32_16x16x32_bf16 v[208:211], v[28:31], a[120:123], v[208:211]
    global_load_dwordx4 a[184:187], v219, s[82:83] offset:2048 sc1
    v_mfma_f32_16x16x32_bf16 v[212:215], v[28:31], a[124:127], v[212:215]
    ds_read_b64_tr_b16 v[22:23], v9 offset:51200
    v_mfma_f32_16x16x32_bf16 v[212:215], v[24:27], a[108:111], v[212:215]
    s_waitcnt lgkmcnt(4)
    v_mfma_f32_16x16x32_bf16 v[180:183], v[32:35], a[108:111], v[180:183]
    ds_read_b64_tr_b16 v[24:25], v6 offset:57344
    v_mfma_f32_16x16x32_bf16 v[180:183], v[36:39], a[124:127], v[180:183]
    v_mfma_f32_16x16x32_bf16 v[176:179], v[36:39], a[120:123], v[176:179]
    ds_read_b64_tr_b16 v[26:27], v6 offset:59392
    v_mfma_f32_16x16x32_bf16 v[176:179], v[32:35], a[104:107], v[176:179]
    global_load_dwordx4 a[188:191], v219, s[82:83] offset:3072 sc1
    v_mfma_f32_16x16x32_bf16 v[172:175], v[32:35], a[100:103], v[172:175]
    ds_read_b64_tr_b16 v[28:29], v11 offset:0
    s_add_u32 m0, s18, 24576
    v_mfma_f32_16x16x32_bf16 v[172:175], v[36:39], a[116:119], v[172:175]
    v_add_u32 v220, 516096, v5
    v_mfma_f32_16x16x32_bf16 v[168:171], v[36:39], a[112:115], v[168:171]
    ds_read_b64_tr_b16 v[30:31], v11 offset:2048
    v_mfma_f32_16x16x32_bf16 v[168:171], v[32:35], a[96:99], v[168:171]
    global_load_lds_dwordx4 v220, s[76:77]
    s_waitcnt lgkmcnt(4)
    v_mfma_f32_16x16x32_bf16 v[72:75], v[16:19], a[96:99], v[72:75]
    ds_read_b64_tr_b16 v[32:33], v7 offset:57344
    s_add_u32 m0, s18, 28672
    v_mfma_f32_16x16x32_bf16 v[72:75], v[20:23], a[112:115], v[72:75]
    v_add_u32 v220, 1179648, v5
    v_mfma_f32_16x16x32_bf16 v[76:79], v[20:23], a[116:119], v[76:79]
    ds_read_b64_tr_b16 v[34:35], v7 offset:59392
    v_mfma_f32_16x16x32_bf16 v[76:79], v[16:19], a[100:103], v[76:79]
    v_mfma_f32_16x16x32_bf16 v[80:83], v[16:19], a[104:107], v[80:83]
    ds_read_b64_tr_b16 v[36:37], v12 offset:0
    v_mfma_f32_16x16x32_bf16 v[80:83], v[20:23], a[120:123], v[80:83]
    global_load_lds_dwordx4 v220, s[76:77]
    v_mfma_f32_16x16x32_bf16 v[84:87], v[20:23], a[124:127], v[84:87]
    ds_read_b64_tr_b16 v[38:39], v12 offset:2048
    s_add_u32 m0, s18, 32768
    v_mfma_f32_16x16x32_bf16 v[84:87], v[16:19], a[108:111], v[84:87]
    v_add_u32 v220, 110592, v5
    s_waitcnt lgkmcnt(4)
    v_mfma_f32_16x16x32_bf16 v[100:103], v[24:27], a[108:111], v[100:103]
    ds_read_b64_tr_b16 v[16:17], v8 offset:57344
    v_mfma_f32_16x16x32_bf16 v[100:103], v[28:31], a[124:127], v[100:103]
    global_load_lds_dwordx4 v220, s[76:77]
    v_mfma_f32_16x16x32_bf16 v[96:99], v[28:31], a[120:123], v[96:99]
    ds_read_b64_tr_b16 v[18:19], v8 offset:59392
    s_add_u32 m0, s18, 36864
    v_mfma_f32_16x16x32_bf16 v[96:99], v[24:27], a[104:107], v[96:99]
    v_add_u32 v220, 774144, v5
    v_mfma_f32_16x16x32_bf16 v[92:95], v[24:27], a[100:103], v[92:95]
    ds_read_b64_tr_b16 v[20:21], v13 offset:0
    v_mfma_f32_16x16x32_bf16 v[92:95], v[28:31], a[116:119], v[92:95]
    v_mfma_f32_16x16x32_bf16 v[88:91], v[28:31], a[112:115], v[88:91]
    ds_read_b64_tr_b16 v[22:23], v13 offset:2048
    v_mfma_f32_16x16x32_bf16 v[88:91], v[24:27], a[96:99], v[88:91]
    global_load_lds_dwordx4 v220, s[76:77]
    s_waitcnt lgkmcnt(4)
    v_mfma_f32_16x16x32_bf16 v[40:43], v[32:35], a[96:99], v[40:43]
    ds_read_b64_tr_b16 v[24:25], v9 offset:57344
    v_add_u32 v219, 40960, v1
    v_mfma_f32_16x16x32_bf16 v[40:43], v[36:39], a[112:115], v[40:43]
    v_mfma_f32_16x16x32_bf16 v[44:47], v[36:39], a[116:119], v[44:47]
    ds_read_b64_tr_b16 v[26:27], v9 offset:59392
    v_mfma_f32_16x16x32_bf16 v[44:47], v[32:35], a[100:103], v[44:47]
    global_load_dwordx4 a[192:195], v219, s[80:81] offset:0 sc1
    v_mfma_f32_16x16x32_bf16 v[48:51], v[32:35], a[104:107], v[48:51]
    ds_read_b64_tr_b16 v[28:29], v14 offset:0
    v_mfma_f32_16x16x32_bf16 v[48:51], v[36:39], a[120:123], v[48:51]
    v_mfma_f32_16x16x32_bf16 v[52:55], v[36:39], a[124:127], v[52:55]
    ds_read_b64_tr_b16 v[30:31], v14 offset:2048
    v_mfma_f32_16x16x32_bf16 v[52:55], v[32:35], a[108:111], v[52:55]
    s_waitcnt lgkmcnt(4)
    v_mfma_f32_16x16x32_bf16 v[68:71], v[16:19], a[108:111], v[68:71]
    ds_read_b64_tr_b16 v[32:33], v218 offset:20480
    v_mfma_f32_16x16x32_bf16 v[68:71], v[20:23], a[124:127], v[68:71]
    global_load_dwordx4 a[196:199], v219, s[80:81] offset:1024 sc1
    v_mfma_f32_16x16x32_bf16 v[64:67], v[20:23], a[120:123], v[64:67]
    ds_read_b64_tr_b16 v[34:35], v218 offset:20992
    v_mfma_f32_16x16x32_bf16 v[64:67], v[16:19], a[104:107], v[64:67]
    v_mfma_f32_16x16x32_bf16 v[60:63], v[16:19], a[100:103], v[60:63]
    ds_read_b64_tr_b16 v[36:37], v218 offset:21504
    v_mfma_f32_16x16x32_bf16 v[60:63], v[20:23], a[116:119], v[60:63]
    global_load_dwordx4 a[200:203], v219, s[82:83] offset:2048 sc1
    v_mfma_f32_16x16x32_bf16 v[56:59], v[20:23], a[112:115], v[56:59]
    ds_read_b64_tr_b16 v[38:39], v218 offset:22016
    v_mfma_f32_16x16x32_bf16 v[56:59], v[16:19], a[96:99], v[56:59]
    s_waitcnt lgkmcnt(4)
    v_mfma_f32_16x16x32_bf16 v[104:107], v[24:27], a[96:99], v[104:107]
    s_barrier
    ds_read_b64_tr_b16 v[16:17], v11 offset:8192
    v_mfma_f32_16x16x32_bf16 v[104:107], v[28:31], a[112:115], v[104:107]
    v_mfma_f32_16x16x32_bf16 v[108:111], v[28:31], a[116:119], v[108:111]
    ds_read_b64_tr_b16 v[18:19], v11 offset:10240
PAD_9:
    s_cbranch_execz PAD_END
    v_mfma_f32_16x16x32_bf16 v[108:111], v[24:27], a[100:103], v[108:111]
    global_load_dwordx4 a[204:207], v219, s[82:83] offset:3072 sc1
    v_mfma_f32_16x16x32_bf16 v[112:115], v[24:27], a[104:107], v[112:115]
    ds_read_b64_tr_b16 v[20:21], v11 offset:16384
    s_add_u32 m0, s18, 40960
    v_mfma_f32_16x16x32_bf16 v[112:115], v[28:31], a[120:123], v[112:115]
    v_add_u32 v220, 258048, v5
    v_mfma_f32_16x16x32_bf16 v[116:119], v[28:31], a[124:127], v[116:119]
    ds_read_b64_tr_b16 v[22:23], v11 offset:18432
    v_mfma_f32_16x16x32_bf16 v[116:119], v[24:27], a[108:111], v[116:119]
    global_load_lds_dwordx4 v220, s[76:77]
    s_add_u32 s42, s42, 0x10000
    buffer_load_dword v216, v222, s[8:11], s42 offen sc1
    s_waitcnt lgkmcnt(4)
    v_mfma_f32_16x16x32_bf16 v[148:151], v[32:35], a[108:111], v[148:151]
    ds_read_b64_tr_b16 v[24:25], v12 offset:8192
    s_add_u32 m0, s18, 45056
    v_mfma_f32_16x16x32_bf16 v[148:151], v[36:39], a[124:127], v[148:151]
    v_add_u32 v220, 921600, v5
    v_mfma_f32_16x16x32_bf16 v[144:147], v[36:39], a[120:123], v[144:147]
    ds_read_b64_tr_b16 v[26:27], v12 offset:10240
    v_mfma_f32_16x16x32_bf16 v[144:147], v[32:35], a[104:107], v[144:147]
    v_mfma_f32_16x16x32_bf16 v[140:143], v[32:35], a[100:103], v[140:143]
    ds_read_b64_tr_b16 v[28:29], v12 offset:16384
    v_mfma_f32_16x16x32_bf16 v[140:143], v[36:39], a[116:119], v[140:143]
    global_load_lds_dwordx4 v220, s[76:77]
    v_mfma_f32_16x16x32_bf16 v[136:139], v[36:39], a[112:115], v[136:139]
    ds_read_b64_tr_b16 v[30:31], v12 offset:18432
    s_add_u32 m0, s18, 49152
    v_mfma_f32_16x16x32_bf16 v[136:139], v[32:35], a[96:99], v[136:139]
    v_add_u32 v220, 405504, v5
    s_waitcnt lgkmcnt(4)
    v_mfma_f32_16x16x32_bf16 v[184:187], v[16:19], a[128:131], v[184:187]
    ds_read_b64_tr_b16 v[32:33], v13 offset:8192
    v_mfma_f32_16x16x32_bf16 v[184:187], v[20:23], a[144:147], v[184:187]
    global_load_lds_dwordx4 v220, s[76:77]
    v_mfma_f32_16x16x32_bf16 v[188:191], v[20:23], a[148:151], v[188:191]
    ds_read_b64_tr_b16 v[34:35], v13 offset:10240
    s_add_u32 m0, s18, 53248
    v_mfma_f32_16x16x32_bf16 v[188:191], v[16:19], a[132:135], v[188:191]
    v_add_u32 v220, 1069056, v5
    v_mfma_f32_16x16x32_bf16 v[192:195], v[16:19], a[136:139], v[192:195]
    ds_read_b64_tr_b16 v[36:37], v13 offset:16384
    v_mfma_f32_16x16x32_bf16 v[192:195], v[20:23], a[152:155], v[192:195]
    v_mfma_f32_16x16x32_bf16 v[196:199], v[20:23], a[156:159], v[196:199]
    ds_read_b64_tr_b16 v[38:39], v13 offset:18432
    v_mfma_f32_16x16x32_bf16 v[196:199], v[16:19], a[140:143], v[196:199]
    global_load_lds_dwordx4 v220, s[76:77]
    s_waitcnt lgkmcnt(4)
    v_mfma_f32_16x16x32_bf16 v[212:215], v[24:27], a[140:143], v[212:215]
    ds_read_b64_tr_b16 v[16:17], v14 offset:8192
    s_add_u32 m0, s18, 57344
    v_mfma_f32_16x16x32_bf16 v[212:215], v[28:31], a[156:159], v[212:215]
    v_add_u32 v220, 552960, v5
    v_mfma_f32_16x16x32_bf16 v[208:211], v[28:31], a[152:155], v[208:211]
    ds_read_b64_tr_b16 v[18:19], v14 offset:10240
    v_mfma_f32_16x16x32_bf16 v[208:211], v[24:27], a[136:139], v[208:211]
    global_load_lds_dwordx4 v220, s[76:77]
    v_mfma_f32_16x16x32_bf16 v[204:207], v[24:27], a[132:135], v[204:207]
    ds_read_b64_tr_b16 v[20:21], v14 offset:16384
    s_add_u32 m0, s18, 61440
    v_mfma_f32_16x16x32_bf16 v[204:207], v[28:31], a[148:151], v[204:207]
    v_add_u32 v220, 1216512, v5
    v_mfma_f32_16x16x32_bf16 v[200:203], v[28:31], a[144:147], v[200:203]
    ds_read_b64_tr_b16 v[22:23], v14 offset:18432
    v_mfma_f32_16x16x32_bf16 v[200:203], v[24:27], a[128:131], v[200:203]
    s_waitcnt lgkmcnt(4)
    v_mfma_f32_16x16x32_bf16 v[168:171], v[32:35], a[128:131], v[168:171]
    ds_read_b64_tr_b16 v[24:25], v11 offset:24576
    v_mfma_f32_16x16x32_bf16 v[168:171], v[36:39], a[144:147], v[168:171]
    global_load_lds_dwordx4 v220, s[76:77]
    v_mfma_f32_16x16x32_bf16 v[172:175], v[36:39], a[148:151], v[172:175]
    ds_read_b64_tr_b16 v[26:27], v11 offset:26624
    v_add_u32 v219, 45056, v1
    v_mfma_f32_16x16x32_bf16 v[172:175], v[32:35], a[132:135], v[172:175]
    v_mfma_f32_16x16x32_bf16 v[176:179], v[32:35], a[136:139], v[176:179]
    ds_read_b64_tr_b16 v[28:29], v11 offset:32768
    v_mfma_f32_16x16x32_bf16 v[176:179], v[36:39], a[152:155], v[176:179]
    global_load_dwordx4 a[208:211], v219, s[80:81] offset:0 sc1
    v_mfma_f32_16x16x32_bf16 v[180:183], v[36:39], a[156:159], v[180:183]
    ds_read_b64_tr_b16 v[30:31], v11 offset:34816
    v_mfma_f32_16x16x32_bf16 v[180:183], v[32:35], a[140:143], v[180:183]
    s_waitcnt vmcnt(6)
    v_cmp_ne_u32 vcc, s6, v216
    s_cbranch_vccnz PS_40
PK_39:
    s_waitcnt lgkmcnt(4)
    v_mfma_f32_16x16x32_bf16 v[84:87], v[16:19], a[140:143], v[84:87]
    ds_read_b64_tr_b16 v[32:33], v12 offset:24576
    v_mfma_f32_16x16x32_bf16 v[84:87], v[20:23], a[156:159], v[84:87]
    v_mfma_f32_16x16x32_bf16 v[80:83], v[20:23], a[152:155], v[80:83]
    ds_read_b64_tr_b16 v[34:35], v12 offset:26624
    v_mfma_f32_16x16x32_bf16 v[80:83], v[16:19], a[136:139], v[80:83]
    global_load_dwordx4 a[212:215], v219, s[80:81] offset:1024 sc1
    v_mfma_f32_16x16x32_bf16 v[76:79], v[16:19], a[132:135], v[76:79]
    ds_read_b64_tr_b16 v[36:37], v12 offset:32768
    v_mfma_f32_16x16x32_bf16 v[76:79], v[20:23], a[148:151], v[76:79]
    v_mfma_f32_16x16x32_bf16 v[72:75], v[20:23], a[144:147], v[72:75]
    ds_read_b64_tr_b16 v[38:39], v12 offset:34816
    v_mfma_f32_16x16x32_bf16 v[72:75], v[16:19], a[128:131], v[72:75]
    global_load_dwordx4 a[216:219], v219, s[82:83] offset:2048 sc1
    s_waitcnt lgkmcnt(4)
    v_mfma_f32_16x16x32_bf16 v[88:91], v[24:27], a[128:131], v[88:91]
    s_barrier
    ds_read_b64_tr_b16 v[16:17], v13 offset:24576
    v_mfma_f32_16x16x32_bf16 v[88:91], v[28:31], a[144:147], v[88:91]
    v_mfma_f32_16x16x32_bf16 v[92:95], v[28:31], a[148:151], v[92:95]
    ds_read_b64_tr_b16 v[18:19], v13 offset:26624
    v_mfma_f32_16x16x32_bf16 v[92:95], v[24:27], a[132:135], v[92:95]
    v_mfma_f32_16x16x32_bf16 v[96:99], v[24:27], a[136:139], v[96:99]
    ds_read_b64_tr_b16 v[20:21], v13 offset:32768
    v_mfma_f32_16x16x32_bf16 v[96:99], v[28:31], a[152:155], v[96:99]
    global_load_dwordx4 a[220:223], v219, s[82:83] offset:3072 sc1
    v_mfma_f32_16x16x32_bf16 v[100:103], v[28:31], a[156:159], v[100:103]
    ds_read_b64_tr_b16 v[22:23], v13 offset:34816
    v_add_u32 v219, 49152, v1
    v_mfma_f32_16x16x32_bf16 v[100:103], v[24:27], a[140:143], v[100:103]
    s_waitcnt lgkmcnt(4)
    v_mfma_f32_16x16x32_bf16 v[52:55], v[32:35], a[140:143], v[52:55]
    ds_read_b64_tr_b16 v[24:25], v14 offset:24576
    v_mfma_f32_16x16x32_bf16 v[52:55], v[36:39], a[156:159], v[52:55]
    global_load_dwordx4 a[224:227], v219, s[80:81] offset:0 sc1
    v_mfma_f32_16x16x32_bf16 v[48:51], v[36:39], a[152:155], v[48:51]
    ds_read_b64_tr_b16 v[26:27], v14 offset:26624
    v_mfma_f32_16x16x32_bf16 v[48:51], v[32:35], a[136:139], v[48:51]
    v_mfma_f32_16x16x32_bf16 v[44:47], v[32:35], a[132:135], v[44:47]
    ds_read_b64_tr_b16 v[28:29], v14 offset:32768
    v_mfma_f32_16x16x32_bf16 v[44:47], v[36:39], a[148:151], v[44:47]
    v_mfma_f32_16x16x32_bf16 v[40:43], v[36:39], a[144:147], v[40:43]
    ds_read_b64_tr_b16 v[30:31], v14 offset:34816
    v_mfma_f32_16x16x32_bf16 v[40:43], v[32:35], a[128:131], v[40:43]
    global_load_dwordx4 a[228:231], v219, s[80:81] offset:1024 sc1
    s_waitcnt lgkmcnt(4)
    v_mfma_f32_16x16x32_bf16 v[56:59], v[16:19], a[128:131], v[56:59]
    ds_read_b64_tr_b16 v[32:33], v218 offset:26624
    v_mfma_f32_16x16x32_bf16 v[56:59], v[20:23], a[144:147], v[56:59]
    v_mfma_f32_16x16x32_bf16 v[60:63], v[20:23], a[148:151], v[60:63]
    ds_read_b64_tr_b16 v[34:35], v218 offset:27136
    v_mfma_f32_16x16x32_bf16 v[60:63], v[16:19], a[132:135], v[60:63]
    global_load_dwordx4 a[232:235], v219, s[82:83] offset:2048 sc1
    v_mfma_f32_16x16x32_bf16 v[64:67], v[16:19], a[136:139], v[64:67]
    ds_read_b64_tr_b16 v[36:37], v218 offset:27648
    v_mfma_f32_16x16x32_bf16 v[64:67], v[20:23], a[152:155], v[64:67]
    v_mfma_f32_16x16x32_bf16 v[68:71], v[20:23], a[156:159], v[68:71]
    ds_read_b64_tr_b16 v[38:39], v218 offset:28160
    v_mfma_f32_16x16x32_bf16 v[68:71], v[16:19], a[140:143], v[68:71]
    s_waitcnt lgkmcnt(4)
    v_mfma_f32_16x16x32_bf16 v[116:119], v[24:27], a[140:143], v[116:119]
    ds_read_b64_tr_b16 v[16:17], v11 offset:40960
    v_mfma_f32_16x16x32_bf16 v[116:119], v[28:31], a[156:159], v[116:119]
    global_load_dwordx4 a[236:239], v219, s[82:83] offset:3072 sc1
    v_mfma_f32_16x16x32_bf16 v[112:115], v[28:31], a[152:155], v[112:115]
    ds_read_b64_tr_b16 v[18:19], v11 offset:43008
    v_add_u32 v219, 53248, v1
    v_mfma_f32_16x16x32_bf16 v[112:115], v[24:27], a[136:139], v[112:115]
    v_mfma_f32_16x16x32_bf16 v[108:111], v[24:27], a[132:135], v[108:111]
    ds_read_b64_tr_b16 v[20:21], v11 offset:49152
    v_mfma_f32_16x16x32_bf16 v[108:111], v[28:31], a[148:151], v[108:111]
    global_load_dwordx4 a[240:243], v219, s[80:81] offset:0 sc1
    v_mfma_f32_16x16x32_bf16 v[104:107], v[28:31], a[144:147], v[104:107]
    ds_read_b64_tr_b16 v[22:23], v11 offset:51200
    v_mfma_f32_16x16x32_bf16 v[104:107], v[24:27], a[128:131], v[104:107]
    s_waitcnt lgkmcnt(4)
    v_mfma_f32_16x16x32_bf16 v[136:139], v[32:35], a[128:131], v[136:139]
    ds_read_b64_tr_b16 v[24:25], v12 offset:40960
    v_mfma_f32_16x16x32_bf16 v[136:139], v[36:39], a[144:147], v[136:139]
    v_mfma_f32_16x16x32_bf16 v[140:143], v[36:39], a[148:151], v[140:143]
    ds_read_b64_tr_b16 v[26:27], v12 offset:43008
    v_mfma_f32_16x16x32_bf16 v[140:143], v[32:35], a[132:135], v[140:143]
    global_load_dwordx4 a[244:247], v219, s[80:81] offset:1024 sc1
    v_mfma_f32_16x16x32_bf16 v[144:147], v[32:35], a[136:139], v[144:147]
    ds_read_b64_tr_b16 v[28:29], v12 offset:49152
    v_mfma_f32_16x16x32_bf16 v[144:147], v[36:39], a[152:155], v[144:147]
    v_mfma_f32_16x16x32_bf16 v[148:151], v[36:39], a[156:159], v[148:151]
    ds_read_b64_tr_b16 v[30:31], v12 offset:51200
    v_mfma_f32_16x16x32_bf16 v[148:151], v[32:35], a[140:143], v[148:151]
    global_load_dwordx4 a[248:251], v219, s[82:83] offset:2048 sc1
    s_waitcnt lgkmcnt(4)
    v_mfma_f32_16x16x32_bf16 v[196:199], v[16:19], a[172:175], v[196:199]
    ds_read_b64_tr_b16 v[32:33], v13 offset:40960
    v_mfma_f32_16x16x32_bf16 v[196:199], v[20:23], a[188:191], v[196:199]
    v_mfma_f32_16x16x32_bf16 v[192:195], v[20:23], a[184:187], v[192:195]
    ds_read_b64_tr_b16 v[34:35], v13 offset:43008
    v_mfma_f32_16x16x32_bf16 v[192:195], v[16:19], a[168:171], v[192:195]
    v_mfma_f32_16x16x32_bf16 v[188:191], v[16:19], a[164:167], v[188:191]
    ds_read_b64_tr_b16 v[36:37], v13 offset:49152
    v_mfma_f32_16x16x32_bf16 v[188:191], v[20:23], a[180:183], v[188:191]
    global_load_dwordx4 a[252:255], v219, s[82:83] offset:3072 sc1
    v_mfma_f32_16x16x32_bf16 v[184:187], v[20:23], a[176:179], v[184:187]
    ds_read_b64_tr_b16 v[38:39], v13 offset:51200
    v_add_u32 v219, 57344, v1
    v_mfma_f32_16x16x32_bf16 v[184:187], v[16:19], a[160:163], v[184:187]
    s_waitcnt lgkmcnt(4)
    v_mfma_f32_16x16x32_bf16 v[200:203], v[24:27], a[160:163], v[200:203]
    s_barrier
    ds_read_b64_tr_b16 v[16:17], v14 offset:40960
    v_mfma_f32_16x16x32_bf16 v[200:203], v[28:31], a[176:179], v[200:203]
    global_load_dwordx4 v[224:227], v219, s[80:81] offset:0 sc1
    v_mfma_f32_16x16x32_bf16 v[204:207], v[28:31], a[180:183], v[204:207]
    ds_read_b64_tr_b16 v[18:19], v14 offset:43008
    v_mfma_f32_16x16x32_bf16 v[204:207], v[24:27], a[164:167], v[204:207]
    v_mfma_f32_16x16x32_bf16 v[208:211], v[24:27], a[168:171], v[208:211]
    ds_read_b64_tr_b16 v[20:21], v14 offset:49152
    v_mfma_f32_16x16x32_bf16 v[208:211], v[28:31], a[184:187], v[208:211]
    v_mfma_f32_16x16x32_bf16 v[212:215], v[28:31], a[188:191], v[212:215]
    ds_read_b64_tr_b16 v[22:23], v14 offset:51200
    v_mfma_f32_16x16x32_bf16 v[212:215], v[24:27], a[172:175], v[212:215]
    global_load_dwordx4 v[228:231], v219, s[80:81] offset:1024 sc1
    s_waitcnt lgkmcnt(4)
    v_mfma_f32_16x16x32_bf16 v[180:183], v[32:35], a[172:175], v[180:183]
    ds_read_b64_tr_b16 v[24:25], v11 offset:57344
    v_mfma_f32_16x16x32_bf16 v[180:183], v[36:39], a[188:191], v[180:183]
    v_mfma_f32_16x16x32_bf16 v[176:179], v[36:39], a[184:187], v[176:179]
    ds_read_b64_tr_b16 v[26:27], v11 offset:59392
    v_mfma_f32_16x16x32_bf16 v[176:179], v[32:35], a[168:171], v[176:179]
    global_load_dwordx4 v[232:235], v219, s[82:83] offset:2048 sc1
    v_mfma_f32_16x16x32_bf16 v[172:175], v[32:35], a[164:167], v[172:175]
    ds_read_b64_tr_b16 v[28:29], v6 offset:0
    v_mfma_f32_16x16x32_bf16 v[172:175], v[36:39], a[180:183], v[172:175]
    v_mfma_f32_16x16x32_bf16 v[168:171], v[36:39], a[176:179], v[168:171]
    ds_read_b64_tr_b16 v[30:31], v6 offset:2048
    v_mfma_f32_16x16x32_bf16 v[168:171], v[32:35], a[160:163], v[168:171]
    s_waitcnt lgkmcnt(4)
    v_mfma_f32_16x16x32_bf16 v[72:75], v[16:19], a[160:163], v[72:75]
    ds_read_b64_tr_b16 v[32:33], v12 offset:57344
    v_bfe_u32 v216, v0, 4, 2
    v_mfma_f32_16x16x32_bf16 v[72:75], v[20:23], a[176:179], v[72:75]
    global_load_dwordx4 v[236:239], v219, s[82:83] offset:3072 sc1
    v_and_b32 v218, 56, v2
    v_mfma_f32_16x16x32_bf16 v[76:79], v[20:23], a[180:183], v[76:79]
    ds_read_b64_tr_b16 v[34:35], v12 offset:59392
    v_add_u32 v219, 61440, v1
    v_mfma_f32_16x16x32_bf16 v[76:79], v[16:19], a[164:167], v[76:79]
    v_lshl_add_u32 v218, v216, 6, v218
    v_bfe_u32 v216, v0, 3, 1
    v_mfma_f32_16x16x32_bf16 v[80:83], v[16:19], a[168:171], v[80:83]
    ds_read_b64_tr_b16 v[36:37], v7 offset:0
    v_lshl_add_u32 v218, v216, 8, v218
    v_mfma_f32_16x16x32_bf16 v[80:83], v[20:23], a[184:187], v[80:83]
    global_load_dwordx4 v[240:243], v219, s[80:81] offset:0 sc1
    s_lshl_b32 s46, s3, 11
    v_mfma_f32_16x16x32_bf16 v[84:87], v[20:23], a[188:191], v[84:87]
    ds_read_b64_tr_b16 v[38:39], v7 offset:2048
    s_add_u32 s47, s46, 141312
    v_mfma_f32_16x16x32_bf16 v[84:87], v[16:19], a[172:175], v[84:87]
    v_add_u32 v216, s47, v1
    s_waitcnt lgkmcnt(4)
    v_mfma_f32_16x16x32_bf16 v[100:103], v[24:27], a[172:175], v[100:103]
    ds_read_b64_tr_b16 v[16:17], v13 offset:57344
    s_xor_b32 s46, s46, 4096
    v_mfma_f32_16x16x32_bf16 v[100:103], v[28:31], a[188:191], v[100:103]
    s_add_u32 s47, s46, 141312
    v_add_u32 v222, s47, v1
    v_mfma_f32_16x16x32_bf16 v[96:99], v[28:31], a[184:187], v[96:99]
    ds_read_b64_tr_b16 v[18:19], v13 offset:59392
    v_mfma_f32_16x16x32_bf16 v[96:99], v[24:27], a[168:171], v[96:99]
    global_load_dwordx4 v[244:247], v219, s[80:81] offset:1024 sc1
    v_mfma_f32_16x16x32_bf16 v[92:95], v[24:27], a[164:167], v[92:95]
    ds_read_b64_tr_b16 v[20:21], v8 offset:0
    v_mfma_f32_16x16x32_bf16 v[92:95], v[28:31], a[180:183], v[92:95]
    v_mfma_f32_16x16x32_bf16 v[88:91], v[28:31], a[176:179], v[88:91]
    ds_read_b64_tr_b16 v[22:23], v8 offset:2048
    v_mfma_f32_16x16x32_bf16 v[88:91], v[24:27], a[160:163], v[88:91]
    global_load_dwordx4 v[248:251], v219, s[82:83] offset:2048 sc1
    s_waitcnt lgkmcnt(4)
    v_mfma_f32_16x16x32_bf16 v[40:43], v[32:35], a[160:163], v[40:43]
    ds_read_b64_tr_b16 v[24:25], v14 offset:57344
    v_mfma_f32_16x16x32_bf16 v[40:43], v[36:39], a[176:179], v[40:43]
    v_mfma_f32_16x16x32_bf16 v[44:47], v[36:39], a[180:183], v[44:47]
    ds_read_b64_tr_b16 v[26:27], v14 offset:59392
    v_mfma_f32_16x16x32_bf16 v[44:47], v[32:35], a[164:167], v[44:47]
    v_mfma_f32_16x16x32_bf16 v[48:51], v[32:35], a[168:171], v[48:51]
    ds_read_b64_tr_b16 v[28:29], v9 offset:0
    v_mfma_f32_16x16x32_bf16 v[48:51], v[36:39], a[184:187], v[48:51]
    global_load_dwordx4 v[252:255], v219, s[82:83] offset:3072 sc1
    v_mfma_f32_16x16x32_bf16 v[52:55], v[36:39], a[188:191], v[52:55]
    ds_read_b64_tr_b16 v[30:31], v9 offset:2048
    s_add_u32 m0, s18, 65536
    v_mfma_f32_16x16x32_bf16 v[52:55], v[32:35], a[172:175], v[52:55]
    v_add_u32 v220, 368768, v5
    s_waitcnt lgkmcnt(4)
    v_mfma_f32_16x16x32_bf16 v[68:71], v[16:19], a[172:175], v[68:71]
    ds_read_b64_tr_b16 v[32:33], v10 offset:8192
    v_mfma_f32_16x16x32_bf16 v[68:71], v[20:23], a[188:191], v[68:71]
    global_load_lds_dwordx4 v220, s[76:77]
    v_mfma_f32_16x16x32_bf16 v[64:67], v[20:23], a[184:187], v[64:67]
    ds_read_b64_tr_b16 v[34:35], v10 offset:8704
    s_add_u32 m0, s18, 69632
    v_mfma_f32_16x16x32_bf16 v[64:67], v[16:19], a[168:171], v[64:67]
    v_add_u32 v220, 1032320, v5
    v_mfma_f32_16x16x32_bf16 v[60:63], v[16:19], a[164:167], v[60:63]
    ds_read_b64_tr_b16 v[36:37], v10 offset:9216
    v_mfma_f32_16x16x32_bf16 v[60:63], v[20:23], a[180:183], v[60:63]
    v_mfma_f32_16x16x32_bf16 v[56:59], v[20:23], a[176:179], v[56:59]
    ds_read_b64_tr_b16 v[38:39], v10 offset:9728
    v_mfma_f32_16x16x32_bf16 v[56:59], v[16:19], a[160:163], v[56:59]
    global_load_lds_dwordx4 v220, s[76:77]
    s_waitcnt lgkmcnt(4)
    v_mfma_f32_16x16x32_bf16 v[104:107], v[24:27], a[160:163], v[104:107]
    s_waitcnt vmcnt(22)
    s_barrier
    ds_read_b64_tr_b16 v[16:17], v6 offset:16384
    v_mfma_f32_16x16x32_bf16 v[104:107], v[28:31], a[176:179], v[104:107]
    s_add_u32 m0, s18, 73728
    v_add_u32 v220, 516224, v5
    v_mfma_f32_16x16x32_bf16 v[108:111], v[28:31], a[180:183], v[108:111]
    ds_read_b64_tr_b16 v[18:19], v6 offset:18432
    v_mfma_f32_16x16x32_bf16 v[108:111], v[24:27], a[164:167], v[108:111]
    global_load_lds_dwordx4 v220, s[76:77]
    v_mfma_f32_16x16x32_bf16 v[112:115], v[24:27], a[168:171], v[112:115]
    ds_read_b64_tr_b16 v[20:21], v6 offset:24576
    s_add_u32 m0, s18, 77824
    v_mfma_f32_16x16x32_bf16 v[112:115], v[28:31], a[184:187], v[112:115]
    v_add_u32 v220, 1179776, v5
    v_mfma_f32_16x16x32_bf16 v[116:119], v[28:31], a[188:191], v[116:119]
    ds_read_b64_tr_b16 v[22:23], v6 offset:26624
    v_mfma_f32_16x16x32_bf16 v[116:119], v[24:27], a[172:175], v[116:119]
    s_waitcnt lgkmcnt(4)
    v_mfma_f32_16x16x32_bf16 v[148:151], v[32:35], a[172:175], v[148:151]
    ds_read_b64_tr_b16 v[24:25], v6 offset:32768
    v_mfma_f32_16x16x32_bf16 v[148:151], v[36:39], a[188:191], v[148:151]
    global_load_lds_dwordx4 v220, s[76:77]
    v_mfma_f32_16x16x32_bf16 v[144:147], v[36:39], a[184:187], v[144:147]
    ds_read_b64_tr_b16 v[26:27], v6 offset:34816
    s_add_u32 m0, s18, 81920
    v_mfma_f32_16x16x32_bf16 v[144:147], v[32:35], a[168:171], v[144:147]
    v_add_u32 v220, 110720, v5
    v_mfma_f32_16x16x32_bf16 v[140:143], v[32:35], a[164:167], v[140:143]
    ds_read_b64_tr_b16 v[28:29], v6 offset:40960
    v_mfma_f32_16x16x32_bf16 v[140:143], v[36:39], a[180:183], v[140:143]
    global_load_lds_dwordx4 v220, s[76:77]
    v_mfma_f32_16x16x32_bf16 v[136:139], v[36:39], a[176:179], v[136:139]
    ds_read_b64_tr_b16 v[30:31], v6 offset:43008
    s_add_u32 m0, s18, 86016
    v_mfma_f32_16x16x32_bf16 v[136:139], v[32:35], a[160:163], v[136:139]
    v_add_u32 v220, 774272, v5
    s_waitcnt vmcnt(21) lgkmcnt(4)
    v_mfma_f32_16x16x32_bf16 v[184:187], v[16:19], a[192:195], v[184:187]
    ds_read_b64_tr_b16 v[32:33], v6 offset:49152
    v_mfma_f32_16x16x32_bf16 v[184:187], v[20:23], a[208:211], v[184:187]
    v_mfma_f32_16x16x32_bf16 v[188:191], v[20:23], a[212:215], v[188:191]
    ds_read_b64_tr_b16 v[34:35], v6 offset:51200
    v_mfma_f32_16x16x32_bf16 v[188:191], v[16:19], a[196:199], v[188:191]
    global_load_lds_dwordx4 v220, s[76:77]
    v_mfma_f32_16x16x32_bf16 v[192:195], v[16:19], a[200:203], v[192:195]
    ds_read_b64_tr_b16 v[36:37], v6 offset:57344
    s_add_u32 m0, s18, 90112
    v_mfma_f32_16x16x32_bf16 v[192:195], v[20:23], a[216:219], v[192:195]
    v_add_u32 v220, 258176, v5
    v_mfma_f32_16x16x32_bf16 v[196:199], v[20:23], a[220:223], v[196:199]
    ds_read_b64_tr_b16 v[38:39], v6 offset:59392
    v_mfma_f32_16x16x32_bf16 v[196:199], v[16:19], a[204:207], v[196:199]
    global_load_lds_dwordx4 v220, s[76:77]
    s_waitcnt vmcnt(15) lgkmcnt(4)
    v_mfma_f32_16x16x32_bf16 v[196:199], v[24:27], a[236:239], v[196:199]
    ds_read_b64_tr_b16 v[16:17], v7 offset:16384
    s_add_u32 m0, s18, 94208
    v_mfma_f32_16x16x32_bf16 v[196:199], v[28:31], a[252:255], v[196:199]
    v_add_u32 v220, 921728, v5
    v_mfma_f32_16x16x32_bf16 v[192:195], v[28:31], a[248:251], v[192:195]
    ds_read_b64_tr_b16 v[18:19], v7 offset:18432
    v_mfma_f32_16x16x32_bf16 v[192:195], v[24:27], a[232:235], v[192:195]
    v_mfma_f32_16x16x32_bf16 v[188:191], v[24:27], a[228:231], v[188:191]
    ds_read_b64_tr_b16 v[20:21], v7 offset:24576
    v_mfma_f32_16x16x32_bf16 v[188:191], v[28:31], a[244:247], v[188:191]
    global_load_lds_dwordx4 v220, s[76:77]
    v_mfma_f32_16x16x32_bf16 v[184:187], v[28:31], a[240:243], v[184:187]
    ds_read_b64_tr_b16 v[22:23], v7 offset:26624
    s_add_u32 m0, s18, 98304
    v_mfma_f32_16x16x32_bf16 v[184:187], v[24:27], a[224:227], v[184:187]
    v_add_u32 v220, 405632, v5
    s_waitcnt vmcnt(8) lgkmcnt(4)
    v_mfma_f32_16x16x32_bf16 v[184:187], v[32:35], v[224:227], v[184:187]
    ds_read_b64_tr_b16 v[24:25], v7 offset:32768
    v_mfma_f32_16x16x32_bf16 v[184:187], v[36:39], v[240:243], v[184:187]
    global_load_lds_dwordx4 v220, s[76:77]
    v_mfma_f32_16x16x32_bf16 v[188:191], v[36:39], v[244:247], v[188:191]
    ds_read_b64_tr_b16 v[26:27], v7 offset:34816
    s_add_u32 m0, s18, 102400
    v_mfma_f32_16x16x32_bf16 v[188:191], v[32:35], v[228:231], v[188:191]
    v_add_u32 v220, 1069184, v5
    v_mfma_f32_16x16x32_bf16 v[192:195], v[32:35], v[232:235], v[192:195]
    ds_read_b64_tr_b16 v[28:29], v7 offset:40960
    v_mfma_f32_16x16x32_bf16 v[192:195], v[36:39], v[248:251], v[192:195]
    v_mfma_f32_16x16x32_bf16 v[196:199], v[36:39], v[252:255], v[196:199]
    ds_read_b64_tr_b16 v[30:31], v7 offset:43008
    v_mfma_f32_16x16x32_bf16 v[196:199], v[32:35], v[236:239], v[196:199]
    global_load_lds_dwordx4 v220, s[76:77]
    s_waitcnt lgkmcnt(4)
    v_mfma_f32_16x16x32_bf16 v[212:215], v[16:19], a[204:207], v[212:215]
    ds_read_b64_tr_b16 v[32:33], v7 offset:49152
    s_add_u32 m0, s18, 106496
    v_mfma_f32_16x16x32_bf16 v[212:215], v[20:23], a[220:223], v[212:215]
    v_add_u32 v220, 553088, v5
    v_mfma_f32_16x16x32_bf16 v[208:211], v[20:23], a[216:219], v[208:211]
    ds_read_b64_tr_b16 v[34:35], v7 offset:51200
    v_mfma_f32_16x16x32_bf16 v[208:211], v[16:19], a[200:203], v[208:211]
    global_load_lds_dwordx4 v220, s[76:77]
    v_mfma_f32_16x16x32_bf16 v[204:207], v[16:19], a[196:199], v[204:207]
    ds_read_b64_tr_b16 v[36:37], v7 offset:57344
    s_add_u32 m0, s18, 110592
    v_mfma_f32_16x16x32_bf16 v[204:207], v[20:23], a[212:215], v[204:207]
    v_add_u32 v220, 1216640, v5
    v_mfma_f32_16x16x32_bf16 v[200:203], v[20:23], a[208:211], v[200:203]
    ds_read_b64_tr_b16 v[38:39], v7 offset:59392
    v_mfma_f32_16x16x32_bf16 v[200:203], v[16:19], a[192:195], v[200:203]
    s_waitcnt lgkmcnt(4)
    v_mfma_f32_16x16x32_bf16 v[200:203], v[24:27], a[224:227], v[200:203]
    ds_read_b64_tr_b16 v[16:17], v8 offset:16384
    v_cvt_pk_bf16_f32 v192, v192, v193
    v_mfma_f32_16x16x32_bf16 v[200:203], v[28:31], a[240:243], v[200:203]
    global_load_lds_dwordx4 v220, s[76:77]
    v_cvt_pk_bf16_f32 v193, v194, v195
    v_mfma_f32_16x16x32_bf16 v[204:207], v[28:31], a[244:247], v[204:207]
    ds_read_b64_tr_b16 v[18:19], v8 offset:18432
    s_add_u32 m0, s18, 114688
    v_mfma_f32_16x16x32_bf16 v[204:207], v[24:27], a[228:231], v[204:207]
    v_add_u32 v220, 3072, v1
    v_mfma_f32_16x16x32_bf16 v[208:211], v[24:27], a[232:235], v[208:211]
    ds_read_b64_tr_b16 v[20:21], v8 offset:24576
    ds_write_b64 v216, v[192:193] offset:0
    v_mfma_f32_16x16x32_bf16 v[208:211], v[28:31], a[248:251], v[208:211]
    global_load_lds_dwordx4 v220, s[86:87] sc1
    v_cvt_pk_bf16_f32 v196, v196, v197
    v_mfma_f32_16x16x32_bf16 v[212:215], v[28:31], a[252:255], v[212:215]
    ds_read_b64_tr_b16 v[22:23], v8 offset:26624
    s_add_u32 m0, s18, 118784
    v_mfma_f32_16x16x32_bf16 v[212:215], v[24:27], a[236:239], v[212:215]
    v_add_u32 v220, 224256, v1
    s_waitcnt lgkmcnt(5)
    v_mfma_f32_16x16x32_bf16 v[212:215], v[32:35], v[236:239], v[212:215]
    ds_read_b64_tr_b16 v[24:25], v8 offset:32768
    v_cvt_pk_bf16_f32 v197, v198, v199
    v_mfma_f32_16x16x32_bf16 v[212:215], v[36:39], v[252:255], v[212:215]
    v_mfma_f32_16x16x32_bf16 v[208:211], v[36:39], v[248:251], v[208:211]
    ds_read_b64_tr_b16 v[26:27], v8 offset:34816
    ds_write_b64 v216, v[196:197] offset:1024
    v_mfma_f32_16x16x32_bf16 v[208:211], v[32:35], v[232:235], v[208:211]
    global_load_lds_dwordx4 v220, s[86:87] sc1
    v_mfma_f32_16x16x32_bf16 v[204:207], v[32:35], v[228:231], v[204:207]
    ds_read_b64_tr_b16 v[28:29], v8 offset:40960
    v_mfma_f32_16x16x32_bf16 v[204:207], v[36:39], v[244:247], v[204:207]
    v_mfma_f32_16x16x32_bf16 v[200:203], v[36:39], v[240:243], v[200:203]
    ds_read_b64_tr_b16 v[30:31], v8 offset:43008
    v_mfma_f32_16x16x32_bf16 v[200:203], v[32:35], v[224:227], v[200:203]
    s_waitcnt lgkmcnt(5)
    v_mfma_f32_16x16x32_bf16 v[168:171], v[16:19], a[192:195], v[168:171]
    ds_read_b64_tr_b16 v[32:33], v8 offset:49152
    v_mfma_f32_16x16x32_bf16 v[168:171], v[20:23], a[208:211], v[168:171]
    v_mfma_f32_16x16x32_bf16 v[172:175], v[20:23], a[212:215], v[172:175]
    ds_read_b64_tr_b16 v[34:35], v8 offset:51200
    v_mfma_f32_16x16x32_bf16 v[172:175], v[16:19], a[196:199], v[172:175]
    v_mfma_f32_16x16x32_bf16 v[176:179], v[16:19], a[200:203], v[176:179]
    ds_read_b64_tr_b16 v[36:37], v8 offset:57344
    v_mfma_f32_16x16x32_bf16 v[176:179], v[20:23], a[216:219], v[176:179]
    v_mfma_f32_16x16x32_bf16 v[180:183], v[20:23], a[220:223], v[180:183]
    ds_read_b64_tr_b16 v[38:39], v8 offset:59392
    v_mfma_f32_16x16x32_bf16 v[180:183], v[16:19], a[204:207], v[180:183]
    s_waitcnt lgkmcnt(4)
    v_mfma_f32_16x16x32_bf16 v[180:183], v[24:27], a[236:239], v[180:183]
    ds_read_b64_tr_b16 v[16:17], v9 offset:16384
    v_cvt_pk_bf16_f32 v194, v208, v209
    v_mfma_f32_16x16x32_bf16 v[180:183], v[28:31], a[252:255], v[180:183]
    v_cvt_pk_bf16_f32 v195, v210, v211
    v_mfma_f32_16x16x32_bf16 v[176:179], v[28:31], a[248:251], v[176:179]
    ds_read_b64_tr_b16 v[18:19], v9 offset:18432
    ds_write_b64 v216, v[194:195] offset:8
    v_mfma_f32_16x16x32_bf16 v[176:179], v[24:27], a[232:235], v[176:179]
    v_cvt_pk_bf16_f32 v198, v212, v213
    v_cvt_pk_bf16_f32 v199, v214, v215
    v_mfma_f32_16x16x32_bf16 v[172:175], v[24:27], a[228:231], v[172:175]
    ds_read_b64_tr_b16 v[20:21], v9 offset:24576
    ds_write_b64 v216, v[198:199] offset:1032
    v_mfma_f32_16x16x32_bf16 v[172:175], v[28:31], a[244:247], v[172:175]
    v_mfma_f32_16x16x32_bf16 v[168:171], v[28:31], a[240:243], v[168:171]
    ds_read_b64_tr_b16 v[22:23], v9 offset:26624
    v_mfma_f32_16x16x32_bf16 v[168:171], v[24:27], a[224:227], v[168:171]
    s_waitcnt lgkmcnt(6)
    v_mfma_f32_16x16x32_bf16 v[168:171], v[32:35], v[224:227], v[168:171]
    ds_read_b64_tr_b16 v[24:25], v9 offset:32768
    v_mfma_f32_16x16x32_bf16 v[168:171], v[36:39], v[240:243], v[168:171]
    v_mfma_f32_16x16x32_bf16 v[172:175], v[36:39], v[244:247], v[172:175]
    ds_read_b64_tr_b16 v[26:27], v9 offset:34816
    v_mfma_f32_16x16x32_bf16 v[172:175], v[32:35], v[228:231], v[172:175]
    v_mfma_f32_16x16x32_bf16 v[176:179], v[32:35], v[232:235], v[176:179]
    ds_read_b64_tr_b16 v[28:29], v9 offset:40960
    v_mfma_f32_16x16x32_bf16 v[176:179], v[36:39], v[248:251], v[176:179]
    v_mfma_f32_16x16x32_bf16 v[180:183], v[36:39], v[252:255], v[180:183]
    ds_read_b64_tr_b16 v[30:31], v9 offset:43008
    v_mfma_f32_16x16x32_bf16 v[180:183], v[32:35], v[236:239], v[180:183]
    s_waitcnt lgkmcnt(4)
    v_mfma_f32_16x16x32_bf16 v[84:87], v[16:19], a[204:207], v[84:87]
    ds_read_b64_tr_b16 v[32:33], v9 offset:49152
    s_barrier
    v_mfma_f32_16x16x32_bf16 v[84:87], v[20:23], a[220:223], v[84:87]
    ds_read_b128 v[192:195], v222 offset:0
    ds_read_b128 v[196:199], v222 offset:1024
    v_mfma_f32_16x16x32_bf16 v[80:83], v[20:23], a[216:219], v[80:83]
    ds_read_b64_tr_b16 v[34:35], v9 offset:51200
    v_mfma_f32_16x16x32_bf16 v[80:83], v[16:19], a[200:203], v[80:83]
    v_mfma_f32_16x16x32_bf16 v[76:79], v[16:19], a[196:199], v[76:79]
    ds_read_b64_tr_b16 v[36:37], v9 offset:57344
    v_mfma_f32_16x16x32_bf16 v[76:79], v[20:23], a[212:215], v[76:79]
    v_mfma_f32_16x16x32_bf16 v[72:75], v[20:23], a[208:211], v[72:75]
    ds_read_b64_tr_b16 v[38:39], v9 offset:59392
    v_mfma_f32_16x16x32_bf16 v[72:75], v[16:19], a[192:195], v[72:75]
    s_waitcnt lgkmcnt(6)
    v_mfma_f32_16x16x32_bf16 v[72:75], v[24:27], a[224:227], v[72:75]
    s_waitcnt vmcnt(2)
    s_barrier
    ds_read_b64_tr_b16 v[16:17], v11 offset:0
    v_mfma_f32_16x16x32_bf16 v[72:75], v[28:31], a[240:243], v[72:75]
    v_cvt_pk_bf16_f32 v176, v176, v177
    v_cvt_pk_bf16_f32 v177, v178, v179
    v_mfma_f32_16x16x32_bf16 v[76:79], v[28:31], a[244:247], v[76:79]
    ds_read_b64_tr_b16 v[18:19], v11 offset:2048
    ds_write_b64 v216, v[176:177] offset:8192
    v_mfma_f32_16x16x32_bf16 v[76:79], v[24:27], a[228:231], v[76:79]
    v_cvt_pk_bf16_f32 v180, v180, v181
    v_cvt_pk_bf16_f32 v181, v182, v183
    v_mfma_f32_16x16x32_bf16 v[80:83], v[24:27], a[232:235], v[80:83]
    ds_read_b64_tr_b16 v[20:21], v11 offset:8192
    ds_write_b64 v216, v[180:181] offset:9216
    v_mfma_f32_16x16x32_bf16 v[80:83], v[28:31], a[248:251], v[80:83]
    s_waitcnt lgkmcnt(8)
    v_lshlrev_b32 v208, 16, v192
    v_mfma_f32_16x16x32_bf16 v[84:87], v[28:31], a[252:255], v[84:87]
    ds_read_b64_tr_b16 v[22:23], v11 offset:10240
    v_and_b32 v192, 0xffff0000, v192
    v_mfma_f32_16x16x32_bf16 v[84:87], v[24:27], a[236:239], v[84:87]
    v_add_f32 v184, v184, v208
    s_waitcnt lgkmcnt(6)
    v_mfma_f32_16x16x32_bf16 v[84:87], v[32:35], v[236:239], v[84:87]
    ds_read_b64_tr_b16 v[24:25], v11 offset:16384
    v_add_f32 v185, v185, v192
    v_mfma_f32_16x16x32_bf16 v[84:87], v[36:39], v[252:255], v[84:87]
    v_cvt_pk_bf16_f32 v184, v184, v185
PAD_10:
    s_cbranch_execz PAD_END
    v_lshlrev_b32 v209, 16, v193
    v_mfma_f32_16x16x32_bf16 v[80:83], v[36:39], v[248:251], v[80:83]
    ds_read_b64_tr_b16 v[26:27], v11 offset:18432
    v_and_b32 v193, 0xffff0000, v193
    v_mfma_f32_16x16x32_bf16 v[80:83], v[32:35], v[232:235], v[80:83]
    v_add_f32 v186, v186, v209
    v_add_f32 v187, v187, v193
    v_mfma_f32_16x16x32_bf16 v[76:79], v[32:35], v[228:231], v[76:79]
    ds_read_b64_tr_b16 v[28:29], v11 offset:24576
    v_cvt_pk_bf16_f32 v185, v186, v187
    v_mfma_f32_16x16x32_bf16 v[76:79], v[36:39], v[244:247], v[76:79]
    v_lshlrev_b32 v208, 16, v194
    v_and_b32 v194, 0xffff0000, v194
    v_mfma_f32_16x16x32_bf16 v[72:75], v[36:39], v[240:243], v[72:75]
    ds_read_b64_tr_b16 v[30:31], v11 offset:26624
    v_add_f32 v200, v200, v208
    v_mfma_f32_16x16x32_bf16 v[72:75], v[32:35], v[224:227], v[72:75]
    v_add_f32 v201, v201, v194
    s_waitcnt lgkmcnt(4)
    v_mfma_f32_16x16x32_bf16 v[88:91], v[16:19], a[192:195], v[88:91]
    ds_read_b64_tr_b16 v[32:33], v11 offset:32768
    v_cvt_pk_bf16_f32 v186, v200, v201
    v_mfma_f32_16x16x32_bf16 v[88:91], v[20:23], a[208:211], v[88:91]
    v_lshlrev_b32 v209, 16, v195
    v_and_b32 v195, 0xffff0000, v195
    v_mfma_f32_16x16x32_bf16 v[92:95], v[20:23], a[212:215], v[92:95]
    ds_read_b64_tr_b16 v[34:35], v11 offset:34816
    v_add_f32 v202, v202, v209
    v_mfma_f32_16x16x32_bf16 v[92:95], v[16:19], a[196:199], v[92:95]
    v_add_f32 v203, v203, v195
    v_cvt_pk_bf16_f32 v187, v202, v203
    v_mfma_f32_16x16x32_bf16 v[96:99], v[16:19], a[200:203], v[96:99]
    ds_read_b64_tr_b16 v[36:37], v11 offset:40960
    v_lshlrev_b32 v212, 16, v196
    v_mfma_f32_16x16x32_bf16 v[96:99], v[20:23], a[216:219], v[96:99]
    s_add_u32 s21, s22, 0
    v_and_b32 v196, 0xffff0000, v196
    v_mfma_f32_16x16x32_bf16 v[100:103], v[20:23], a[220:223], v[100:103]
    ds_read_b64_tr_b16 v[38:39], v11 offset:43008
    v_add_f32 v188, v188, v212
    v_mfma_f32_16x16x32_bf16 v[100:103], v[16:19], a[204:207], v[100:103]
    buffer_store_dwordx4 v[184:187], v1, s[8:11], s21 offen offset:0 sc1
    s_waitcnt lgkmcnt(4)
    v_mfma_f32_16x16x32_bf16 v[100:103], v[24:27], a[236:239], v[100:103]
    ds_read_b64_tr_b16 v[16:17], v12 offset:0
    v_add_f32 v189, v189, v196
    v_mfma_f32_16x16x32_bf16 v[100:103], v[28:31], a[252:255], v[100:103]
    v_cvt_pk_bf16_f32 v188, v188, v189
    v_lshlrev_b32 v213, 16, v197
    v_mfma_f32_16x16x32_bf16 v[96:99], v[28:31], a[248:251], v[96:99]
    ds_read_b64_tr_b16 v[18:19], v12 offset:2048
    v_and_b32 v197, 0xffff0000, v197
    v_mfma_f32_16x16x32_bf16 v[96:99], v[24:27], a[232:235], v[96:99]
    v_add_f32 v190, v190, v213
    v_add_f32 v191, v191, v197
    v_mfma_f32_16x16x32_bf16 v[92:95], v[24:27], a[228:231], v[92:95]
    ds_read_b64_tr_b16 v[20:21], v12 offset:8192
    v_cvt_pk_bf16_f32 v189, v190, v191
    v_mfma_f32_16x16x32_bf16 v[92:95], v[28:31], a[244:247], v[92:95]
    v_lshlrev_b32 v212, 16, v198
    v_and_b32 v198, 0xffff0000, v198
    v_mfma_f32_16x16x32_bf16 v[88:91], v[28:31], a[240:243], v[88:91]
    ds_read_b64_tr_b16 v[22:23], v12 offset:10240
    v_add_f32 v204, v204, v212
    v_mfma_f32_16x16x32_bf16 v[88:91], v[24:27], a[224:227], v[88:91]
    v_add_f32 v205, v205, v198
    s_waitcnt lgkmcnt(4)
    v_mfma_f32_16x16x32_bf16 v[88:91], v[32:35], v[224:227], v[88:91]
    ds_read_b64_tr_b16 v[24:25], v12 offset:16384
    v_cvt_pk_bf16_f32 v190, v204, v205
    v_mfma_f32_16x16x32_bf16 v[88:91], v[36:39], v[240:243], v[88:91]
    v_lshlrev_b32 v213, 16, v199
    v_and_b32 v199, 0xffff0000, v199
    v_mfma_f32_16x16x32_bf16 v[92:95], v[36:39], v[244:247], v[92:95]
    ds_read_b64_tr_b16 v[26:27], v12 offset:18432
    v_add_f32 v206, v206, v213
    v_mfma_f32_16x16x32_bf16 v[92:95], v[32:35], v[228:231], v[92:95]
    v_add_f32 v207, v207, v199
    v_cvt_pk_bf16_f32 v191, v206, v207
    v_mfma_f32_16x16x32_bf16 v[96:99], v[32:35], v[232:235], v[96:99]
    ds_read_b64_tr_b16 v[28:29], v12 offset:24576
    v_cvt_pk_bf16_f32 v178, v80, v81
    v_mfma_f32_16x16x32_bf16 v[96:99], v[36:39], v[248:251], v[96:99]
    buffer_store_dwordx4 v[188:191], v1, s[8:11], s21 offen offset:1024 sc1
    v_cvt_pk_bf16_f32 v179, v82, v83
    v_mfma_f32_16x16x32_bf16 v[100:103], v[36:39], v[252:255], v[100:103]
    ds_read_b64_tr_b16 v[30:31], v12 offset:26624
    ds_write_b64 v216, v[178:179] offset:8200
    v_mfma_f32_16x16x32_bf16 v[100:103], v[32:35], v[236:239], v[100:103]
    v_cvt_pk_bf16_f32 v182, v84, v85
    s_waitcnt lgkmcnt(5)
    v_mfma_f32_16x16x32_bf16 v[52:55], v[16:19], a[204:207], v[52:55]
    ds_read_b64_tr_b16 v[32:33], v12 offset:32768
    v_cvt_pk_bf16_f32 v183, v86, v87
    v_mfma_f32_16x16x32_bf16 v[52:55], v[20:23], a[220:223], v[52:55]
    v_mfma_f32_16x16x32_bf16 v[48:51], v[20:23], a[216:219], v[48:51]
    ds_read_b64_tr_b16 v[34:35], v12 offset:34816
    ds_write_b64 v216, v[182:183] offset:9224
    v_mfma_f32_16x16x32_bf16 v[48:51], v[16:19], a[200:203], v[48:51]
    s_waitcnt lgkmcnt(0)
    s_barrier
    v_mfma_f32_16x16x32_bf16 v[44:47], v[16:19], a[196:199], v[44:47]
    ds_read_b64_tr_b16 v[36:37], v12 offset:40960
    ds_read_b128 v[176:179], v222 offset:8192
    v_mfma_f32_16x16x32_bf16 v[44:47], v[20:23], a[212:215], v[44:47]
    ds_read_b128 v[180:183], v222 offset:9216
    v_mfma_f32_16x16x32_bf16 v[40:43], v[20:23], a[208:211], v[40:43]
    ds_read_b64_tr_b16 v[38:39], v12 offset:43008
    v_mfma_f32_16x16x32_bf16 v[40:43], v[16:19], a[192:195], v[40:43]
    v_mfma_f32_16x16x32_bf16 v[40:43], v[24:27], a[224:227], v[40:43]
    ds_read_b64_tr_b16 v[16:17], v13 offset:0
    v_cvt_pk_bf16_f32 v96, v96, v97
    v_mfma_f32_16x16x32_bf16 v[40:43], v[28:31], a[240:243], v[40:43]
    v_cvt_pk_bf16_f32 v97, v98, v99
    v_mfma_f32_16x16x32_bf16 v[44:47], v[28:31], a[244:247], v[44:47]
    ds_read_b64_tr_b16 v[18:19], v13 offset:2048
    ds_write_b64 v216, v[96:97] offset:0
    v_mfma_f32_16x16x32_bf16 v[44:47], v[24:27], a[228:231], v[44:47]
    v_cvt_pk_bf16_f32 v100, v100, v101
    v_cvt_pk_bf16_f32 v101, v102, v103
    v_mfma_f32_16x16x32_bf16 v[48:51], v[24:27], a[232:235], v[48:51]
    ds_read_b64_tr_b16 v[20:21], v13 offset:8192
    ds_write_b64 v216, v[100:101] offset:1024
    v_mfma_f32_16x16x32_bf16 v[48:51], v[28:31], a[248:251], v[48:51]
    s_waitcnt lgkmcnt(6)
    v_lshlrev_b32 v80, 16, v176
    v_mfma_f32_16x16x32_bf16 v[52:55], v[28:31], a[252:255], v[52:55]
    ds_read_b64_tr_b16 v[22:23], v13 offset:10240
    v_and_b32 v176, 0xffff0000, v176
    v_mfma_f32_16x16x32_bf16 v[52:55], v[24:27], a[236:239], v[52:55]
    v_add_f32 v168, v168, v80
    s_waitcnt lgkmcnt(6)
    v_mfma_f32_16x16x32_bf16 v[52:55], v[32:35], v[236:239], v[52:55]
    ds_read_b64_tr_b16 v[24:25], v13 offset:16384
    v_add_f32 v169, v169, v176
    v_mfma_f32_16x16x32_bf16 v[52:55], v[36:39], v[252:255], v[52:55]
    v_cvt_pk_bf16_f32 v168, v168, v169
    v_lshlrev_b32 v81, 16, v177
    v_mfma_f32_16x16x32_bf16 v[48:51], v[36:39], v[248:251], v[48:51]
    ds_read_b64_tr_b16 v[26:27], v13 offset:18432
    v_and_b32 v177, 0xffff0000, v177
    v_mfma_f32_16x16x32_bf16 v[48:51], v[32:35], v[232:235], v[48:51]
    v_add_f32 v170, v170, v81
    v_add_f32 v171, v171, v177
    v_mfma_f32_16x16x32_bf16 v[44:47], v[32:35], v[228:231], v[44:47]
    ds_read_b64_tr_b16 v[28:29], v13 offset:24576
    v_cvt_pk_bf16_f32 v169, v170, v171
    v_mfma_f32_16x16x32_bf16 v[44:47], v[36:39], v[244:247], v[44:47]
    v_lshlrev_b32 v80, 16, v178
    v_and_b32 v178, 0xffff0000, v178
    v_mfma_f32_16x16x32_bf16 v[40:43], v[36:39], v[240:243], v[40:43]
    ds_read_b64_tr_b16 v[30:31], v13 offset:26624
    v_add_f32 v72, v72, v80
    v_mfma_f32_16x16x32_bf16 v[40:43], v[32:35], v[224:227], v[40:43]
    v_add_f32 v73, v73, v178
    s_waitcnt lgkmcnt(4)
    v_mfma_f32_16x16x32_bf16 v[56:59], v[16:19], a[192:195], v[56:59]
    ds_read_b64_tr_b16 v[32:33], v13 offset:32768
    v_cvt_pk_bf16_f32 v170, v72, v73
    v_mfma_f32_16x16x32_bf16 v[56:59], v[20:23], a[208:211], v[56:59]
    v_lshlrev_b32 v81, 16, v179
    v_and_b32 v179, 0xffff0000, v179
    v_mfma_f32_16x16x32_bf16 v[60:63], v[20:23], a[212:215], v[60:63]
    ds_read_b64_tr_b16 v[34:35], v13 offset:34816
    v_add_f32 v74, v74, v81
    v_mfma_f32_16x16x32_bf16 v[60:63], v[16:19], a[196:199], v[60:63]
    v_add_f32 v75, v75, v179
    v_cvt_pk_bf16_f32 v171, v74, v75
    v_mfma_f32_16x16x32_bf16 v[64:67], v[16:19], a[200:203], v[64:67]
    ds_read_b64_tr_b16 v[36:37], v13 offset:40960
    v_lshlrev_b32 v84, 16, v180
    v_mfma_f32_16x16x32_bf16 v[64:67], v[20:23], a[216:219], v[64:67]
    s_add_u32 s21, s22, 4096
    v_and_b32 v180, 0xffff0000, v180
    v_mfma_f32_16x16x32_bf16 v[68:71], v[20:23], a[220:223], v[68:71]
    ds_read_b64_tr_b16 v[38:39], v13 offset:43008
    v_add_f32 v172, v172, v84
    v_mfma_f32_16x16x32_bf16 v[68:71], v[16:19], a[204:207], v[68:71]
    buffer_store_dwordx4 v[168:171], v1, s[8:11], s21 offen offset:0 sc1
    s_waitcnt lgkmcnt(4)
    v_mfma_f32_16x16x32_bf16 v[68:71], v[24:27], a[236:239], v[68:71]
    ds_read_b64_tr_b16 v[16:17], v14 offset:0
    v_add_f32 v173, v173, v180
    v_mfma_f32_16x16x32_bf16 v[68:71], v[28:31], a[252:255], v[68:71]
    v_cvt_pk_bf16_f32 v172, v172, v173
    v_lshlrev_b32 v85, 16, v181
    v_mfma_f32_16x16x32_bf16 v[64:67], v[28:31], a[248:251], v[64:67]
    ds_read_b64_tr_b16 v[18:19], v14 offset:2048
    v_and_b32 v181, 0xffff0000, v181
    v_mfma_f32_16x16x32_bf16 v[64:67], v[24:27], a[232:235], v[64:67]
    v_add_f32 v174, v174, v85
    v_add_f32 v175, v175, v181
    v_mfma_f32_16x16x32_bf16 v[60:63], v[24:27], a[228:231], v[60:63]
    ds_read_b64_tr_b16 v[20:21], v14 offset:8192
    v_cvt_pk_bf16_f32 v173, v174, v175
    v_mfma_f32_16x16x32_bf16 v[60:63], v[28:31], a[244:247], v[60:63]
    v_lshlrev_b32 v84, 16, v182
    v_and_b32 v182, 0xffff0000, v182
    v_mfma_f32_16x16x32_bf16 v[56:59], v[28:31], a[240:243], v[56:59]
    ds_read_b64_tr_b16 v[22:23], v14 offset:10240
    v_add_f32 v76, v76, v84
    v_mfma_f32_16x16x32_bf16 v[56:59], v[24:27], a[224:227], v[56:59]
    v_add_f32 v77, v77, v182
    s_waitcnt lgkmcnt(4)
    v_mfma_f32_16x16x32_bf16 v[56:59], v[32:35], v[224:227], v[56:59]
    ds_read_b64_tr_b16 v[24:25], v14 offset:16384
    v_cvt_pk_bf16_f32 v174, v76, v77
    v_mfma_f32_16x16x32_bf16 v[56:59], v[36:39], v[240:243], v[56:59]
    v_lshlrev_b32 v85, 16, v183
    v_and_b32 v183, 0xffff0000, v183
    v_mfma_f32_16x16x32_bf16 v[60:63], v[36:39], v[244:247], v[60:63]
    ds_read_b64_tr_b16 v[26:27], v14 offset:18432
    v_add_f32 v78, v78, v85
    v_mfma_f32_16x16x32_bf16 v[60:63], v[32:35], v[228:231], v[60:63]
    v_add_f32 v79, v79, v183
    v_cvt_pk_bf16_f32 v175, v78, v79
    v_mfma_f32_16x16x32_bf16 v[64:67], v[32:35], v[232:235], v[64:67]
    ds_read_b64_tr_b16 v[28:29], v14 offset:24576
    v_cvt_pk_bf16_f32 v98, v48, v49
    v_mfma_f32_16x16x32_bf16 v[64:67], v[36:39], v[248:251], v[64:67]
    buffer_store_dwordx4 v[172:175], v1, s[8:11], s21 offen offset:1024 sc1
    v_cvt_pk_bf16_f32 v99, v50, v51
    v_mfma_f32_16x16x32_bf16 v[68:71], v[36:39], v[252:255], v[68:71]
    ds_read_b64_tr_b16 v[30:31], v14 offset:26624
    ds_write_b64 v216, v[98:99] offset:8
    v_mfma_f32_16x16x32_bf16 v[68:71], v[32:35], v[236:239], v[68:71]
    v_cvt_pk_bf16_f32 v102, v52, v53
    s_waitcnt lgkmcnt(5)
    v_mfma_f32_16x16x32_bf16 v[116:119], v[16:19], a[204:207], v[116:119]
    ds_read_b64_tr_b16 v[32:33], v14 offset:32768
    v_cvt_pk_bf16_f32 v103, v54, v55
    v_mfma_f32_16x16x32_bf16 v[116:119], v[20:23], a[220:223], v[116:119]
    v_mfma_f32_16x16x32_bf16 v[112:115], v[20:23], a[216:219], v[112:115]
    ds_read_b64_tr_b16 v[34:35], v14 offset:34816
    ds_write_b64 v216, v[102:103] offset:1032
    v_mfma_f32_16x16x32_bf16 v[112:115], v[16:19], a[200:203], v[112:115]
    s_waitcnt lgkmcnt(0)
    s_barrier
    v_mfma_f32_16x16x32_bf16 v[108:111], v[16:19], a[196:199], v[108:111]
    ds_read_b64_tr_b16 v[36:37], v14 offset:40960
    ds_read_b128 v[96:99], v222 offset:0
    v_mfma_f32_16x16x32_bf16 v[108:111], v[20:23], a[212:215], v[108:111]
    ds_read_b128 v[100:103], v222 offset:1024
    v_mfma_f32_16x16x32_bf16 v[104:107], v[20:23], a[208:211], v[104:107]
    ds_read_b64_tr_b16 v[38:39], v14 offset:43008
    v_mfma_f32_16x16x32_bf16 v[104:107], v[16:19], a[192:195], v[104:107]
    v_mfma_f32_16x16x32_bf16 v[104:107], v[24:27], a[224:227], v[104:107]
    s_waitcnt vmcnt(4)
    s_barrier
    ds_read_b64_tr_b16 v[16:17], v10 offset:10240
    v_mfma_f32_16x16x32_bf16 v[104:107], v[28:31], a[240:243], v[104:107]
    v_cvt_pk_bf16_f32 v64, v64, v65
    v_cvt_pk_bf16_f32 v65, v66, v67
    v_mfma_f32_16x16x32_bf16 v[108:111], v[28:31], a[244:247], v[108:111]
    ds_read_b64_tr_b16 v[18:19], v10 offset:10752
    ds_write_b64 v216, v[64:65] offset:8192
    v_mfma_f32_16x16x32_bf16 v[108:111], v[24:27], a[228:231], v[108:111]
    v_cvt_pk_bf16_f32 v68, v68, v69
    v_cvt_pk_bf16_f32 v69, v70, v71
    v_mfma_f32_16x16x32_bf16 v[112:115], v[24:27], a[232:235], v[112:115]
    ds_read_b64_tr_b16 v[20:21], v10 offset:11264
    ds_write_b64 v216, v[68:69] offset:9216
    v_mfma_f32_16x16x32_bf16 v[112:115], v[28:31], a[248:251], v[112:115]
    s_waitcnt lgkmcnt(6)
    v_lshlrev_b32 v48, 16, v96
    v_mfma_f32_16x16x32_bf16 v[116:119], v[28:31], a[252:255], v[116:119]
    ds_read_b64_tr_b16 v[22:23], v10 offset:11776
    v_and_b32 v96, 0xffff0000, v96
    v_mfma_f32_16x16x32_bf16 v[116:119], v[24:27], a[236:239], v[116:119]
    v_add_f32 v88, v88, v48
    s_waitcnt lgkmcnt(6)
    v_mfma_f32_16x16x32_bf16 v[116:119], v[32:35], v[236:239], v[116:119]
    ds_read_b64_tr_b16 v[24:25], v15 offset:49152
    v_add_f32 v89, v89, v96
    v_mfma_f32_16x16x32_bf16 v[116:119], v[36:39], v[252:255], v[116:119]
    v_cvt_pk_bf16_f32 v88, v88, v89
    v_lshlrev_b32 v49, 16, v97
    v_mfma_f32_16x16x32_bf16 v[112:115], v[36:39], v[248:251], v[112:115]
    ds_read_b64_tr_b16 v[26:27], v15 offset:49664
    v_and_b32 v97, 0xffff0000, v97
    v_mfma_f32_16x16x32_bf16 v[112:115], v[32:35], v[232:235], v[112:115]
    v_add_f32 v90, v90, v49
    v_add_f32 v91, v91, v97
    v_mfma_f32_16x16x32_bf16 v[108:111], v[32:35], v[228:231], v[108:111]
    ds_read_b64_tr_b16 v[28:29], v15 offset:50176
    v_cvt_pk_bf16_f32 v89, v90, v91
    v_mfma_f32_16x16x32_bf16 v[108:111], v[36:39], v[244:247], v[108:111]
    v_lshlrev_b32 v48, 16, v98
    v_and_b32 v98, 0xffff0000, v98
    v_mfma_f32_16x16x32_bf16 v[104:107], v[36:39], v[240:243], v[104:107]
    ds_read_b64_tr_b16 v[30:31], v15 offset:50688
    v_add_f32 v40, v40, v48
    v_mfma_f32_16x16x32_bf16 v[104:107], v[32:35], v[224:227], v[104:107]
    v_add_f32 v41, v41, v98
    s_waitcnt lgkmcnt(4)
    v_mfma_f32_16x16x32_bf16 v[136:139], v[16:19], a[192:195], v[136:139]
    ds_read_b64_tr_b16 v[32:33], v15 offset:51200
    v_cvt_pk_bf16_f32 v90, v40, v41
    v_mfma_f32_16x16x32_bf16 v[136:139], v[20:23], a[208:211], v[136:139]
    v_lshlrev_b32 v49, 16, v99
    v_and_b32 v99, 0xffff0000, v99
    v_mfma_f32_16x16x32_bf16 v[140:143], v[20:23], a[212:215], v[140:143]
    ds_read_b64_tr_b16 v[34:35], v15 offset:51712
    v_add_f32 v42, v42, v49
    v_mfma_f32_16x16x32_bf16 v[140:143], v[16:19], a[196:199], v[140:143]
    v_add_f32 v43, v43, v99
    v_cvt_pk_bf16_f32 v91, v42, v43
    v_mfma_f32_16x16x32_bf16 v[144:147], v[16:19], a[200:203], v[144:147]
    ds_read_b64_tr_b16 v[36:37], v15 offset:52224
    v_lshlrev_b32 v52, 16, v100
    v_mfma_f32_16x16x32_bf16 v[144:147], v[20:23], a[216:219], v[144:147]
    s_add_u32 s21, s22, 8192
    v_and_b32 v100, 0xffff0000, v100
    v_mfma_f32_16x16x32_bf16 v[148:151], v[20:23], a[220:223], v[148:151]
    ds_read_b64_tr_b16 v[38:39], v15 offset:52736
    v_add_f32 v92, v92, v52
    v_mfma_f32_16x16x32_bf16 v[148:151], v[16:19], a[204:207], v[148:151]
    buffer_store_dwordx4 v[88:91], v1, s[8:11], s21 offen offset:0 sc1
    s_waitcnt lgkmcnt(4)
    v_mfma_f32_16x16x32_bf16 v[148:151], v[24:27], a[236:239], v[148:151]
    v_add_f32 v93, v93, v100
    v_cvt_pk_bf16_f32 v92, v92, v93
    v_mfma_f32_16x16x32_bf16 v[148:151], v[28:31], a[252:255], v[148:151]
    v_lshlrev_b32 v53, 16, v101
    v_and_b32 v101, 0xffff0000, v101
    v_mfma_f32_16x16x32_bf16 v[144:147], v[28:31], a[248:251], v[144:147]
    v_add_f32 v94, v94, v53
    v_add_f32 v95, v95, v101
    v_mfma_f32_16x16x32_bf16 v[144:147], v[24:27], a[232:235], v[144:147]
    v_cvt_pk_bf16_f32 v93, v94, v95
    v_lshlrev_b32 v52, 16, v102
    v_mfma_f32_16x16x32_bf16 v[140:143], v[24:27], a[228:231], v[140:143]
    v_and_b32 v102, 0xffff0000, v102
    v_add_f32 v44, v44, v52
    v_mfma_f32_16x16x32_bf16 v[140:143], v[28:31], a[244:247], v[140:143]
    v_add_f32 v45, v45, v102
    v_cvt_pk_bf16_f32 v94, v44, v45
    v_mfma_f32_16x16x32_bf16 v[136:139], v[28:31], a[240:243], v[136:139]
    v_lshlrev_b32 v53, 16, v103
    v_and_b32 v103, 0xffff0000, v103
    v_mfma_f32_16x16x32_bf16 v[136:139], v[24:27], a[224:227], v[136:139]
    v_add_f32 v46, v46, v53
    s_waitcnt lgkmcnt(0)
    v_mfma_f32_16x16x32_bf16 v[136:139], v[32:35], v[224:227], v[136:139]
    v_add_f32 v47, v47, v103
    v_cvt_pk_bf16_f32 v95, v46, v47
    v_mfma_f32_16x16x32_bf16 v[136:139], v[36:39], v[240:243], v[136:139]
    v_cvt_pk_bf16_f32 v66, v112, v113
    v_cvt_pk_bf16_f32 v67, v114, v115
    v_mfma_f32_16x16x32_bf16 v[140:143], v[36:39], v[244:247], v[140:143]
    ds_write_b64 v216, v[66:67] offset:8200
    v_cvt_pk_bf16_f32 v70, v116, v117
    v_mfma_f32_16x16x32_bf16 v[140:143], v[32:35], v[228:231], v[140:143]
    buffer_store_dwordx4 v[92:95], v1, s[8:11], s21 offen offset:1024 sc1
    v_cvt_pk_bf16_f32 v71, v118, v119
    v_mfma_f32_16x16x32_bf16 v[144:147], v[32:35], v[232:235], v[144:147]
    ds_write_b64 v216, v[70:71] offset:9224
    s_waitcnt lgkmcnt(0)
    s_barrier
    v_mfma_f32_16x16x32_bf16 v[144:147], v[36:39], v[248:251], v[144:147]
    ds_read_b128 v[64:67], v222 offset:8192
    ds_read_b128 v[68:71], v222 offset:9216
    v_mfma_f32_16x16x32_bf16 v[148:151], v[36:39], v[252:255], v[148:151]
    s_waitcnt lgkmcnt(0)
    v_lshlrev_b32 v112, 16, v64
    v_mfma_f32_16x16x32_bf16 v[148:151], v[32:35], v[236:239], v[148:151]
    v_and_b32 v64, 0xffff0000, v64
    s_nop 7
    v_add_f32 v56, v56, v112
    v_add_f32 v57, v57, v64
    v_cvt_pk_bf16_f32 v56, v56, v57
    v_lshlrev_b32 v113, 16, v65
    v_and_b32 v65, 0xffff0000, v65
    v_add_f32 v58, v58, v113
    v_add_f32 v59, v59, v65
    v_cvt_pk_bf16_f32 v57, v58, v59
    v_lshlrev_b32 v112, 16, v66
    v_and_b32 v66, 0xffff0000, v66
    v_add_f32 v104, v104, v112
    v_add_f32 v105, v105, v66
    v_cvt_pk_bf16_f32 v58, v104, v105
    v_lshlrev_b32 v113, 16, v67
    v_and_b32 v67, 0xffff0000, v67
    v_add_f32 v106, v106, v113
    v_add_f32 v107, v107, v67
    v_cvt_pk_bf16_f32 v59, v106, v107
    s_add_u32 s21, s22, 12288
    buffer_store_dwordx4 v[56:59], v1, s[8:11], s21 offen offset:0 sc1
    v_lshlrev_b32 v116, 16, v68
    v_and_b32 v68, 0xffff0000, v68
    v_add_f32 v60, v60, v116
    v_add_f32 v61, v61, v68
    v_cvt_pk_bf16_f32 v60, v60, v61
    v_lshlrev_b32 v117, 16, v69
    v_and_b32 v69, 0xffff0000, v69
    v_add_f32 v62, v62, v117
    v_add_f32 v63, v63, v69
    v_cvt_pk_bf16_f32 v61, v62, v63
    v_lshlrev_b32 v116, 16, v70
    v_and_b32 v70, 0xffff0000, v70
    v_add_f32 v108, v108, v116
    v_add_f32 v109, v109, v70
    v_cvt_pk_bf16_f32 v62, v108, v109
    v_lshlrev_b32 v117, 16, v71
    v_and_b32 v71, 0xffff0000, v71
    v_add_f32 v110, v110, v117
    v_add_f32 v111, v111, v71
    v_cvt_pk_bf16_f32 v63, v110, v111
    buffer_store_dwordx4 v[60:63], v1, s[8:11], s21 offen offset:1024 sc1
    v_cvt_pk_bf16_f32 v144, v144, v145
    v_cvt_pk_bf16_f32 v145, v146, v147
    ds_write_b64 v216, v[144:145] offset:0
    v_cvt_pk_bf16_f32 v148, v148, v149
    v_cvt_pk_bf16_f32 v149, v150, v151
    ds_write_b64 v216, v[148:149] offset:1024
    s_waitcnt lgkmcnt(0)
    s_barrier
    ds_read_b64 v[144:145], v222 offset:0
    ds_read_b64 v[148:149], v222 offset:1024
    s_waitcnt lgkmcnt(0)
    v_lshlrev_b32 v146, 16, v144
    v_and_b32 v144, 0xffff0000, v144
    v_add_f32 v136, v136, v146
    v_add_f32 v137, v137, v144
    v_cvt_pk_bf16_f32 v136, v136, v137
    v_lshlrev_b32 v147, 16, v145
    v_and_b32 v145, 0xffff0000, v145
    v_add_f32 v138, v138, v147
    v_add_f32 v139, v139, v145
    v_cvt_pk_bf16_f32 v137, v138, v139
    buffer_store_dwordx2 v[136:137], v218, s[8:11], s43 offen offset:0 sc1
    v_lshlrev_b32 v150, 16, v148
    v_and_b32 v148, 0xffff0000, v148
    v_add_f32 v140, v140, v150
    v_add_f32 v141, v141, v148
    v_cvt_pk_bf16_f32 v140, v140, v141
    v_lshlrev_b32 v151, 16, v149
    v_and_b32 v149, 0xffff0000, v149
    v_add_f32 v142, v142, v151
    v_add_f32 v143, v143, v149
    v_cvt_pk_bf16_f32 v141, v142, v143
    buffer_store_dwordx2 v[140:141], v218, s[8:11], s43 offen offset:1024 sc1
    v_subrev_u32 v6, s93, v6
    v_subrev_u32 v7, s93, v7
    v_subrev_u32 v8, s93, v8
    v_subrev_u32 v9, s93, v9
    v_subrev_u32 v10, s93, v10
    v_subrev_u32 v11, s93, v11
    v_subrev_u32 v12, s93, v12
    v_subrev_u32 v13, s93, v13
    v_subrev_u32 v14, s93, v14
    v_subrev_u32 v15, s93, v15
    s_load_dwordx2 s[52:53], s[0:1], 80
    v_and_b32 v29, 7, v0
    v_lshlrev_b32 v29, 6, v29
    v_add_u32 v29, 131072, v29
    s_lshl_b32 s48, s3, 3
    v_and_b32 v28, 32, v0
    v_bfe_u32 v30, v0, 4, 1
    v_lshl_add_u32 v28, v30, 2, v28
    v_add3_u32 v28, v28, v29, s48
    s_mov_b32 s48, 131072
    v_lshl_add_u32 v30, v0, 4, s48
    v_lshl_add_u32 v31, v0, 2, s48
    ds_read_b128 v[240:243], v30 offset:1024
    ds_read_b128 v[244:247], v30 offset:5120
    ds_read_b32 v248, v31 offset:9216
    v_and_b32 v16, 7, v0
    v_bfe_u32 v17, v0, 3, 2
    v_bfe_u32 v18, v0, 5, 1
    v_lshrrev_b32 v19, 6, v0
    v_lshl_add_u32 v20, v19, 2, v18
    v_lshl_add_u32 v21, v19, 1, v18
    v_lshlrev_b32 v217, 4, v16
    v_lshl_add_u32 v217, v17, 8, v217
    v_lshl_add_u32 v217, v20, 12, v217
    v_bfe_u32 v22, v0, 4, 2
    v_lshl_add_u32 v22, v22, 4, v16
    v_bfe_u32 v23, v0, 3, 1
    v_lshlrev_b32 v23, 2, v23
    v_lshrrev_b32 v24, 1, v19
    v_lshl_add_u32 v23, v24, 12, v23
    v_add_u32 v23, 65536, v23
    v_and_b32 v24, 1, v19
    v_lshl_add_u32 v218, v22, 4, v23
    v_lshl_add_u32 v218, v24, 3, v218
    v_bfe_u32 v22, v0, 4, 2
    v_lshl_add_u32 v22, v22, 3, v16
    v_lshl_add_u32 v219, v22, 3, v23
    v_lshl_add_u32 v219, v24, 9, v219
    v_mul_u32_u24 v22, 1152, v16
    v_lshl_add_u32 v250, v20, 6, v22
    v_lshl_add_u32 v250, v17, 3, v250
    v_lshl_add_u32 v251, v21, 4, v22
    v_lshl_add_u32 v251, v17, 2, v251
    v_lshlrev_b32 v22, 3, v16
    v_lshl_add_u32 v252, v20, 9, v22
    v_lshl_add_u32 v252, v17, 6, v252
    v_lshl_add_u32 v253, v21, 7, v22
    v_lshrrev_b32 v22, 1, v17
    v_lshl_add_u32 v253, v22, 6, v253
    v_and_b32 v22, 1, v17
    v_lshl_add_u32 v253, v22, 2, v253
    v_add_u32 v253, 0x2000, v253
    s_mov_b32 s50, 0x3f80
    s_mov_b32 s51, 0x3f800000
    s_mov_b32 s96, 0
    s_waitcnt vmcnt(0)
    s_barrier
    buffer_store_dword v221, v4, s[8:11], s30 offen sc1
    s_cmp_lg_u32 s7, 0
    s_cbranch_scc1 NP_41
    s_mul_i32 s48, s2, 9216
    s_add_u32 s48, s48, 0x5c00000
    buffer_load_dwordx2 v[72:73], v252, s[8:11], s48 offen sc1
    s_add_u32 s49, s48, 256
    buffer_load_dwordx2 v[74:75], v252, s[8:11], s49 offen sc1
    s_add_u32 s49, s48, 1024
    buffer_load_dwordx2 v[76:77], v252, s[8:11], s49 offen sc1
    s_add_u32 s49, s48, 1280
    buffer_load_dwordx2 v[78:79], v252, s[8:11], s49 offen sc1
    buffer_load_dword v80, v253, s[8:11], s48 offen sc1
NP_41:
    v_and_b32 v16, 63, v0
    v_lshlrev_b32 v16, 8, v16
    s_mov_b64 exec, 0xf
    s_mov_b32 s49, 0x80000
    buffer_load_dword v200, v16, s[8:11], s31 offen sc1
SP_42:
    s_waitcnt vmcnt(0)
    v_cmp_ne_u32 vcc, s6, v200
    s_cbranch_vccz SO_43
    s_mov_b64 exec, vcc
    buffer_load_dword v200, v16, s[8:11], s31 offen sc1
    s_sub_u32 s49, s49, 1
    s_cmp_lg_u32 s49, 0
    s_cbranch_scc1 SP_42
SO_43:
    s_mov_b64 exec, -1
    s_add_u32 s48, s28, 0x4000000
    s_add_u32 s49, s48, 8192
    s_add_u32 s47, s41, 0x4000000
    buffer_load_dwordx4 v[144:147], v217, s[8:11], s48 offen sc1
    buffer_load_dwordx4 v[148:151], v217, s[8:11], s49 offen sc1
    buffer_load_dword v152, v219, s[8:11], s47 offen sc1
    s_add_u32 s48, s28, 0x4240000
    s_add_u32 s49, s48, 8192
    s_add_u32 s47, s41, 0x4240000
    buffer_load_dwordx4 v[156:159], v217, s[8:11], s48 offen sc1
    buffer_load_dwordx4 v[160:163], v217, s[8:11], s49 offen sc1
    buffer_load_dword v164, v219, s[8:11], s47 offen sc1
    s_add_u32 s48, s28, 0x4480000
    s_add_u32 s49, s48, 8192
    s_add_u32 s47, s41, 0x4480000
    buffer_load_dwordx4 v[168:171], v217, s[8:11], s48 offen sc1
    buffer_load_dwordx4 v[172:175], v217, s[8:11], s49 offen sc1
    buffer_load_dword v176, v219, s[8:11], s47 offen sc1
    s_add_u32 s48, s28, 0x46c0000
    s_add_u32 s49, s48, 8192
    s_add_u32 s47, s41, 0x46c0000
    buffer_load_dwordx4 v[180:183], v217, s[8:11], s48 offen sc1
    buffer_load_dwordx4 v[184:187], v217, s[8:11], s49 offen sc1
    buffer_load_dword v188, v219, s[8:11], s47 offen sc1
    s_waitcnt lgkmcnt(0)
    v_lshlrev_b32 v32, 16, v240
    v_and_b32 v33, 0xffff0000, v240
    v_lshlrev_b32 v34, 16, v241
    v_and_b32 v35, 0xffff0000, v241
    v_lshlrev_b32 v36, 16, v242
    v_and_b32 v37, 0xffff0000, v242
    v_lshlrev_b32 v38, 16, v243
    v_and_b32 v39, 0xffff0000, v243
    v_lshlrev_b32 v40, 16, v244
    v_and_b32 v41, 0xffff0000, v244
    v_lshlrev_b32 v42, 16, v245
    v_and_b32 v43, 0xffff0000, v245
    v_lshlrev_b32 v44, 16, v246
    v_and_b32 v45, 0xffff0000, v246
    v_lshlrev_b32 v46, 16, v247
    v_and_b32 v47, 0xffff0000, v247
    v_lshlrev_b32 v48, 16, v248
    v_and_b32 v49, 0xffff0000, v248
    v_lshlrev_b32 v118, 16, v72
    v_and_b32 v119, 0xffff0000, v72
    v_lshlrev_b32 v120, 16, v73
    v_and_b32 v121, 0xffff0000, v73
    v_lshlrev_b32 v122, 16, v74
    v_and_b32 v123, 0xffff0000, v74
    v_lshlrev_b32 v124, 16, v75
    v_and_b32 v125, 0xffff0000, v75
    v_lshlrev_b32 v126, 16, v76
    v_and_b32 v127, 0xffff0000, v76
    v_lshlrev_b32 v128, 16, v77
    v_and_b32 v129, 0xffff0000, v77
    v_lshlrev_b32 v130, 16, v78
    v_and_b32 v131, 0xffff0000, v78
    v_lshlrev_b32 v132, 16, v79
    v_and_b32 v133, 0xffff0000, v79
    v_lshlrev_b32 v134, 16, v80
    v_and_b32 v135, 0xffff0000, v80
    s_waitcnt vmcnt(11)
    v_dot2c_f32_bf16 v32, s50, v144
    v_dot2c_f32_bf16 v33, s51, v144
    v_dot2c_f32_bf16 v34, s50, v145
    v_dot2c_f32_bf16 v35, s51, v145
    v_dot2c_f32_bf16 v36, s50, v146
    v_dot2c_f32_bf16 v37, s51, v146
    v_dot2c_f32_bf16 v38, s50, v147
    v_dot2c_f32_bf16 v39, s51, v147
    s_waitcnt vmcnt(10)
    v_dot2c_f32_bf16 v40, s50, v148
    v_dot2c_f32_bf16 v41, s51, v148
    v_dot2c_f32_bf16 v42, s50, v149
    v_dot2c_f32_bf16 v43, s51, v149
    v_dot2c_f32_bf16 v44, s50, v150
    v_dot2c_f32_bf16 v45, s51, v150
    v_dot2c_f32_bf16 v46, s50, v151
    v_dot2c_f32_bf16 v47, s51, v151
    s_waitcnt vmcnt(9)
    v_dot2c_f32_bf16 v48, s50, v152
    v_dot2c_f32_bf16 v49, s51, v152
    s_waitcnt vmcnt(8)
PAD_11:
    s_cbranch_execz PAD_END
    v_dot2c_f32_bf16 v32, s50, v156
    v_dot2c_f32_bf16 v33, s51, v156
    v_dot2c_f32_bf16 v34, s50, v157
    v_dot2c_f32_bf16 v35, s51, v157
    v_dot2c_f32_bf16 v36, s50, v158
    v_dot2c_f32_bf16 v37, s51, v158
    v_dot2c_f32_bf16 v38, s50, v159
    v_dot2c_f32_bf16 v39, s51, v159
    s_waitcnt vmcnt(7)
    v_dot2c_f32_bf16 v40, s50, v160
    v_dot2c_f32_bf16 v41, s51, v160
    v_dot2c_f32_bf16 v42, s50, v161
    v_dot2c_f32_bf16 v43, s51, v161
    v_dot2c_f32_bf16 v44, s50, v162
    v_dot2c_f32_bf16 v45, s51, v162
    v_dot2c_f32_bf16 v46, s50, v163
    v_dot2c_f32_bf16 v47, s51, v163
    s_waitcnt vmcnt(6)
    v_dot2c_f32_bf16 v48, s50, v164
    v_dot2c_f32_bf16 v49, s51, v164
    s_waitcnt vmcnt(5)
    v_dot2c_f32_bf16 v32, s50, v168
    v_dot2c_f32_bf16 v33, s51, v168
    v_dot2c_f32_bf16 v34, s50, v169
    v_dot2c_f32_bf16 v35, s51, v169
    v_dot2c_f32_bf16 v36, s50, v170
    v_dot2c_f32_bf16 v37, s51, v170
    v_dot2c_f32_bf16 v38, s50, v171
    v_dot2c_f32_bf16 v39, s51, v171
    s_waitcnt vmcnt(4)
    v_dot2c_f32_bf16 v40, s50, v172
    v_dot2c_f32_bf16 v41, s51, v172
    v_dot2c_f32_bf16 v42, s50, v173
    v_dot2c_f32_bf16 v43, s51, v173
    v_dot2c_f32_bf16 v44, s50, v174
    v_dot2c_f32_bf16 v45, s51, v174
    v_dot2c_f32_bf16 v46, s50, v175
    v_dot2c_f32_bf16 v47, s51, v175
    s_waitcnt vmcnt(3)
    v_dot2c_f32_bf16 v48, s50, v176
    v_dot2c_f32_bf16 v49, s51, v176
    s_waitcnt vmcnt(2)
    v_dot2c_f32_bf16 v32, s50, v180
    v_dot2c_f32_bf16 v33, s51, v180
    v_dot2c_f32_bf16 v34, s50, v181
    v_dot2c_f32_bf16 v35, s51, v181
    v_dot2c_f32_bf16 v36, s50, v182
    v_dot2c_f32_bf16 v37, s51, v182
    v_dot2c_f32_bf16 v38, s50, v183
    v_dot2c_f32_bf16 v39, s51, v183
    s_waitcnt vmcnt(1)
    v_dot2c_f32_bf16 v40, s50, v184
    v_dot2c_f32_bf16 v41, s51, v184
    v_dot2c_f32_bf16 v42, s50, v185
    v_dot2c_f32_bf16 v43, s51, v185
    v_dot2c_f32_bf16 v44, s50, v186
    v_dot2c_f32_bf16 v45, s51, v186
    v_dot2c_f32_bf16 v46, s50, v187
    v_dot2c_f32_bf16 v47, s51, v187
    s_waitcnt vmcnt(0)
    v_dot2c_f32_bf16 v48, s50, v188
    v_dot2c_f32_bf16 v49, s51, v188
    v_cvt_pk_bf16_f32 v84, v32, v33
    v_cvt_pk_bf16_f32 v85, v34, v35
    v_cvt_pk_bf16_f32 v86, v36, v37
    v_cvt_pk_bf16_f32 v87, v38, v39
    v_cvt_pk_bf16_f32 v88, v40, v41
    v_cvt_pk_bf16_f32 v89, v42, v43
    v_cvt_pk_bf16_f32 v90, v44, v45
    v_cvt_pk_bf16_f32 v91, v46, v47
    v_cvt_pk_bf16_f32 v92, v48, v49
    s_cmp_lg_u32 s7, 0
    s_cbranch_scc1 FIN_7
    v_lshlrev_b32 v32, 16, v84
    v_and_b32 v33, 0xffff0000, v84
    v_lshlrev_b32 v34, 16, v85
    v_and_b32 v35, 0xffff0000, v85
    v_lshlrev_b32 v36, 16, v86
    v_and_b32 v37, 0xffff0000, v86
    v_lshlrev_b32 v38, 16, v87
    v_and_b32 v39, 0xffff0000, v87
    v_lshlrev_b32 v40, 16, v88
    v_and_b32 v41, 0xffff0000, v88
    v_lshlrev_b32 v42, 16, v89
    v_and_b32 v43, 0xffff0000, v89
    v_lshlrev_b32 v44, 16, v90
    v_and_b32 v45, 0xffff0000, v90
    v_lshlrev_b32 v46, 16, v91
    v_and_b32 v47, 0xffff0000, v91
    v_lshlrev_b32 v48, 16, v92
    v_and_b32 v49, 0xffff0000, v92
    s_mov_b32 s7, 0x8000
    v_pk_add_f32 v[24:25], v[32:33], v[34:35]
    v_pk_mul_f32 v[26:27], v[32:33], v[32:33]
    v_pk_add_f32 v[16:17], v[38:39], v[40:41]
    v_pk_mul_f32 v[20:21], v[38:39], v[38:39]
    v_pk_add_f32 v[18:19], v[44:45], v[46:47]
    v_pk_mul_f32 v[22:23], v[44:45], v[44:45]
    v_pk_add_f32 v[24:25], v[24:25], v[36:37]
    v_pk_fma_f32 v[26:27], v[34:35], v[34:35], v[26:27]
    v_pk_add_f32 v[16:17], v[16:17], v[42:43]
    v_pk_fma_f32 v[20:21], v[40:41], v[40:41], v[20:21]
    v_pk_add_f32 v[18:19], v[18:19], v[48:49]
    v_pk_fma_f32 v[22:23], v[46:47], v[46:47], v[22:23]
    v_pk_add_f32 v[24:25], v[24:25], v[16:17]
    v_pk_fma_f32 v[26:27], v[36:37], v[36:37], v[26:27]
    v_pk_fma_f32 v[20:21], v[42:43], v[42:43], v[20:21]
    v_pk_fma_f32 v[22:23], v[48:49], v[48:49], v[22:23]
    v_pk_add_f32 v[24:25], v[24:25], v[18:19]
    v_pk_add_f32 v[26:27], v[26:27], v[20:21]
    v_add_f32 v24, v24, v25
    v_pk_add_f32 v[26:27], v[26:27], v[22:23]
    v_add_f32 v26, v26, v27
    s_nop 1
    v_permlane32_swap_b32 v24, v26
    v_add_f32 v24, v24, v26
    s_nop 1
    v_add_f32_dpp v24, v24, v24 row_ror:8 row_mask:0xf bank_mask:0xf
    ds_write_b32 v28, v24 offset:0
    s_waitcnt lgkmcnt(0)
    s_barrier
    ds_read_b128 v[52:55], v29 offset:0
    ds_read_b128 v[56:59], v29 offset:16
    ds_read_b128 v[60:63], v29 offset:32
    ds_read_b128 v[64:67], v29 offset:48
    s_waitcnt lgkmcnt(2)
    v_pk_add_f32 v[52:53], v[52:53], v[54:55]
    v_pk_add_f32 v[56:57], v[56:57], v[58:59]
    s_waitcnt lgkmcnt(0)
    v_pk_add_f32 v[60:61], v[60:61], v[62:63]
    v_pk_add_f32 v[64:65], v[64:65], v[66:67]
    v_pk_add_f32 v[52:53], v[52:53], v[56:57]
    v_pk_add_f32 v[60:61], v[60:61], v[64:65]
    v_add_f32 v24, v52, v53
    v_add_f32 v26, v60, v61
    v_mul_f32 v24, 0x3ae38e39, v24
    v_mul_f32 v26, 0x3ae38e39, v26
    v_fma_f32 v26, -v24, v24, v26
    v_cvt_pk_bf16_f32 v24, v24, v24
    v_max_f32 v26, 0, v26
    v_lshlrev_b32 v24, 16, v24
    v_cvt_pk_bf16_f32 v26, v26, v26
    v_pk_add_f32 v[52:53], v[32:33], v[24:25] op_sel_hi:[1,0] neg_lo:[0,1] neg_hi:[0,1]
    v_lshlrev_b32 v26, 16, v26
    v_pk_add_f32 v[54:55], v[34:35], v[24:25] op_sel_hi:[1,0] neg_lo:[0,1] neg_hi:[0,1]
    v_add_f32 v26, 0x3727c5ac, v26
    v_pk_add_f32 v[56:57], v[36:37], v[24:25] op_sel_hi:[1,0] neg_lo:[0,1] neg_hi:[0,1]
    v_cvt_pk_bf16_f32 v26, v26, v26
    v_pk_add_f32 v[58:59], v[38:39], v[24:25] op_sel_hi:[1,0] neg_lo:[0,1] neg_hi:[0,1]
    v_lshlrev_b32 v26, 16, v26
    v_pk_add_f32 v[60:61], v[40:41], v[24:25] op_sel_hi:[1,0] neg_lo:[0,1] neg_hi:[0,1]
    v_sqrt_f32 v26, v26
    v_pk_add_f32 v[62:63], v[42:43], v[24:25] op_sel_hi:[1,0] neg_lo:[0,1] neg_hi:[0,1]
    v_cvt_pk_bf16_f32 v26, v26, v26
    v_pk_add_f32 v[64:65], v[44:45], v[24:25] op_sel_hi:[1,0] neg_lo:[0,1] neg_hi:[0,1]
    v_lshlrev_b32 v26, 16, v26
    v_pk_add_f32 v[66:67], v[46:47], v[24:25] op_sel_hi:[1,0] neg_lo:[0,1] neg_hi:[0,1]
    v_rcp_f32 v26, v26
    v_pk_add_f32 v[68:69], v[48:49], v[24:25] op_sel_hi:[1,0] neg_lo:[0,1] neg_hi:[0,1]
    v_pk_mul_f32 v[52:53], v[52:53], v[26:27] op_sel_hi:[1,0]
    v_pk_mul_f32 v[54:55], v[54:55], v[26:27] op_sel_hi:[1,0]
    v_pk_mul_f32 v[56:57], v[56:57], v[26:27] op_sel_hi:[1,0]
    v_pk_mul_f32 v[58:59], v[58:59], v[26:27] op_sel_hi:[1,0]
    v_pk_mul_f32 v[60:61], v[60:61], v[26:27] op_sel_hi:[1,0]
    v_pk_mul_f32 v[62:63], v[62:63], v[26:27] op_sel_hi:[1,0]
    v_pk_mul_f32 v[64:65], v[64:65], v[26:27] op_sel_hi:[1,0]
    v_pk_mul_f32 v[66:67], v[66:67], v[26:27] op_sel_hi:[1,0]
    v_pk_mul_f32 v[68:69], v[68:69], v[26:27] op_sel_hi:[1,0]
    s_branch NOY_5
FIN_7:
    s_mov_b32 s54, 0x240000
    s_mov_b32 s55, 0x20000
    s_mul_i32 s48, s2, 9216
    ds_write_b64 v250, v[84:85] offset:0
    ds_write_b64 v250, v[86:87] offset:32
    ds_write_b64 v250, v[88:89] offset:128
    ds_write_b64 v250, v[90:91] offset:160
    ds_write_b32 v251, v92 offset:1024
    v_lshlrev_b32 v16, 4, v0
    v_lshlrev_b32 v17, 2, v0
    s_add_u32 s49, s48, 4096
    s_add_u32 s47, s48, 8192
    s_waitcnt lgkmcnt(0)
    s_barrier
    ds_read_b128 v[20:23], v16
    ds_read_b128 v[24:27], v16 offset:4096
    ds_read_b32 v28, v17 offset:8192
    s_waitcnt lgkmcnt(2)
    buffer_store_dwordx4 v[20:23], v16, s[52:55], s48 offen sc1
    s_waitcnt lgkmcnt(1)
    buffer_store_dwordx4 v[24:27], v16, s[52:55], s49 offen sc1
    s_waitcnt lgkmcnt(0)
    buffer_store_dword v28, v17, s[52:55], s47 offen sc1
END_1:
    s_endpgm
PS_34:
    s_mov_b32 s26, 0x80000
PL_46:
    buffer_load_dword v216, v222, s[8:11], s42 offen sc1
    s_sub_u32 s26, s26, 1
    s_waitcnt vmcnt(0)
    v_cmp_ne_u32 vcc, s6, v216
    s_cmp_eq_u32 s26, 0
    s_cbranch_scc1 PK_33
    s_cbranch_vccnz PL_46
    s_branch PK_33
PS_36:
    s_mov_b32 s26, 0x80000
PL_47:
    buffer_load_dword v216, v222, s[8:11], s42 offen sc1
    s_sub_u32 s26, s26, 1
    s_waitcnt vmcnt(0)
    v_cmp_ne_u32 vcc, s6, v216
    s_cmp_eq_u32 s26, 0
    s_cbranch_scc1 PK_35
    s_cbranch_vccnz PL_47
    s_branch PK_35
PS_38:
    s_mov_b32 s26, 0x80000
PL_48:
    buffer_load_dword v216, v222, s[8:11], s42 offen sc1
    s_sub_u32 s26, s26, 1
    s_waitcnt vmcnt(0)
    v_cmp_ne_u32 vcc, s6, v216
    s_cmp_eq_u32 s26, 0
    s_cbranch_scc1 PK_37
    s_cbranch_vccnz PL_48
    s_branch PK_37
PS_40:
    s_mov_b32 s26, 0x80000
PL_49:
    buffer_load_dword v216, v222, s[8:11], s42 offen sc1
    s_sub_u32 s26, s26, 1
    s_waitcnt vmcnt(0)
    v_cmp_ne_u32 vcc, s6, v216
    s_cmp_eq_u32 s26, 0
    s_cbranch_scc1 PK_39
    s_cbranch_vccnz PL_49
    s_branch PK_39
.p2align 6
code_end:
    s_endpgm
.section .rodata,"a"
.p2align 6
.amdhsa_kernel interleave_layers__ssm_conv_h3__glu_gated_reglu__prompt_kernel
  .amdhsa_next_free_vgpr 512
  .amdhsa_next_free_sgpr 100
  .amdhsa_accum_offset 256
  .amdhsa_group_segment_fixed_size 0
  .amdhsa_kernarg_size 104
  .amdhsa_user_sgpr_count 2
  .amdhsa_user_sgpr_kernarg_segment_ptr 1
  .amdhsa_system_sgpr_workgroup_id_x 1
  .amdhsa_float_denorm_mode_32 3
  .amdhsa_float_denorm_mode_16_64 3
.end_amdhsa_kernel
```
